```python
import torch

def _softmax(x, axis=-1):
    return torch.softmax(x, dim=axis)
def _gelu(x):
    return torch.nn.functional.gelu(x, approximate="tanh")
def _silu(x):
    return torch.nn.functional.silu(x)
def _sigmoid(x):
    return torch.sigmoid(x)
def _layernorm(x, axis=-1, eps=1e-5):
    m = x.mean(dim=axis, keepdim=True)
    v = x.var(dim=axis, keepdim=True, unbiased=False)
    return (x - m) / torch.sqrt(v + eps)
def _scatter_add(tgt, idx, src, axis=0):
    return tgt.clone().index_add_(axis, idx, src)
def _segment_sum(src, seg, n):
    out = torch.zeros((n,) + src.shape[1:], dtype=src.dtype)
    return out.index_add_(0, seg, src)
def _pad(x, pw):
    flat = tuple(v for pair in reversed(pw) for v in pair)
    return torch.nn.functional.pad(x, flat)

kernel_name = 'standalone__gqa_softmax__near_ridge'

def setup_inputs():

    _w = (lambda a: (lambda t: t.to(torch.bfloat16) if t.is_floating_point() else t)(torch.as_tensor(a)))
    B, Hq, Hkv, Sq, Sk, D = 16, 32, 4, 512, 512, 128
    return {
        "q": _w((lambda *s: torch.randn(*s, dtype=torch.bfloat16) * 0.8)(B, Hq, Sq, D)),
        "k": _w((lambda *s: torch.randn(*s, dtype=torch.bfloat16) * 0.8)(B, Hkv, Sk, D)),
        "v": _w((lambda *s: torch.randn(*s, dtype=torch.bfloat16) * 0.05)(B, Hkv, Sk, D)),
    }

def reference(q, k, v):
    B, Hq, Sq, D = q.shape
    Hkv = k.shape[1]
    rep = Hq // Hkv
    k = (lambda x, n, axis: torch.repeat_interleave(x, n, dim=axis))(k, rep, axis=1)
    v = (lambda x, n, axis: torch.repeat_interleave(x, n, dim=axis))(v, rep, axis=1)
    scale = D ** -0.5
    scores = torch.einsum("bhqd,bhkd->bhqk", q, k) * scale
    p = _softmax(scores, axis=-1)
    return torch.einsum("bhqk,bhkd->bhqd", p, v)
```

```asm
; @launch grid=(256,1,1) block=(256,1,1) lds=163840
.amdgcn_target "amdgcn-amd-amdhsa--gfx950"
.text
.globl standalone__gqa_softmax__near_ridge_kernel
.p2align 12
.fill 832, 4, 0xbf810000
.p2align 8
.type standalone__gqa_softmax__near_ridge_kernel,@function
standalone__gqa_softmax__near_ridge_kernel:
    s_load_dwordx8 s[4:11], s[0:1], 0
    v_lshrrev_b32 v16, 6, v0
    v_and_b32 v20, 63, v0
    v_readfirstlane_b32 s3, v16
    s_cmp_ge_u32 s2, 256
    s_cbranch_scc1 L_end
    v_lshlrev_b32 v0, 4, v20
    s_and_b32 s46, s2, 7
    s_lshr_b32 s47, s2, 3
    s_lshl_b32 s46, s46, 5
    s_add_u32 s46, s46, s47
    s_lshl2_add_u32 s48, s46, s3
    s_lshl_b32 s48, s48, 16
    s_lshr_b32 s46, s46, 2
    s_lshl_b32 s46, s46, 17
    s_lshl_b32 s52, s3, 12
    s_add_u32 s49, s46, s52
    s_sub_u32 s18, 0x20000, s52
    s_mov_b32 s19, 0x20000
    s_mov_b32 s15, s19
    s_mov_b32 s14, 0x10000
    s_mov_b32 s32, 0
    s_movk_i32 s33, 0x4000
    s_mov_b32 s42, 0
    s_mul_i32 s76, s3, 4192
    s_add_u32 s77, s76, 32
    s_add_u32 s78, s76, 64
    s_add_u32 s79, s76, 96
    s_getpc_b64 s[28:29]
L_pc:
    s_mov_b32 s30, L_slow - L_pc
    s_bfe_u32 s47, s2, 0x30003
    s_lshl2_add_u32 s47, s47, s3
    s_lshl_b32 s47, s47, 11
    v_lshl_add_u32 v59, v20, 5, s47
    v_min_u32 v59, s30, v59
    v_mov_b32 v31, s29
    v_add_co_u32 v30, vcc, s28, v59
    s_nop 1
    v_addc_co_u32 v31, vcc, 0, v31, vcc
    global_load_dword v59, v[30:31], off
    s_waitcnt lgkmcnt(0)
    s_add_u32 s16, s6, s49
    s_addc_u32 s17, s7, 0
    s_add_u32 s12, s4, s48
    s_addc_u32 s13, s5, 0
    s_mov_b32 m0, s76
    buffer_load_dwordx4 v[132:135], v0, s[16:19], s32 offen offset:0 nt
    buffer_load_dwordx4 v[148:151], v0, s[16:19], s32 offen offset:1024 nt
    buffer_load_dwordx4 v[164:167], v0, s[16:19], s32 offen offset:2048 nt
    buffer_load_dwordx4 v[180:183], v0, s[16:19], s32 offen offset:3072 nt
    buffer_load_dwordx4 v0, s[12:15], s42 offen offset:0 nt lds
    s_mov_b32 m0, s77
    s_nop 0
    buffer_load_dwordx4 v0, s[12:15], s42 offen offset:1024 nt lds
    s_mov_b32 m0, s78
    s_nop 0
    buffer_load_dwordx4 v0, s[12:15], s42 offen offset:2048 nt lds
    s_mov_b32 m0, s79
    s_nop 0
    buffer_load_dwordx4 v0, s[12:15], s42 offen offset:3072 nt lds
    s_add_u32 s42, s42, 4096
    s_add_u32 s20, s8, s49
    s_addc_u32 s21, s9, 0
    s_sub_u32 s28, s20, 8
    s_subb_u32 s29, s21, 0
    s_add_u32 s30, s18, 8
    s_mov_b32 s31, 0x20000
    s_add_u32 s24, s10, s48
    s_addc_u32 s25, s11, 0
    s_mov_b32 s22, s18
    s_mov_b32 s23, 0x20000
    s_mov_b32 s26, 0x10000
    s_mov_b32 s27, 0x20000
    s_mov_b32 s34, 32768
    s_mov_b32 s35, 49152
    s_mov_b32 s36, 65536
    s_mov_b32 s37, 81920
    s_mov_b32 s38, 98304
    s_mov_b32 s39, 114688
    s_mul_i32 s50, s3, 4160
    s_add_u32 s96, s50, 97504
    s_add_u32 s97, s50, 114088
    s_add_u32 s98, s50, 130672
    s_add_u32 s99, s50, 147256
    s_mov_b32 s43, 0
    s_mov_b32 s44, 2
    s_mov_b32 s45, 0x3e0293ee
    s_mov_b32 s54, 0xffff0000

    v_and_b32 v17, 15, v20
    v_lshrrev_b32 v18, 4, v20
    v_lshlrev_b32 v23, 8, v17
    v_lshlrev_b32 v19, 8, v18
    v_xor_b32 v21, v17, v18
    v_lshl_add_u32 v60, v21, 4, v19
    v_xor_b32 v61, 64, v60
    v_add_u32 v62, 64736, v60
    v_add_u32 v63, 64736, v61
    v_and_b32 v22, 7, v17
    v_xor_b32 v22, s3, v22
    v_lshl_add_u32 v22, v22, 4, v23
    v_and_b32 v24, 1, v18
    v_lshl_add_u32 v22, v24, 7, v22
    v_lshrrev_b32 v26, 1, v18
    v_lshl_add_u32 v50, v26, 12, v22
    v_cmp_gt_u32 vcc, 2048, v50
    v_add_u32 v22, 49152, v50
    v_xor_b32 v51, 64, v50
    v_cndmask_b32 v49, v50, v22, vcc
    v_xor_b32 v48, 64, v49
    v_and_b32 v25, 3, v20
    v_lshrrev_b32 v28, 2, v17
    v_lshrrev_b32 v22, 1, v17
    v_xor_b32 v22, v22, v28
    v_and_b32 v22, 1, v22
    v_mul_u32_u24 v22, 6, v22
    v_xor_b32 v29, v22, v17
    v_lshrrev_b32 v22, 2, v29
    v_lshlrev_b32 v22, 5, v22
    v_lshl_add_u32 v22, v29, 8, v22
    v_lshl_add_u32 v22, v18, 4, v22
    v_add_u32 v3, s76, v22
    v_mul_u32_u24 v22, 2056, v24
    v_lshl_add_u32 v22, v26, 8, v22
    v_lshl_add_u32 v22, v25, 4, v22
    v_mul_u32_u24 v24, 4160, v28
    v_add_u32 v24, 97504, v24
    v_add_u32 v1, v24, v22
    v_and_b32 v26, 7, v29
    v_lshlrev_b32 v26, 8, v26
    v_lshl_add_u32 v26, v18, 4, v26
    v_and_b32 v27, 8, v17
    v_lshl_add_u32 v2, v27, 3, v26
    v_cmp_eq_u32 vcc, 1, v25
    v_mov_b32 v22, 0x44444444
    v_mov_b32 v24, 0xeeeeeeee
    v_cndmask_b32 v57, v22, v24, vcc
    v_cmp_gt_u32 vcc, 2, v25
    v_mov_b32 v22, 0x3f803f80
    v_mov_b32 v58, 0
    v_cndmask_b32 v22, 0, v22, vcc
    v_mov_b32 v12, v22
    v_mov_b32 v13, v22
    v_mov_b32 v14, v22
    v_mov_b32 v15, v22
    s_mov_b32 vcc_lo, 0xff00ff00
    s_mov_b32 vcc_hi, 0xff00ff00
    s_nop 0
    s_mov_b32 m0, s99
    buffer_load_dwordx4 v[196:199], v0, s[16:19], s33 offen offset:0 nt
    buffer_load_dwordx4 v[212:215], v0, s[16:19], s33 offen offset:1024 nt
    buffer_load_dwordx4 v[228:231], v0, s[16:19], s33 offen offset:2048 nt
    buffer_load_dwordx4 v[244:247], v0, s[16:19], s33 offen offset:3072 nt
    s_mov_b64 exec, 0
    s_cmp_eq_u32 s3, 0
    s_cbranch_scc1 L_hop1
    s_cmp_eq_u32 s3, 1
    s_cbranch_scc1 L_hop2
    s_cmp_eq_u32 s3, 2
    s_cbranch_scc1 L_hop3
    s_branch L_hop4
L_hback:
    s_mov_b64 exec, -1
    s_waitcnt vmcnt(11)
    s_nop 0
    buffer_load_dwordx4 v0, s[20:23], s32 offen offset:0 nt lds
    buffer_load_dwordx4 v0, s[20:23], s32 offen offset:1024 nt lds
    buffer_load_dwordx4 v0, s[28:31], s32 offen offset:2056 nt lds
    buffer_load_dwordx4 v0, s[28:31], s32 offen offset:3080 nt lds
    s_mov_b32 m0, s98
    v_lshlrev_b32 v44, 16, v132
    v_lshlrev_b32 v45, 16, v133
    v_lshlrev_b32 v46, 16, v134
    v_lshlrev_b32 v47, 16, v135
    v_and_b32 v132, s54, v132
    v_and_b32 v133, s54, v133
    v_and_b32 v134, s54, v134
    v_and_b32 v135, s54, v135
    v_pk_mul_f32 v[44:45], v[44:45], s[44:45] op_sel:[0,1] op_sel_hi:[1,1]
    v_pk_mul_f32 v[46:47], v[46:47], s[44:45] op_sel:[0,1] op_sel_hi:[1,1]
    v_pk_mul_f32 v[132:133], v[132:133], s[44:45] op_sel:[0,1] op_sel_hi:[1,1]
    v_pk_mul_f32 v[134:135], v[134:135], s[44:45] op_sel:[0,1] op_sel_hi:[1,1]
    v_cvt_pk_bf16_f32 v132, v44, v132
    v_cvt_pk_bf16_f32 v133, v45, v133
    v_cvt_pk_bf16_f32 v134, v46, v134
    v_cvt_pk_bf16_f32 v135, v47, v135
    ds_write_b128 v50, v[132:135] offset:48352
    s_waitcnt vmcnt(14)
    v_lshlrev_b32 v4, 16, v148
    v_lshlrev_b32 v5, 16, v149
    v_lshlrev_b32 v6, 16, v150
    v_lshlrev_b32 v7, 16, v151
    v_and_b32 v148, s54, v148
    v_and_b32 v149, s54, v149
    v_and_b32 v150, s54, v150
    v_and_b32 v151, s54, v151
    v_pk_mul_f32 v[4:5], v[4:5], s[44:45] op_sel:[0,1] op_sel_hi:[1,1]
    v_pk_mul_f32 v[6:7], v[6:7], s[44:45] op_sel:[0,1] op_sel_hi:[1,1]
    v_pk_mul_f32 v[148:149], v[148:149], s[44:45] op_sel:[0,1] op_sel_hi:[1,1]
    v_pk_mul_f32 v[150:151], v[150:151], s[44:45] op_sel:[0,1] op_sel_hi:[1,1]
    v_cvt_pk_bf16_f32 v148, v4, v148
    v_cvt_pk_bf16_f32 v149, v5, v149
    v_cvt_pk_bf16_f32 v150, v6, v150
    v_cvt_pk_bf16_f32 v151, v7, v151
    ds_write_b128 v50, v[148:151] offset:56544
    s_waitcnt vmcnt(13)
    v_lshlrev_b32 v44, 16, v164
    v_lshlrev_b32 v45, 16, v165
    v_lshlrev_b32 v46, 16, v166
    v_lshlrev_b32 v47, 16, v167
    v_and_b32 v164, s54, v164
    v_and_b32 v165, s54, v165
    v_and_b32 v166, s54, v166
    v_and_b32 v167, s54, v167
    v_pk_mul_f32 v[44:45], v[44:45], s[44:45] op_sel:[0,1] op_sel_hi:[1,1]
    v_pk_mul_f32 v[46:47], v[46:47], s[44:45] op_sel:[0,1] op_sel_hi:[1,1]
    v_pk_mul_f32 v[164:165], v[164:165], s[44:45] op_sel:[0,1] op_sel_hi:[1,1]
    v_pk_mul_f32 v[166:167], v[166:167], s[44:45] op_sel:[0,1] op_sel_hi:[1,1]
    v_cvt_pk_bf16_f32 v164, v44, v164
    v_cvt_pk_bf16_f32 v165, v45, v165
    v_cvt_pk_bf16_f32 v166, v46, v166
    v_cvt_pk_bf16_f32 v167, v47, v167
    ds_write_b128 v51, v[164:167] offset:48352
    s_waitcnt vmcnt(12)
    v_lshlrev_b32 v4, 16, v180
    v_lshlrev_b32 v5, 16, v181
    v_lshlrev_b32 v6, 16, v182
    v_lshlrev_b32 v7, 16, v183
    v_and_b32 v180, s54, v180
    v_and_b32 v181, s54, v181
    v_and_b32 v182, s54, v182
    v_and_b32 v183, s54, v183
    v_pk_mul_f32 v[4:5], v[4:5], s[44:45] op_sel:[0,1] op_sel_hi:[1,1]
    v_pk_mul_f32 v[6:7], v[6:7], s[44:45] op_sel:[0,1] op_sel_hi:[1,1]
    v_pk_mul_f32 v[180:181], v[180:181], s[44:45] op_sel:[0,1] op_sel_hi:[1,1]
    v_pk_mul_f32 v[182:183], v[182:183], s[44:45] op_sel:[0,1] op_sel_hi:[1,1]
    v_cvt_pk_bf16_f32 v180, v4, v180
    v_cvt_pk_bf16_f32 v181, v5, v181
    v_cvt_pk_bf16_f32 v182, v6, v182
    v_cvt_pk_bf16_f32 v183, v7, v183
    ds_write_b128 v51, v[180:183] offset:56544
    s_waitcnt lgkmcnt(0)
    s_barrier
    ds_read_b128 a[64:67], v60 offset:48352
    ds_read_b128 a[68:71], v61 offset:49376
    ds_read_b128 a[72:75], v60 offset:50400
    ds_read_b128 a[76:79], v61 offset:51424
    ds_read_b128 a[80:83], v60 offset:52448
    ds_read_b128 a[84:87], v61 offset:53472
    ds_read_b128 a[88:91], v60 offset:54496
    ds_read_b128 a[92:95], v61 offset:55520
    s_waitcnt vmcnt(8)
    ds_read_b128 a[0:3], v3 offset:0
    ds_read_b128 a[4:7], v3 offset:64
    ds_read_b128 a[8:11], v3 offset:128
    ds_read_b128 a[12:15], v3 offset:192
    buffer_load_dwordx4 v[136:139], v0, s[16:19], s34 offen offset:0 nt
    buffer_load_dwordx4 v[152:155], v0, s[16:19], s34 offen offset:1024 nt
    buffer_load_dwordx4 v[168:171], v0, s[16:19], s34 offen offset:2048 nt
    buffer_load_dwordx4 v[184:187], v0, s[16:19], s34 offen offset:3072 nt
    s_waitcnt lgkmcnt(3)
    v_mfma_f32_16x16x32_bf16 v[16:19], a[64:67], a[0:3], -4.0
    s_waitcnt vmcnt(11) lgkmcnt(2)
    ds_read_b128 a[96:99], v60 offset:56544
    ds_read_b128 a[100:103], v61 offset:57568
    ds_read_b128 a[104:107], v60 offset:58592
    v_lshlrev_b32 v56, 16, v196
    v_and_b32 v196, s54, v196
    v_mul_f32 v56, s45, v56
    v_mul_f32 v196, s45, v196
    v_cvt_pk_bf16_f32 v196, v56, v196
    v_lshlrev_b32 v44, 16, v197
    v_and_b32 v197, s54, v197
    v_mfma_f32_16x16x32_bf16 v[16:19], a[68:71], a[4:7], v[16:19]
    s_waitcnt lgkmcnt(4)
    buffer_load_dwordx4 v0, s[20:23], s33 offen offset:0 nt lds
    ds_read_b128 a[108:111], v61 offset:59616
    ds_read_b128 a[124:127], v61 offset:63712
    ds_read_b128 a[120:123], v60 offset:62688
    v_mul_f32 v44, s45, v44
    v_mul_f32 v197, s45, v197
    v_cvt_pk_bf16_f32 v197, v44, v197
    v_lshlrev_b32 v45, 16, v198
    v_and_b32 v198, s54, v198
    v_mul_f32 v45, s45, v45
    v_mfma_f32_16x16x32_bf16 v[16:19], a[72:75], a[8:11], v[16:19]
    s_waitcnt vmcnt(11) lgkmcnt(6)
    buffer_load_dwordx4 v0, s[20:23], s33 offen offset:1024 nt lds
    v_mul_f32 v198, s45, v198
    v_cvt_pk_bf16_f32 v198, v45, v198
    v_lshlrev_b32 v46, 16, v199
    v_and_b32 v199, s54, v199
    v_mul_f32 v46, s45, v46
    v_mul_f32 v199, s45, v199
    v_cvt_pk_bf16_f32 v199, v46, v199
    v_lshlrev_b32 v47, 16, v212
    v_and_b32 v212, s54, v212
    v_mul_f32 v47, s45, v47
    v_mfma_f32_16x16x32_bf16 v[16:19], a[76:79], a[12:15], v[16:19]
    ds_write_b128 v49, v[196:199] offset:15584
    buffer_load_dwordx4 v0, s[28:31], s33 offen offset:2056 nt lds
    v_mul_f32 v212, s45, v212
    v_cvt_pk_bf16_f32 v212, v47, v212
    v_lshlrev_b32 v56, 16, v213
    v_and_b32 v213, s54, v213
    v_mul_f32 v56, s45, v56
    v_mul_f32 v213, s45, v213
    v_cvt_pk_bf16_f32 v213, v56, v213
    v_mfma_f32_16x16x32_bf16 v[20:23], a[92:95], a[12:15], -4.0
    s_waitcnt vmcnt(12)
    buffer_load_dwordx4 v0, s[28:31], s33 offen offset:3080 nt lds
    v_lshlrev_b32 v44, 16, v214
    v_and_b32 v214, s54, v214
    v_mul_f32 v44, s45, v44
    v_mul_f32 v214, s45, v214
    v_cvt_pk_bf16_f32 v214, v44, v214
    v_lshlrev_b32 v45, 16, v215
    v_and_b32 v215, s54, v215
    v_mul_f32 v45, s45, v45
    v_mul_f32 v215, s45, v215
    v_cvt_pk_bf16_f32 v215, v45, v215
    v_lshlrev_b32 v46, 16, v228
    v_mfma_f32_16x16x32_bf16 v[20:23], a[88:91], a[8:11], v[20:23]
    s_mov_b32 m0, s76
    ds_write_b128 v50, v[212:215] offset:23776
    v_and_b32 v228, s54, v228
    v_mul_f32 v46, s45, v46
    v_mul_f32 v228, s45, v228
    v_cvt_pk_bf16_f32 v228, v46, v228
    v_lshlrev_b32 v47, 16, v229
    v_and_b32 v229, s54, v229
    v_mul_f32 v47, s45, v47
    v_mul_f32 v229, s45, v229
    v_cvt_pk_bf16_f32 v229, v47, v229
    v_lshlrev_b32 v56, 16, v230
    v_and_b32 v230, s54, v230
    v_mfma_f32_16x16x32_bf16 v[20:23], a[84:87], a[4:7], v[20:23]
    s_waitcnt vmcnt(12)
    v_mul_f32 v56, s45, v56
    v_mul_f32 v230, s45, v230
    v_cvt_pk_bf16_f32 v230, v56, v230
    v_lshlrev_b32 v44, 16, v231
    v_and_b32 v231, s54, v231
    v_mul_f32 v44, s45, v44
    v_mul_f32 v231, s45, v231
    v_cvt_pk_bf16_f32 v231, v44, v231
    v_lshlrev_b32 v45, 16, v244
    v_and_b32 v244, s54, v244
    v_mul_f32 v45, s45, v45
    v_mul_f32 v244, s45, v244
    v_cvt_pk_bf16_f32 v244, v45, v244
    v_lshlrev_b32 v46, 16, v245
    v_and_b32 v245, s54, v245
    v_mfma_f32_16x16x32_bf16 v[20:23], a[80:83], a[0:3], v[20:23]
    s_waitcnt lgkmcnt(7)
    ds_read_b128 a[116:119], v61 offset:61664
    v_mul_f32 v46, s45, v46
    v_mul_f32 v245, s45, v245
    v_cvt_pk_bf16_f32 v245, v46, v245
    v_lshlrev_b32 v47, 16, v246
    v_and_b32 v246, s54, v246
    v_mul_f32 v47, s45, v47
    v_mul_f32 v246, s45, v246
    v_cvt_pk_bf16_f32 v246, v47, v246
    v_lshlrev_b32 v56, 16, v247
    v_and_b32 v247, s54, v247
    v_mul_f32 v56, s45, v56
    v_mul_f32 v247, s45, v247
    v_cvt_pk_bf16_f32 v247, v56, v247
    v_mfma_f32_16x16x32_bf16 v[24:27], a[96:99], a[0:3], -4.0
    s_waitcnt lgkmcnt(7)
    ds_write_b128 v48, v[228:231] offset:15584
    ds_write_b128 v51, v[244:247] offset:23776
    ds_read_b128 a[112:115], v60 offset:60640
    v_mov_b32 v32, 0
    v_mfma_f32_16x16x32_bf16 v[24:27], a[100:103], a[4:7], v[24:27]
    s_waitcnt lgkmcnt(9)
    buffer_load_dwordx4 v0, s[12:15], s42 offen offset:0 nt lds
    v_exp_f32 v16, v16
    v_exp_f32 v17, v17
    v_mfma_f32_16x16x32_bf16 v[24:27], a[104:107], a[8:11], v[24:27]
    s_waitcnt lgkmcnt(8)
    s_mov_b32 m0, s77
    v_exp_f32 v18, v18
    v_exp_f32 v19, v19
    v_cvt_pk_bf16_f32 v64, v16, v17
    v_mov_b32 v33, 0
    v_mfma_f32_16x16x32_bf16 v[24:27], a[108:111], a[12:15], v[24:27]
    s_waitcnt lgkmcnt(7)
    v_cvt_pk_bf16_f32 v65, v18, v19
    v_exp_f32 v20, v20
    v_exp_f32 v21, v21
    v_mfma_f32_16x16x32_bf16 v[28:31], a[124:127], a[12:15], -4.0
    s_waitcnt lgkmcnt(6)
    buffer_load_dwordx4 v0, s[12:15], s42 offen offset:1024 nt lds
    v_exp_f32 v22, v22
    v_exp_f32 v23, v23
    v_mfma_f32_16x16x32_bf16 v[28:31], a[120:123], a[8:11], v[28:31]
    s_waitcnt lgkmcnt(3)
    s_mov_b32 m0, s78
    v_cvt_pk_bf16_f32 v66, v20, v21
    v_cvt_pk_bf16_f32 v67, v22, v23
    v_mov_b32 v36, 0
    v_mov_b32 v37, 0
    v_mfma_f32_16x16x32_bf16 v[28:31], a[116:119], a[4:7], v[28:31]
    s_waitcnt vmcnt(10) lgkmcnt(0)
    v_mfma_f32_16x16x32_bf16 v[28:31], a[112:115], a[0:3], v[28:31]
    s_barrier
    ds_read_b128 v[52:55], v62 offset:0
    ds_read_b128 v[8:11], v63 offset:1024
    ds_read_b128 a[200:203], v60 offset:17632
    ds_read_b128 a[204:207], v61 offset:18656
    ds_read_b128 a[220:223], v61 offset:22752
    ds_read_b128 a[216:219], v60 offset:21728
    ds_read_b128 a[212:215], v61 offset:20704
    buffer_load_dwordx4 v0, s[12:15], s42 offen offset:2048 nt lds
    s_waitcnt lgkmcnt(6)
    v_mfma_f32_16x16x32_bf16 v[16:19], v[52:55], a[0:3], -4.0
    s_waitcnt vmcnt(10) lgkmcnt(5)
    s_mov_b32 m0, s79
    ds_read_b128 a[208:211], v60 offset:19680
    ds_read_b64_tr_b16 a[128:129], v1 offset:49752
    ds_read_b64_tr_b16 a[130:131], v1 offset:50264
    v_exp_f32 v24, v24
    v_lshlrev_b32 v44, 16, v136
    v_mfma_f32_16x16x32_bf16 v[16:19], v[8:11], a[4:7], v[16:19]
    s_waitcnt lgkmcnt(7)
    buffer_load_dwordx4 v[200:203], v0, s[16:19], s35 offen offset:0 nt
    ds_read_b64_tr_b16 a[132:133], v1 offset:50776
    ds_read_b64_tr_b16 a[134:135], v1 offset:51288
    ds_read_b64_tr_b16 a[136:137], v1 offset:49760
    ds_read_b64_tr_b16 a[138:139], v1 offset:50272
    v_mfma_f32_16x16x32_bf16 v[16:19], a[200:203], a[8:11], v[16:19]
    s_waitcnt lgkmcnt(10)
    ds_read_b64_tr_b16 a[140:141], v1 offset:50784
    ds_read_b64_tr_b16 a[142:143], v1 offset:51296
    ds_read_b128 a[224:227], v60 offset:23776
    v_exp_f32 v25, v25
    v_exp_f32 v26, v26
    v_mfma_f32_16x16x32_bf16 v[16:19], a[204:207], a[12:15], v[16:19]
    s_waitcnt lgkmcnt(12)
    buffer_load_dwordx4 v0, s[12:15], s42 offen offset:3072 nt lds
    v_exp_f32 v27, v27
    v_exp_f32 v28, v28
    v_mfma_f32_16x16x32_bf16 v[20:23], a[220:223], a[12:15], -4.0
    s_waitcnt lgkmcnt(11)
    s_mov_b32 m0, s96
    v_exp_f32 v29, v29
    v_exp_f32 v30, v30
    v_exp_f32 v31, v31
    v_cvt_pk_bf16_f32 v68, v24, v25
    v_mfma_f32_16x16x32_bf16 v[20:23], a[216:219], a[8:11], v[20:23]
    s_waitcnt lgkmcnt(10)
    buffer_load_dwordx4 v[216:219], v0, s[16:19], s35 offen offset:1024 nt
    ds_read_b128 a[228:231], v61 offset:24800
    ds_read_b128 a[232:235], v60 offset:25824
    v_cvt_pk_bf16_f32 v69, v26, v27
    v_cvt_pk_bf16_f32 v70, v28, v29
    v_cvt_pk_bf16_f32 v71, v30, v31
    v_mfma_f32_16x16x32_bf16 v[20:23], a[212:215], a[4:7], v[20:23]
    s_waitcnt lgkmcnt(11)
    ds_read_b128 a[236:239], v61 offset:26848
    ds_read_b64_tr_b16 a[144:145], v1 offset:49816
    ds_read_b64_tr_b16 a[146:147], v1 offset:50328
    v_and_b32 v136, s54, v136
    v_mul_f32 v44, s45, v44
    v_mul_f32 v136, s45, v136
    v_mfma_f32_16x16x32_bf16 v[20:23], a[208:211], a[0:3], v[20:23]
    s_waitcnt lgkmcnt(12)
    buffer_load_dwordx4 v[232:235], v0, s[16:19], s35 offen offset:2048 nt
    ds_read_b64_tr_b16 a[148:149], v1 offset:50840
    ds_read_b64_tr_b16 a[150:151], v1 offset:51352
    ds_read_b64_tr_b16 a[156:157], v1 offset:50848
    ds_read_b64_tr_b16 a[158:159], v1 offset:51360
    v_cvt_pk_bf16_f32 v136, v44, v136
    v_mfma_f32_16x16x32_bf16 v[128:131], a[128:131], v[64:67], 0
    s_waitcnt lgkmcnt(14)
    ds_read_b64_tr_b16 a[152:153], v1 offset:49824
    ds_read_b64_tr_b16 a[154:155], v1 offset:50336
    ds_read_b64_tr_b16 a[160:161], v1 offset:49880
    ds_read_b64_tr_b16 a[162:163], v1 offset:50392
    v_lshlrev_b32 v45, 16, v137
    v_and_b32 v137, s54, v137
    v_mul_f32 v45, s45, v45
    v_mfma_f32_16x16x32_bf16 v[128:131], a[132:135], v[68:71], v[128:131]
    s_add_u32 s42, s42, 4096
    buffer_load_dwordx4 v[248:251], v0, s[16:19], s35 offen offset:3072 nt
    ds_read_b64_tr_b16 a[164:165], v1 offset:50904
    ds_read_b64_tr_b16 a[166:167], v1 offset:51416
    ds_read_b128 a[240:243], v60 offset:27872
    v_mul_f32 v137, s45, v137
    v_cvt_pk_bf16_f32 v137, v45, v137
    v_smfmac_f32_16x16x64_bf16 v[32:35], v[12:15], v[64:71], v57
    s_waitcnt lgkmcnt(14)
    ds_read_b128 a[244:247], v61 offset:28896
    ds_read_b128 a[248:251], v60 offset:29920
    v_lshlrev_b32 v46, 16, v138
    v_and_b32 v138, s54, v138
    v_mul_f32 v46, s45, v46
    v_mul_f32 v138, s45, v138
    v_mfma_f32_16x16x32_bf16 v[144:147], a[136:139], v[64:67], 0
    s_waitcnt lgkmcnt(14)
    ds_read_b128 a[252:255], v61 offset:30944
    ds_read_b64_tr_b16 a[168:169], v1 offset:49888
    ds_read_b64_tr_b16 a[170:171], v1 offset:50400
    v_cvt_pk_bf16_f32 v138, v46, v138
    v_lshlrev_b32 v47, 16, v139
    v_and_b32 v139, s54, v139
    v_mul_f32 v47, s45, v47
    v_mfma_f32_16x16x32_bf16 v[144:147], a[140:143], v[68:71], v[144:147]
    s_waitcnt vmcnt(14) lgkmcnt(14)
    v_mul_f32 v139, s45, v139
    v_cvt_pk_bf16_f32 v139, v47, v139
    v_lshlrev_b32 v56, 16, v152
    v_and_b32 v152, s54, v152
    v_mul_f32 v56, s45, v56
    v_mul_f32 v152, s45, v152
    v_cvt_pk_bf16_f32 v152, v56, v152
    v_lshlrev_b32 v44, 16, v153
    v_mfma_f32_16x16x32_bf16 v[24:27], a[224:227], a[0:3], -4.0
    s_waitcnt lgkmcnt(14)
    ds_write_b128 v50, v[136:139] offset:31968
    v_and_b32 v153, s54, v153
    v_mul_f32 v44, s45, v44
    v_mul_f32 v153, s45, v153
    v_cvt_pk_bf16_f32 v153, v44, v153
    v_lshlrev_b32 v45, 16, v154
    v_mfma_f32_16x16x32_bf16 v[24:27], a[228:231], a[4:7], v[24:27]
    s_waitcnt lgkmcnt(14)
    v_and_b32 v154, s54, v154
    v_mul_f32 v45, s45, v45
    v_mul_f32 v154, s45, v154
    v_cvt_pk_bf16_f32 v154, v45, v154
    v_lshlrev_b32 v46, 16, v155
    v_and_b32 v155, s54, v155
    v_mul_f32 v46, s45, v46
    v_mfma_f32_16x16x32_bf16 v[24:27], a[232:235], a[8:11], v[24:27]
    s_waitcnt vmcnt(13) lgkmcnt(14)
    v_mul_f32 v155, s45, v155
    v_cvt_pk_bf16_f32 v155, v46, v155
    v_lshlrev_b32 v47, 16, v168
    v_and_b32 v168, s54, v168
    v_mul_f32 v47, s45, v47
    v_mul_f32 v168, s45, v168
    v_cvt_pk_bf16_f32 v168, v47, v168
    v_mfma_f32_16x16x32_bf16 v[24:27], a[236:239], a[12:15], v[24:27]
    s_waitcnt lgkmcnt(14)
    buffer_load_dwordx4 v0, s[20:23], s34 offen offset:0 nt lds
    ds_write_b128 v50, v[152:155] offset:40160
    v_lshlrev_b32 v56, 16, v169
    v_and_b32 v169, s54, v169
    v_mul_f32 v56, s45, v56
    v_mfma_f32_16x16x32_bf16 v[160:163], a[144:147], v[64:67], 0
    s_waitcnt lgkmcnt(14)
    v_mul_f32 v169, s45, v169
    v_cvt_pk_bf16_f32 v169, v56, v169
    v_lshlrev_b32 v44, 16, v170
    v_and_b32 v170, s54, v170
    v_mul_f32 v44, s45, v44
    v_mul_f32 v170, s45, v170
    v_cvt_pk_bf16_f32 v170, v44, v170
    v_lshlrev_b32 v45, 16, v171
    v_mfma_f32_16x16x32_bf16 v[160:163], a[148:151], v[68:71], v[160:163]
    s_waitcnt vmcnt(13) lgkmcnt(14)
    buffer_load_dwordx4 v0, s[20:23], s34 offen offset:1024 nt lds
    v_and_b32 v171, s54, v171
    v_mul_f32 v45, s45, v45
    v_mul_f32 v171, s45, v171
    v_cvt_pk_bf16_f32 v171, v45, v171
    v_lshlrev_b32 v46, 16, v184
    v_and_b32 v184, s54, v184
    v_mfma_f32_16x16x32_bf16 v[176:179], a[156:159], v[68:71], 0
    s_waitcnt lgkmcnt(12)
    buffer_load_dwordx4 v0, s[28:31], s34 offen offset:2056 nt lds
    ds_write_b128 v51, v[168:171] offset:31968
    v_mul_f32 v46, s45, v46
    v_mul_f32 v184, s45, v184
    v_cvt_pk_bf16_f32 v184, v46, v184
    v_lshlrev_b32 v47, 16, v185
    v_and_b32 v185, s54, v185
    v_mfma_f32_16x16x32_bf16 v[176:179], a[152:155], v[64:67], v[176:179]
    s_waitcnt lgkmcnt(11)
    v_mul_f32 v47, s45, v47
    v_mul_f32 v185, s45, v185
    v_cvt_pk_bf16_f32 v185, v47, v185
    v_lshlrev_b32 v56, 16, v186
    v_and_b32 v186, s54, v186
    v_mul_f32 v56, s45, v56
    v_mul_f32 v186, s45, v186
    v_cvt_pk_bf16_f32 v186, v56, v186
    v_lshlrev_b32 v44, 16, v187
    v_and_b32 v187, s54, v187
    v_mul_f32 v44, s45, v44
    v_mul_f32 v187, s45, v187
    v_cvt_pk_bf16_f32 v187, v44, v187
    v_mfma_f32_16x16x32_bf16 v[192:195], a[160:163], v[64:67], 0
    s_waitcnt lgkmcnt(9)
    ds_read_b64_tr_b16 a[172:173], v1 offset:50912
    ds_read_b64_tr_b16 a[174:175], v1 offset:51424
    ds_write_b128 v51, v[184:187] offset:40160
    v_mfma_f32_16x16x32_bf16 v[192:195], a[164:167], v[68:71], v[192:195]
    s_waitcnt lgkmcnt(11)
    ds_read_b64_tr_b16 a[180:181], v1 offset:50968
    ds_read_b64_tr_b16 a[182:183], v1 offset:51480
    buffer_load_dwordx4 v0, s[28:31], s34 offen offset:3080 nt lds
    v_mfma_f32_16x16x32_bf16 v[28:31], a[240:243], a[0:3], -4.0
    s_waitcnt lgkmcnt(12)
    ds_read_b64_tr_b16 a[176:177], v1 offset:49944
    ds_read_b64_tr_b16 a[178:179], v1 offset:50456
    v_mov_b32 v40, 0
    v_mfma_f32_16x16x32_bf16 v[28:31], a[244:247], a[4:7], v[28:31]
    s_waitcnt lgkmcnt(13)
    ds_read_b64_tr_b16 a[184:185], v1 offset:49952
    ds_read_b64_tr_b16 a[186:187], v1 offset:50464
    ds_read_b64_tr_b16 a[188:189], v1 offset:50976
    v_mov_b32 v41, 0
    v_mfma_f32_16x16x32_bf16 v[28:31], a[248:251], a[8:11], v[28:31]
    s_waitcnt lgkmcnt(14)
    ds_read_b64_tr_b16 a[190:191], v1 offset:51488
    v_exp_f32 v16, v16
    v_mfma_f32_16x16x32_bf16 v[28:31], a[252:255], a[12:15], v[28:31]
    s_waitcnt lgkmcnt(14)
    v_exp_f32 v17, v17
    v_exp_f32 v18, v18
    v_mfma_f32_16x16x32_bf16 v[208:211], a[168:171], v[64:67], 0
    s_waitcnt vmcnt(12) lgkmcnt(6)
    v_exp_f32 v19, v19
    v_exp_f32 v20, v20
    v_mfma_f32_16x16x32_bf16 v[208:211], a[172:175], v[68:71], v[208:211]
    s_barrier
    ds_read_b128 a[192:195], v60 offset:31968
    ds_read_b128 a[196:199], v61 offset:32992
    ds_read_b128 a[200:203], v60 offset:34016
    v_cvt_pk_bf16_f32 v96, v16, v17
    v_mfma_f32_16x16x32_bf16 v[224:227], a[180:183], v[68:71], 0
    s_waitcnt vmcnt(8) lgkmcnt(7)
    ds_read_b128 a[204:207], v61 offset:35040
    v_cvt_pk_bf16_f32 v97, v18, v19
    v_lshlrev_b32 v44, 16, v200
    v_mfma_f32_16x16x32_bf16 v[224:227], a[176:179], v[64:67], v[224:227]
    s_waitcnt lgkmcnt(6)
    ds_read_b64_tr_b16 a[128:129], v1 offset:33168
    ds_read_b64_tr_b16 a[130:131], v1 offset:33680
    v_exp_f32 v21, v21
    v_mfma_f32_16x16x32_bf16 v[240:243], a[184:187], v[64:67], 0
    s_waitcnt lgkmcnt(6)
    v_exp_f32 v22, v22
    v_exp_f32 v23, v23
    v_mfma_f32_16x16x32_bf16 v[240:243], a[188:191], v[68:71], v[240:243]
    s_waitcnt vmcnt(7) lgkmcnt(5)
    ds_read_b128 a[28:31], v3 offset:192
    ds_read_b128 a[24:27], v3 offset:128
    ds_read_b128 a[20:23], v3 offset:64
    v_mfma_f32_16x16x32_bf16 v[16:19], a[192:195], a[0:3], -4.0
    s_waitcnt lgkmcnt(7)
    ds_read_b128 a[16:19], v3 offset:0
    buffer_load_dwordx4 v[140:143], v0, s[16:19], s36 offen offset:0 nt
    ds_read_b64_tr_b16 a[132:133], v1 offset:34192
    v_mfma_f32_16x16x32_bf16 v[16:19], a[196:199], a[4:7], v[16:19]
    s_waitcnt lgkmcnt(8)
    ds_read_b64_tr_b16 a[134:135], v1 offset:34704
    ds_read_b128 a[208:211], v60 offset:36064
    v_cvt_pk_bf16_f32 v98, v20, v21
    v_cvt_pk_bf16_f32 v99, v22, v23
    v_mfma_f32_16x16x32_bf16 v[16:19], a[200:203], a[8:11], v[16:19]
    s_waitcnt lgkmcnt(9)
    ds_read_b128 a[212:215], v61 offset:37088
    ds_read_b64_tr_b16 a[136:137], v1 offset:33176
    v_exp_f32 v24, v24
    v_mfma_f32_16x16x32_bf16 v[16:19], a[204:207], a[12:15], v[16:19]
    s_waitcnt lgkmcnt(8)
    buffer_load_dwordx4 v[156:159], v0, s[16:19], s36 offen offset:1024 nt
    v_exp_f32 v25, v25
    v_mfma_f32_16x16x32_bf16 v[20:23], a[204:207], a[28:31], -4.0
    s_waitcnt lgkmcnt(7)
    v_exp_f32 v26, v26
    v_exp_f32 v27, v27
    v_mfma_f32_16x16x32_bf16 v[20:23], a[200:203], a[24:27], v[20:23]
    s_waitcnt lgkmcnt(6)
    ds_read_b128 a[216:219], v60 offset:38112
    v_exp_f32 v28, v28
    v_exp_f32 v29, v29
    v_mfma_f32_16x16x32_bf16 v[20:23], a[196:199], a[20:23], v[20:23]
    s_waitcnt lgkmcnt(6)
    v_exp_f32 v30, v30
    v_exp_f32 v31, v31
    v_mfma_f32_16x16x32_bf16 v[20:23], a[192:195], a[16:19], v[20:23]
    s_mov_b32 m0, s76
    ds_read_b128 a[220:223], v61 offset:39136
    v_cvt_pk_bf16_f32 v100, v24, v25
    v_cvt_pk_bf16_f32 v101, v26, v27
    v_cvt_pk_bf16_f32 v102, v28, v29
    v_cvt_pk_bf16_f32 v103, v30, v31
    v_mfma_f32_16x16x32_bf16 v[128:131], a[128:131], v[96:99], v[128:131]
    s_waitcnt lgkmcnt(5)
    ds_read_b64_tr_b16 a[138:139], v1 offset:33688
    buffer_load_dwordx4 v[172:175], v0, s[16:19], s36 offen offset:2048 nt
    ds_read_b64_tr_b16 a[140:141], v1 offset:34200
    v_mfma_f32_16x16x32_bf16 v[128:131], a[132:135], v[100:103], v[128:131]
L_hop1:
    s_cbranch_execz L_hop5
    ds_read_b64_tr_b16 a[142:143], v1 offset:34712
    ds_read_b64_tr_b16 a[144:145], v1 offset:33232
    ds_read_b64_tr_b16 a[146:147], v1 offset:33744
    v_lshlrev_b32 v45, 16, v201
    v_smfmac_f32_16x16x64_bf16 v[32:35], v[12:15], v[96:103], v57
    s_waitcnt lgkmcnt(9)
    ds_read_b64_tr_b16 a[148:149], v1 offset:34256
    ds_read_b64_tr_b16 a[150:151], v1 offset:34768
    v_mfma_f32_16x16x32_bf16 v[24:27], a[208:211], a[0:3], -4.0
    s_waitcnt lgkmcnt(10)
    buffer_load_dwordx4 v[188:191], v0, s[16:19], s36 offen offset:3072 nt
    ds_read_b128 a[224:227], v60 offset:40160
    ds_read_b64_tr_b16 a[152:153], v1 offset:33240
    v_mfma_f32_16x16x32_bf16 v[24:27], a[212:215], a[4:7], v[24:27]
    s_waitcnt lgkmcnt(10)
    ds_read_b128 a[228:231], v61 offset:41184
    ds_read_b64_tr_b16 a[154:155], v1 offset:33752
    v_exp_f32 v16, v16
    v_mfma_f32_16x16x32_bf16 v[24:27], a[216:219], a[8:11], v[24:27]
    s_waitcnt lgkmcnt(11)
    ds_read_b128 a[232:235], v60 offset:42208
    ds_read_b64_tr_b16 a[156:157], v1 offset:34264
    v_exp_f32 v17, v17
    v_mfma_f32_16x16x32_bf16 v[24:27], a[220:223], a[12:15], v[24:27]
    s_waitcnt lgkmcnt(12)
    buffer_load_dwordx4 v0, s[12:15], s42 offen offset:0 nt lds
    ds_read_b128 a[236:239], v61 offset:43232
    ds_read_b64_tr_b16 a[158:159], v1 offset:34776
    v_mfma_f32_16x16x32_bf16 v[144:147], a[136:139], v[96:99], v[144:147]
    s_waitcnt lgkmcnt(12)
    v_exp_f32 v18, v18
    v_cvt_pk_bf16_f32 v64, v16, v17
    v_mfma_f32_16x16x32_bf16 v[144:147], a[140:143], v[100:103], v[144:147]
    s_mov_b32 m0, s77
    ds_read_b64_tr_b16 a[164:165], v1 offset:34320
    ds_read_b64_tr_b16 a[166:167], v1 offset:34832
    v_exp_f32 v19, v19
    v_mfma_f32_16x16x32_bf16 v[28:31], a[208:211], a[16:19], -4.0
    buffer_load_dwordx4 v0, s[12:15], s42 offen offset:1024 nt lds
    ds_read_b64_tr_b16 a[160:161], v1 offset:33296
    v_cvt_pk_bf16_f32 v65, v18, v19
    v_mfma_f32_16x16x32_bf16 v[28:31], a[212:215], a[20:23], v[28:31]
    s_mov_b32 m0, s78
    ds_read_b64_tr_b16 a[162:163], v1 offset:33808
    ds_read_b64_tr_b16 a[168:169], v1 offset:33304
    ds_read_b64_tr_b16 a[170:171], v1 offset:33816
    v_lshlrev_b32 v46, 16, v202
    v_mfma_f32_16x16x32_bf16 v[28:31], a[216:219], a[24:27], v[28:31]
    v_exp_f32 v20, v20
    v_exp_f32 v21, v21
    v_mfma_f32_16x16x32_bf16 v[28:31], a[220:223], a[28:31], v[28:31]
    s_waitcnt lgkmcnt(14)
    buffer_load_dwordx4 v0, s[12:15], s42 offen offset:2048 nt lds
    ds_read_b64_tr_b16 a[172:173], v1 offset:34328
    v_exp_f32 v22, v22
    v_mfma_f32_16x16x32_bf16 v[160:163], a[144:147], v[96:99], v[160:163]
    s_waitcnt lgkmcnt(14)
    s_mov_b32 m0, s79
    ds_read_b64_tr_b16 a[174:175], v1 offset:34840
    v_exp_f32 v23, v23
    v_cvt_pk_bf16_f32 v72, v20, v21
    v_mfma_f32_16x16x32_bf16 v[160:163], a[148:151], v[100:103], v[160:163]
    s_waitcnt lgkmcnt(14)
    ds_read_b128 a[240:243], v60 offset:44256
    v_cvt_pk_bf16_f32 v73, v22, v23
    v_lshlrev_b32 v47, 16, v203
    v_and_b32 v200, s54, v200
    v_and_b32 v201, s54, v201
    v_and_b32 v202, s54, v202
    v_and_b32 v203, s54, v203
    v_pk_mul_f32 v[44:45], v[44:45], s[44:45] op_sel:[0,1] op_sel_hi:[1,1]
    v_pk_mul_f32 v[46:47], v[46:47], s[44:45] op_sel:[0,1] op_sel_hi:[1,1]
    v_pk_mul_f32 v[200:201], v[200:201], s[44:45] op_sel:[0,1] op_sel_hi:[1,1]
    v_pk_mul_f32 v[202:203], v[202:203], s[44:45] op_sel:[0,1] op_sel_hi:[1,1]
    v_mfma_f32_16x16x32_bf16 v[16:19], a[224:227], a[0:3], -4.0
    s_waitcnt lgkmcnt(14)
    buffer_load_dwordx4 v0, s[12:15], s42 offen offset:3072 nt lds
    ds_read_b128 a[244:247], v61 offset:45280
    v_cvt_pk_bf16_f32 v200, v44, v200
    v_mfma_f32_16x16x32_bf16 v[16:19], a[228:231], a[4:7], v[16:19]
    s_waitcnt lgkmcnt(13)
    ds_read_b128 a[248:251], v60 offset:46304
    v_cvt_pk_bf16_f32 v201, v45, v201
    v_cvt_pk_bf16_f32 v202, v46, v202
    v_cvt_pk_bf16_f32 v203, v47, v203
    v_mfma_f32_16x16x32_bf16 v[16:19], a[232:235], a[8:11], v[16:19]
    s_waitcnt vmcnt(14) lgkmcnt(12)
    ds_write_b128 v50, v[200:203] offset:48352
    v_lshlrev_b32 v4, 16, v216
    v_lshlrev_b32 v5, 16, v217
    v_lshlrev_b32 v6, 16, v218
    v_mfma_f32_16x16x32_bf16 v[16:19], a[236:239], a[12:15], v[16:19]
    s_mov_b32 m0, s97
    v_lshlrev_b32 v7, 16, v219
    v_and_b32 v216, s54, v216
    v_and_b32 v217, s54, v217
    v_and_b32 v218, s54, v218
    v_and_b32 v219, s54, v219
    v_pk_mul_f32 v[4:5], v[4:5], s[44:45] op_sel:[0,1] op_sel_hi:[1,1]
    v_pk_mul_f32 v[6:7], v[6:7], s[44:45] op_sel:[0,1] op_sel_hi:[1,1]
    v_pk_mul_f32 v[216:217], v[216:217], s[44:45] op_sel:[0,1] op_sel_hi:[1,1]
    v_pk_mul_f32 v[218:219], v[218:219], s[44:45] op_sel:[0,1] op_sel_hi:[1,1]
    v_cvt_pk_bf16_f32 v216, v4, v216
    v_cvt_pk_bf16_f32 v217, v5, v217
    v_mfma_f32_16x16x32_bf16 v[176:179], a[152:155], v[96:99], v[176:179]
    s_waitcnt vmcnt(13) lgkmcnt(12)
    v_cvt_pk_bf16_f32 v218, v6, v218
    v_cvt_pk_bf16_f32 v219, v7, v219
    v_lshlrev_b32 v44, 16, v232
    v_lshlrev_b32 v45, 16, v233
    v_mfma_f32_16x16x32_bf16 v[176:179], a[156:159], v[100:103], v[176:179]
    s_waitcnt lgkmcnt(10)
    ds_write_b128 v50, v[216:219] offset:56544
    v_lshlrev_b32 v46, 16, v234
    v_lshlrev_b32 v47, 16, v235
    v_and_b32 v232, s54, v232
    v_and_b32 v233, s54, v233
    v_and_b32 v234, s54, v234
    v_and_b32 v235, s54, v235
    v_pk_mul_f32 v[44:45], v[44:45], s[44:45] op_sel:[0,1] op_sel_hi:[1,1]
    v_pk_mul_f32 v[46:47], v[46:47], s[44:45] op_sel:[0,1] op_sel_hi:[1,1]
    v_pk_mul_f32 v[232:233], v[232:233], s[44:45] op_sel:[0,1] op_sel_hi:[1,1]
    v_pk_mul_f32 v[234:235], v[234:235], s[44:45] op_sel:[0,1] op_sel_hi:[1,1]
    v_mfma_f32_16x16x32_bf16 v[192:195], a[164:167], v[100:103], v[192:195]
    s_waitcnt lgkmcnt(9)
    v_cvt_pk_bf16_f32 v232, v44, v232
    v_cvt_pk_bf16_f32 v233, v45, v233
    v_cvt_pk_bf16_f32 v234, v46, v234
    v_cvt_pk_bf16_f32 v235, v47, v235
    v_mfma_f32_16x16x32_bf16 v[192:195], a[160:163], v[96:99], v[192:195]
    s_add_u32 s42, s42, 4096
    buffer_load_dwordx4 v0, s[20:23], s35 offen offset:0 nt lds
    ds_write_b128 v51, v[232:235] offset:48352
    v_mfma_f32_16x16x32_bf16 v[20:23], a[224:227], a[16:19], -4.0
    s_waitcnt vmcnt(13)
    v_lshlrev_b32 v4, 16, v248
    v_lshlrev_b32 v5, 16, v249
    v_lshlrev_b32 v6, 16, v250
    v_lshlrev_b32 v7, 16, v251
    v_and_b32 v248, s54, v248
    v_and_b32 v249, s54, v249
    v_and_b32 v250, s54, v250
    v_and_b32 v251, s54, v251
    v_pk_mul_f32 v[4:5], v[4:5], s[44:45] op_sel:[0,1] op_sel_hi:[1,1]
    v_pk_mul_f32 v[6:7], v[6:7], s[44:45] op_sel:[0,1] op_sel_hi:[1,1]
    v_pk_mul_f32 v[248:249], v[248:249], s[44:45] op_sel:[0,1] op_sel_hi:[1,1]
    v_pk_mul_f32 v[250:251], v[250:251], s[44:45] op_sel:[0,1] op_sel_hi:[1,1]
    v_mfma_f32_16x16x32_bf16 v[20:23], a[228:231], a[20:23], v[20:23]
    ds_read_b128 a[252:255], v61 offset:47328
    v_cvt_pk_bf16_f32 v248, v4, v248
    v_cvt_pk_bf16_f32 v249, v5, v249
    v_cvt_pk_bf16_f32 v250, v6, v250
    v_cvt_pk_bf16_f32 v251, v7, v251
    v_mfma_f32_16x16x32_bf16 v[20:23], a[232:235], a[24:27], v[20:23]
    ds_write_b128 v51, v[248:251] offset:56544
    buffer_load_dwordx4 v0, s[20:23], s35 offen offset:1024 nt lds
    ds_read_b64_tr_b16 a[176:177], v1 offset:33360
    v_mfma_f32_16x16x32_bf16 v[20:23], a[236:239], a[28:31], v[20:23]
    s_waitcnt lgkmcnt(11)
    ds_read_b64_tr_b16 a[178:179], v1 offset:33872
    v_exp_f32 v24, v24
    v_exp_f32 v25, v25
    v_mfma_f32_16x16x32_bf16 v[208:211], a[168:171], v[96:99], v[208:211]
    s_waitcnt lgkmcnt(10)
    ds_read_b64_tr_b16 a[180:181], v1 offset:34384
    ds_read_b64_tr_b16 a[182:183], v1 offset:34896
    v_exp_f32 v26, v26
    v_exp_f32 v27, v27
    v_mfma_f32_16x16x32_bf16 v[208:211], a[172:175], v[100:103], v[208:211]
    s_waitcnt lgkmcnt(11)
    ds_read_b64_tr_b16 a[184:185], v1 offset:33368
    v_cvt_pk_bf16_f32 v66, v24, v25
    v_cvt_pk_bf16_f32 v67, v26, v27
    v_mfma_f32_16x16x32_bf16 v[24:27], a[240:243], a[0:3], -4.0
    s_waitcnt lgkmcnt(11)
    buffer_load_dwordx4 v0, s[28:31], s35 offen offset:2056 nt lds
    ds_read_b64_tr_b16 a[186:187], v1 offset:33880
    v_mfma_f32_16x16x32_bf16 v[24:27], a[244:247], a[4:7], v[24:27]
    s_waitcnt lgkmcnt(11)
    ds_read_b64_tr_b16 a[188:189], v1 offset:34392
    v_exp_f32 v28, v28
    v_mfma_f32_16x16x32_bf16 v[24:27], a[248:251], a[8:11], v[24:27]
    s_waitcnt vmcnt(11) lgkmcnt(5)
    ds_read_b64_tr_b16 a[190:191], v1 offset:34904
    v_exp_f32 v29, v29
    v_mfma_f32_16x16x32_bf16 v[24:27], a[252:255], a[12:15], v[24:27]
    s_barrier
    buffer_load_dwordx4 v0, s[28:31], s35 offen offset:3080 nt lds
    v_cvt_pk_bf16_f32 v74, v28, v29
    v_mfma_f32_16x16x32_bf16 v[224:227], a[176:179], v[96:99], v[224:227]
    s_waitcnt lgkmcnt(4)
    v_exp_f32 v30, v30
    v_exp_f32 v31, v31
    v_mfma_f32_16x16x32_bf16 v[224:227], a[180:183], v[100:103], v[224:227]
    s_mov_b32 m0, s99
    ds_read_b128 a[192:195], v60 offset:48352
    v_cvt_pk_bf16_f32 v75, v30, v31
    v_exp_f32 v16, v16
    v_mfma_f32_16x16x32_bf16 v[28:31], a[240:243], a[16:19], -4.0
    ds_read_b128 a[196:199], v61 offset:49376
    v_exp_f32 v17, v17
    v_mfma_f32_16x16x32_bf16 v[28:31], a[244:247], a[20:23], v[28:31]
    ds_read_b128 a[200:203], v60 offset:50400
    v_exp_f32 v18, v18
    v_mfma_f32_16x16x32_bf16 v[28:31], a[248:251], a[24:27], v[28:31]
    ds_read_b128 a[204:207], v61 offset:51424
    v_exp_f32 v19, v19
    v_mfma_f32_16x16x32_bf16 v[28:31], a[252:255], a[28:31], v[28:31]
    s_waitcnt lgkmcnt(6)
    ds_read_b64_tr_b16 a[128:129], v1 offset:0
    v_cvt_pk_bf16_f32 v68, v16, v17
    v_cvt_pk_bf16_f32 v69, v18, v19
    v_mfma_f32_16x16x32_bf16 v[240:243], a[184:187], v[96:99], v[240:243]
    s_waitcnt lgkmcnt(5)
    ds_read_b64_tr_b16 a[130:131], v1 offset:512
    v_exp_f32 v20, v20
    v_mfma_f32_16x16x32_bf16 v[240:243], a[188:191], v[100:103], v[240:243]
    s_waitcnt lgkmcnt(5)
    buffer_load_dwordx4 v[204:207], v0, s[16:19], s37 offen offset:0 nt
    ds_read_b64_tr_b16 a[132:133], v1 offset:1024
    v_mfma_f32_16x16x32_bf16 v[16:19], a[192:195], a[0:3], -4.0
    s_waitcnt lgkmcnt(5)
    v_exp_f32 v21, v21
    v_exp_f32 v22, v22
    v_mfma_f32_16x16x32_bf16 v[16:19], a[196:199], a[4:7], v[16:19]
    s_waitcnt lgkmcnt(4)
    v_exp_f32 v23, v23
    v_cvt_pk_bf16_f32 v76, v20, v21
    v_mfma_f32_16x16x32_bf16 v[16:19], a[200:203], a[8:11], v[16:19]
    s_waitcnt lgkmcnt(3)
    buffer_load_dwordx4 v[220:223], v0, s[16:19], s37 offen offset:1024 nt
    ds_read_b64_tr_b16 a[134:135], v1 offset:1536
    v_cvt_pk_bf16_f32 v77, v22, v23
    v_mfma_f32_16x16x32_bf16 v[16:19], a[204:207], a[12:15], v[16:19]
    ds_read_b64_tr_b16 a[136:137], v1 offset:8
    v_exp_f32 v24, v24
    v_mfma_f32_16x16x32_bf16 v[20:23], a[204:207], a[28:31], -4.0
    v_exp_f32 v25, v25
    v_exp_f32 v26, v26
    v_mfma_f32_16x16x32_bf16 v[20:23], a[200:203], a[24:27], v[20:23]
    buffer_load_dwordx4 v[236:239], v0, s[16:19], s37 offen offset:2048 nt
    v_exp_f32 v27, v27
    v_mfma_f32_16x16x32_bf16 v[20:23], a[196:199], a[20:23], v[20:23]
    ds_read_b64_tr_b16 a[138:139], v1 offset:520
    ds_read_b64_tr_b16 a[140:141], v1 offset:1032
    v_cvt_pk_bf16_f32 v70, v24, v25
    v_cvt_pk_bf16_f32 v71, v26, v27
    v_mfma_f32_16x16x32_bf16 v[20:23], a[192:195], a[16:19], v[20:23]
    ds_read_b64_tr_b16 a[142:143], v1 offset:1544
    v_exp_f32 v28, v28
    v_exp_f32 v29, v29
    v_smfmac_f32_16x16x64_bf16 v[32:35], v[12:15], v[64:71], v57
    s_waitcnt lgkmcnt(6)
    v_exp_f32 v30, v30
    v_exp_f32 v31, v31
    v_mfma_f32_16x16x32_bf16 v[128:131], a[128:131], v[64:67], v[128:131]
    s_waitcnt lgkmcnt(4)
    v_cvt_pk_bf16_f32 v78, v28, v29
    v_cvt_pk_bf16_f32 v79, v30, v31
    v_mfma_f32_16x16x32_bf16 v[128:131], a[132:135], v[68:71], v[128:131]
    ds_read_b128 a[208:211], v60 offset:52448
    buffer_load_dwordx4 v[252:255], v0, s[16:19], s37 offen offset:3072 nt
    v_mfma_f32_16x16x32_bf16 v[132:135], a[132:135], v[76:79], 0
    ds_read_b128 a[212:215], v61 offset:53472
    v_exp_f32 v16, v16
    v_mfma_f32_16x16x32_bf16 v[132:135], a[128:131], v[72:75], v[132:135]
    s_waitcnt lgkmcnt(4)
    ds_read_b128 a[216:219], v60 offset:54496
    v_exp_f32 v17, v17
    v_mfma_f32_16x16x32_bf16 v[148:151], a[136:139], v[72:75], 0
    s_waitcnt lgkmcnt(3)
    ds_read_b128 a[220:223], v61 offset:55520
    v_cvt_pk_bf16_f32 v96, v16, v17
    v_mfma_f32_16x16x32_bf16 v[148:151], a[140:143], v[76:79], v[148:151]
    s_waitcnt vmcnt(15)
    ds_read_b64_tr_b16 a[144:145], v1 offset:64
    ds_read_b64_tr_b16 a[146:147], v1 offset:576
    v_lshlrev_b32 v44, 16, v140
    v_mfma_f32_16x16x32_bf16 v[144:147], a[140:143], v[68:71], v[144:147]
    ds_read_b64_tr_b16 a[148:149], v1 offset:1088
    ds_read_b64_tr_b16 a[150:151], v1 offset:1600
    v_lshlrev_b32 v45, 16, v141
    v_mfma_f32_16x16x32_bf16 v[144:147], a[136:139], v[64:67], v[144:147]
    s_waitcnt lgkmcnt(7)
    ds_read_b64_tr_b16 a[152:153], v1 offset:72
    ds_read_b64_tr_b16 a[154:155], v1 offset:584
    v_lshlrev_b32 v46, 16, v142
    v_mfma_f32_16x16x32_bf16 v[24:27], a[208:211], a[0:3], -4.0
    s_waitcnt lgkmcnt(8)
    ds_read_b64_tr_b16 a[156:157], v1 offset:1096
    ds_read_b64_tr_b16 a[158:159], v1 offset:1608
    v_mfma_f32_16x16x32_bf16 v[24:27], a[212:215], a[4:7], v[24:27]
    s_waitcnt lgkmcnt(9)
    ds_read_b128 a[224:227], v60 offset:56544
    v_exp_f32 v18, v18
    v_mfma_f32_16x16x32_bf16 v[24:27], a[216:219], a[8:11], v[24:27]
    s_waitcnt lgkmcnt(9)
    ds_read_b128 a[228:231], v61 offset:57568
    v_exp_f32 v19, v19
    v_mfma_f32_16x16x32_bf16 v[24:27], a[220:223], a[12:15], v[24:27]
    ds_read_b128 a[232:235], v60 offset:58592
    v_cvt_pk_bf16_f32 v97, v18, v19
    v_mfma_f32_16x16x32_bf16 v[28:31], a[220:223], a[28:31], -4.0
    ds_read_b128 a[236:239], v61 offset:59616
    v_exp_f32 v20, v20
    v_mfma_f32_16x16x32_bf16 v[28:31], a[216:219], a[24:27], v[28:31]
    ds_read_b64_tr_b16 a[160:161], v1 offset:128
    v_exp_f32 v21, v21
    v_mfma_f32_16x16x32_bf16 v[28:31], a[212:215], a[20:23], v[28:31]
    ds_read_b64_tr_b16 a[162:163], v1 offset:640
    v_exp_f32 v22, v22
    v_mfma_f32_16x16x32_bf16 v[28:31], a[208:211], a[16:19], v[28:31]
    s_waitcnt lgkmcnt(12)
    v_exp_f32 v23, v23
    v_mfma_f32_16x16x32_bf16 v[160:163], a[144:147], v[64:67], v[160:163]
    s_waitcnt lgkmcnt(10)
    ds_read_b64_tr_b16 a[164:165], v1 offset:1152
    v_cvt_pk_bf16_f32 v104, v20, v21
    v_cvt_pk_bf16_f32 v105, v22, v23
    v_mfma_f32_16x16x32_bf16 v[160:163], a[148:151], v[68:71], v[160:163]
    buffer_load_dwordx4 v0, s[20:23], s36 offen offset:0 nt lds
    ds_read_b64_tr_b16 a[166:167], v1 offset:1664
    v_mfma_f32_16x16x32_bf16 v[164:167], a[148:151], v[76:79], 0
    ds_read_b64_tr_b16 a[168:169], v1 offset:136
    ds_read_b64_tr_b16 a[170:171], v1 offset:648
    v_add_u32 v50, 64736, v50
    v_mfma_f32_16x16x32_bf16 v[164:167], a[144:147], v[72:75], v[164:167]
    s_waitcnt vmcnt(15) lgkmcnt(12)
    ds_read_b64_tr_b16 a[172:173], v1 offset:1160
    ds_read_b64_tr_b16 a[174:175], v1 offset:1672
    v_lshlrev_b32 v4, 16, v156
    v_mfma_f32_16x16x32_bf16 v[180:183], a[152:155], v[72:75], 0
    s_waitcnt lgkmcnt(12)
    ds_read_b128 a[240:243], v60 offset:60640
    v_lshlrev_b32 v5, 16, v157
    v_mfma_f32_16x16x32_bf16 v[180:183], a[156:159], v[76:79], v[180:183]
    buffer_load_dwordx4 v0, s[20:23], s36 offen offset:1024 nt lds
    ds_read_b128 a[244:247], v61 offset:61664
    v_mfma_f32_16x16x32_bf16 v[176:179], a[156:159], v[68:71], v[176:179]
    ds_read_b128 a[248:251], v60 offset:62688
    v_lshlrev_b32 v47, 16, v143
    v_and_b32 v140, s54, v140
    v_and_b32 v141, s54, v141
    v_and_b32 v142, s54, v142
    v_and_b32 v143, s54, v143
    v_pk_mul_f32 v[44:45], v[44:45], s[44:45] op_sel:[0,1] op_sel_hi:[1,1]
    v_pk_mul_f32 v[46:47], v[46:47], s[44:45] op_sel:[0,1] op_sel_hi:[1,1]
    v_pk_mul_f32 v[140:141], v[140:141], s[44:45] op_sel:[0,1] op_sel_hi:[1,1]
    v_pk_mul_f32 v[142:143], v[142:143], s[44:45] op_sel:[0,1] op_sel_hi:[1,1]
    v_mfma_f32_16x16x32_bf16 v[176:179], a[152:155], v[64:67], v[176:179]
    s_waitcnt lgkmcnt(14)
    v_cvt_pk_bf16_f32 v140, v44, v140
    v_cvt_pk_bf16_f32 v141, v45, v141
    v_cvt_pk_bf16_f32 v142, v46, v142
    v_mfma_f32_16x16x32_bf16 v[16:19], a[224:227], a[0:3], -4.0
    s_waitcnt vmcnt(15) lgkmcnt(13)
    v_cvt_pk_bf16_f32 v143, v47, v143
    v_lshlrev_b32 v6, 16, v158
    v_lshlrev_b32 v44, 16, v172
    v_mfma_f32_16x16x32_bf16 v[16:19], a[228:231], a[4:7], v[16:19]
    s_waitcnt lgkmcnt(12)
    buffer_load_dwordx4 v0, s[28:31], s36 offen offset:2056 nt lds
    v_lshlrev_b32 v45, 16, v173
    v_mfma_f32_16x16x32_bf16 v[16:19], a[232:235], a[8:11], v[16:19]
    s_waitcnt lgkmcnt(11)
    ds_write_b128 v50, v[140:143] offset:0
    v_lshlrev_b32 v46, 16, v174
    v_mfma_f32_16x16x32_bf16 v[16:19], a[236:239], a[12:15], v[16:19]
    v_lshlrev_b32 v7, 16, v159
    v_and_b32 v156, s54, v156
    v_and_b32 v157, s54, v157
    v_and_b32 v158, s54, v158
    v_and_b32 v159, s54, v159
    v_pk_mul_f32 v[4:5], v[4:5], s[44:45] op_sel:[0,1] op_sel_hi:[1,1]
    v_pk_mul_f32 v[6:7], v[6:7], s[44:45] op_sel:[0,1] op_sel_hi:[1,1]
    v_pk_mul_f32 v[156:157], v[156:157], s[44:45] op_sel:[0,1] op_sel_hi:[1,1]
    v_pk_mul_f32 v[158:159], v[158:159], s[44:45] op_sel:[0,1] op_sel_hi:[1,1]
    v_cvt_pk_bf16_f32 v156, v4, v156
    v_mfma_f32_16x16x32_bf16 v[20:23], a[236:239], a[28:31], -4.0
    v_cvt_pk_bf16_f32 v157, v5, v157
    v_cvt_pk_bf16_f32 v158, v6, v158
    v_cvt_pk_bf16_f32 v159, v7, v159
    v_mfma_f32_16x16x32_bf16 v[20:23], a[232:235], a[24:27], v[20:23]
    buffer_load_dwordx4 v0, s[28:31], s36 offen offset:3080 nt lds
    v_add_u32 v51, 64736, v51
    v_mfma_f32_16x16x32_bf16 v[20:23], a[228:231], a[20:23], v[20:23]
    s_waitcnt vmcnt(16)
    ds_write_b128 v50, v[156:159] offset:8192
    v_lshlrev_b32 v4, 16, v188
    v_mfma_f32_16x16x32_bf16 v[20:23], a[224:227], a[16:19], v[20:23]
    v_lshlrev_b32 v47, 16, v175
    v_and_b32 v172, s54, v172
    v_and_b32 v173, s54, v173
    v_and_b32 v174, s54, v174
    v_and_b32 v175, s54, v175
    v_pk_mul_f32 v[44:45], v[44:45], s[44:45] op_sel:[0,1] op_sel_hi:[1,1]
    v_pk_mul_f32 v[46:47], v[46:47], s[44:45] op_sel:[0,1] op_sel_hi:[1,1]
    v_pk_mul_f32 v[172:173], v[172:173], s[44:45] op_sel:[0,1] op_sel_hi:[1,1]
    v_pk_mul_f32 v[174:175], v[174:175], s[44:45] op_sel:[0,1] op_sel_hi:[1,1]
    v_cvt_pk_bf16_f32 v172, v44, v172
    v_smfmac_f32_16x16x64_bf16 v[36:39], v[12:15], v[72:79], v57
    s_waitcnt lgkmcnt(11)
    v_cvt_pk_bf16_f32 v173, v45, v173
    v_cvt_pk_bf16_f32 v174, v46, v174
    v_mfma_f32_16x16x32_bf16 v[196:199], a[160:163], v[72:75], 0
    s_waitcnt lgkmcnt(9)
    ds_read_b128 a[252:255], v61 offset:63712
    v_cvt_pk_bf16_f32 v175, v47, v175
    v_lshlrev_b32 v5, 16, v189
    v_lshlrev_b32 v6, 16, v190
    v_mfma_f32_16x16x32_bf16 v[196:199], a[164:167], v[76:79], v[196:199]
    s_mov_b32 m0, s98
    ds_write_b128 v51, v[172:175] offset:0
    ds_read_b64_tr_b16 a[176:177], v1 offset:192
    v_mfma_f32_16x16x32_bf16 v[192:195], a[164:167], v[68:71], v[192:195]
    v_lshlrev_b32 v7, 16, v191
    v_and_b32 v188, s54, v188
    v_and_b32 v189, s54, v189
    v_and_b32 v190, s54, v190
    v_and_b32 v191, s54, v191
    v_pk_mul_f32 v[4:5], v[4:5], s[44:45] op_sel:[0,1] op_sel_hi:[1,1]
    v_pk_mul_f32 v[6:7], v[6:7], s[44:45] op_sel:[0,1] op_sel_hi:[1,1]
    v_pk_mul_f32 v[188:189], v[188:189], s[44:45] op_sel:[0,1] op_sel_hi:[1,1]
    v_pk_mul_f32 v[190:191], v[190:191], s[44:45] op_sel:[0,1] op_sel_hi:[1,1]
    v_cvt_pk_bf16_f32 v188, v4, v188
    v_mfma_f32_16x16x32_bf16 v[192:195], a[160:163], v[64:67], v[192:195]
    s_waitcnt lgkmcnt(10)
    v_cvt_pk_bf16_f32 v189, v5, v189
    v_cvt_pk_bf16_f32 v190, v6, v190
    v_cvt_pk_bf16_f32 v191, v7, v191
    v_mfma_f32_16x16x32_bf16 v[208:211], a[168:171], v[64:67], v[208:211]
    s_waitcnt lgkmcnt(8)
    ds_write_b128 v51, v[188:191] offset:8192
    v_exp_f32 v24, v24
    v_mfma_f32_16x16x32_bf16 v[208:211], a[172:175], v[68:71], v[208:211]
    ds_read_b64_tr_b16 a[178:179], v1 offset:704
    v_exp_f32 v25, v25
    v_mfma_f32_16x16x32_bf16 v[212:215], a[172:175], v[76:79], 0
    v_exp_f32 v26, v26
    v_exp_f32 v27, v27
    v_mfma_f32_16x16x32_bf16 v[212:215], a[168:171], v[72:75], v[212:215]
    s_waitcnt lgkmcnt(9)
    ds_read_b64_tr_b16 a[180:181], v1 offset:1216
    v_cvt_pk_bf16_f32 v98, v24, v25
    v_cvt_pk_bf16_f32 v99, v26, v27
    v_mfma_f32_16x16x32_bf16 v[24:27], a[240:243], a[0:3], -4.0
    s_waitcnt lgkmcnt(9)
    ds_read_b64_tr_b16 a[182:183], v1 offset:1728
    v_exp_f32 v28, v28
    v_mfma_f32_16x16x32_bf16 v[24:27], a[244:247], a[4:7], v[24:27]
    s_waitcnt lgkmcnt(9)
    ds_read_b64_tr_b16 a[184:185], v1 offset:200
    v_exp_f32 v29, v29
    v_mfma_f32_16x16x32_bf16 v[24:27], a[248:251], a[8:11], v[24:27]
    s_waitcnt vmcnt(8) lgkmcnt(4)
    v_exp_f32 v30, v30
    v_exp_f32 v31, v31
    v_mfma_f32_16x16x32_bf16 v[24:27], a[252:255], a[12:15], v[24:27]
    s_barrier
    v_cvt_pk_bf16_f32 v106, v28, v29
    v_cvt_pk_bf16_f32 v107, v30, v31
    v_mfma_f32_16x16x32_bf16 v[28:31], a[252:255], a[28:31], -4.0
    buffer_load_dwordx4 v0, s[20:23], s37 offen offset:0 lds
    ds_read_b64_tr_b16 a[186:187], v1 offset:712
    v_mfma_f32_16x16x32_bf16 v[28:31], a[248:251], a[24:27], v[28:31]
    ds_read_b64_tr_b16 a[188:189], v1 offset:1224
    ds_read_b64_tr_b16 a[190:191], v1 offset:1736
    v_mfma_f32_16x16x32_bf16 v[28:31], a[244:247], a[20:23], v[28:31]
    ds_read_b128 a[192:195], v62 offset:0
    v_exp_f32 v16, v16
    v_mfma_f32_16x16x32_bf16 v[28:31], a[240:243], a[16:19], v[28:31]
    s_waitcnt lgkmcnt(7)
    ds_read_b128 a[196:199], v63 offset:1024
    v_exp_f32 v17, v17
    v_mfma_f32_16x16x32_bf16 v[224:227], a[176:179], v[64:67], v[224:227]
    s_waitcnt lgkmcnt(6)
    buffer_load_dwordx4 v0, s[20:23], s37 offen offset:1024 lds
    v_mfma_f32_16x16x32_bf16 v[224:227], a[180:183], v[68:71], v[224:227]
    ds_read_b128 a[200:203], v62 offset:2048
    v_exp_f32 v18, v18
    v_mfma_f32_16x16x32_bf16 v[228:231], a[180:183], v[76:79], 0
    ds_read_b128 a[204:207], v63 offset:3072
    v_exp_f32 v19, v19
    v_mfma_f32_16x16x32_bf16 v[228:231], a[176:179], v[72:75], v[228:231]
    s_waitcnt lgkmcnt(6)
    v_cvt_pk_bf16_f32 v100, v16, v17
    v_cvt_pk_bf16_f32 v101, v18, v19
    v_mfma_f32_16x16x32_bf16 v[244:247], a[184:187], v[72:75], 0
    s_waitcnt lgkmcnt(4)
    buffer_load_dwordx4 v0, s[28:31], s37 offen offset:2056 lds
    ds_read_b128 a[32:35], v3 offset:0
    v_mfma_f32_16x16x32_bf16 v[244:247], a[188:191], v[76:79], v[244:247]
    ds_read_b128 a[36:39], v3 offset:64
    v_exp_f32 v20, v20
    v_mfma_f32_16x16x32_bf16 v[240:243], a[188:191], v[68:71], v[240:243]
    v_exp_f32 v21, v21
    v_mfma_f32_16x16x32_bf16 v[240:243], a[184:187], v[64:67], v[240:243]
    s_waitcnt lgkmcnt(5)
    v_exp_f32 v22, v22
    v_cvt_pk_bf16_f32 v108, v20, v21
    v_mfma_f32_16x16x32_bf16 v[16:19], a[192:195], a[0:3], -4.0
    s_waitcnt lgkmcnt(4)
    buffer_load_dwordx4 v0, s[28:31], s37 offen offset:3080 lds
    v_mfma_f32_16x16x32_bf16 v[16:19], a[196:199], a[4:7], v[16:19]
    s_waitcnt lgkmcnt(3)
    ds_read_b128 a[40:43], v3 offset:128
    v_exp_f32 v23, v23
    v_mfma_f32_16x16x32_bf16 v[16:19], a[200:203], a[8:11], v[16:19]
    s_waitcnt vmcnt(11) lgkmcnt(3)
    ds_read_b128 a[44:47], v3 offset:192
    v_cvt_pk_bf16_f32 v109, v22, v23
    v_lshlrev_b32 v44, 16, v204
    v_mfma_f32_16x16x32_bf16 v[16:19], a[204:207], a[12:15], v[16:19]
    s_mov_b32 m0, s76
    ds_read_b64_tr_b16 a[128:129], v1 offset:16584
    v_exp_f32 v24, v24
    v_mfma_f32_16x16x32_bf16 v[20:23], a[204:207], a[28:31], -4.0
    buffer_load_dwordx4 v[88:91], v0, s[16:19], s38 offen offset:0 nt
    v_mfma_f32_16x16x32_bf16 v[20:23], a[200:203], a[24:27], v[20:23]
    v_exp_f32 v25, v25
    v_exp_f32 v26, v26
    v_mfma_f32_16x16x32_bf16 v[20:23], a[196:199], a[20:23], v[20:23]
    ds_read_b64_tr_b16 a[130:131], v1 offset:17096
    v_exp_f32 v27, v27
    v_cvt_pk_bf16_f32 v102, v24, v25
    v_mfma_f32_16x16x32_bf16 v[20:23], a[192:195], a[16:19], v[20:23]
    s_waitcnt lgkmcnt(5)
    ds_read_b64_tr_b16 a[132:133], v1 offset:17608
    ds_read_b64_tr_b16 a[134:135], v1 offset:18120
    v_cvt_pk_bf16_f32 v103, v26, v27
    v_mfma_f32_16x16x32_bf16 v[24:27], a[192:195], a[32:35], -4.0
    s_waitcnt lgkmcnt(6)
    buffer_load_dwordx4 v[92:95], v0, s[16:19], s38 offen offset:1024 nt
    v_mfma_f32_16x16x32_bf16 v[24:27], a[196:199], a[36:39], v[24:27]
    s_waitcnt lgkmcnt(5)
    ds_read_b64_tr_b16 a[136:137], v1 offset:16592
    ds_read_b64_tr_b16 a[138:139], v1 offset:17104
    v_lshlrev_b32 v45, 16, v205
    v_mfma_f32_16x16x32_bf16 v[24:27], a[200:203], a[40:43], v[24:27]
    s_waitcnt lgkmcnt(6)
    ds_read_b64_tr_b16 a[140:141], v1 offset:17616
    ds_read_b64_tr_b16 a[142:143], v1 offset:18128
    v_exp_f32 v28, v28
    v_mfma_f32_16x16x32_bf16 v[24:27], a[204:207], a[44:47], v[24:27]
    ds_read_b128 a[208:211], v62 offset:4096
    v_exp_f32 v29, v29
    v_smfmac_f32_16x16x64_bf16 v[32:35], v[12:15], v[96:103], v57
    s_waitcnt lgkmcnt(7)
    v_exp_f32 v30, v30
    v_exp_f32 v31, v31
    v_mfma_f32_16x16x32_bf16 v[128:131], a[128:131], v[96:99], v[128:131]
    s_waitcnt lgkmcnt(5)
    v_cvt_pk_bf16_f32 v110, v28, v29
    v_cvt_pk_bf16_f32 v111, v30, v31
    v_mfma_f32_16x16x32_bf16 v[128:131], a[132:135], v[100:103], v[128:131]
    buffer_load_dwordx4 v[120:123], v0, s[16:19], s38 offen offset:2048 nt
    ds_read_b128 a[212:215], v63 offset:5120
    v_mfma_f32_16x16x32_bf16 v[132:135], a[132:135], v[108:111], v[132:135]
    ds_read_b128 a[216:219], v62 offset:6144
    v_exp_f32 v16, v16
    v_mfma_f32_16x16x32_bf16 v[132:135], a[128:131], v[104:107], v[132:135]
    s_waitcnt lgkmcnt(5)
    ds_read_b128 a[220:223], v63 offset:7168
    v_lshlrev_b32 v46, 16, v206
    v_mfma_f32_16x16x32_bf16 v[148:151], a[136:139], v[104:107], v[148:151]
    s_waitcnt lgkmcnt(4)
    ds_read_b64_tr_b16 a[144:145], v1 offset:16648
    v_exp_f32 v17, v17
    v_mfma_f32_16x16x32_bf16 v[148:151], a[140:143], v[108:111], v[148:151]
    buffer_load_dwordx4 v[124:127], v0, s[16:19], s38 offen offset:3072 nt
    v_cvt_pk_bf16_f32 v64, v16, v17
    v_mfma_f32_16x16x32_bf16 v[144:147], a[140:143], v[100:103], v[144:147]
    ds_read_b64_tr_b16 a[146:147], v1 offset:17160
    v_exp_f32 v18, v18
    v_mfma_f32_16x16x32_bf16 v[144:147], a[136:139], v[96:99], v[144:147]
    s_waitcnt lgkmcnt(5)
    v_exp_f32 v19, v19
    v_mfma_f32_16x16x32_bf16 v[28:31], a[208:211], a[0:3], -4.0
    s_waitcnt lgkmcnt(4)
    v_cvt_pk_bf16_f32 v65, v18, v19
    v_exp_f32 v20, v20
    v_mfma_f32_16x16x32_bf16 v[28:31], a[212:215], a[4:7], v[28:31]
    s_waitcnt lgkmcnt(3)
    buffer_load_dwordx4 v0, s[12:15], s42 offen offset:0 nt lds
    ds_read_b64_tr_b16 a[148:149], v1 offset:17672
    v_mfma_f32_16x16x32_bf16 v[28:31], a[216:219], a[8:11], v[28:31]
    s_waitcnt lgkmcnt(3)
    ds_read_b64_tr_b16 a[150:151], v1 offset:18184
    v_exp_f32 v21, v21
    v_mfma_f32_16x16x32_bf16 v[28:31], a[220:223], a[12:15], v[28:31]
    s_mov_b32 m0, s77
    v_exp_f32 v22, v22
    v_mfma_f32_16x16x32_bf16 v[16:19], a[220:223], a[28:31], -4.0
    v_exp_f32 v23, v23
    v_cvt_pk_bf16_f32 v72, v20, v21
    v_mfma_f32_16x16x32_bf16 v[16:19], a[216:219], a[24:27], v[16:19]
    buffer_load_dwordx4 v0, s[12:15], s42 offen offset:1024 nt lds
    v_cvt_pk_bf16_f32 v73, v22, v23
    v_mfma_f32_16x16x32_bf16 v[16:19], a[212:215], a[20:23], v[16:19]
    s_waitcnt vmcnt(16)
    ds_read_b64_tr_b16 a[152:153], v1 offset:16656
    ds_read_b64_tr_b16 a[154:155], v1 offset:17168
    v_lshlrev_b32 v4, 16, v220
    v_mfma_f32_16x16x32_bf16 v[16:19], a[208:211], a[16:19], v[16:19]
    s_mov_b32 m0, s78
    ds_read_b64_tr_b16 a[156:157], v1 offset:17680
    ds_read_b64_tr_b16 a[158:159], v1 offset:18192
    v_lshlrev_b32 v5, 16, v221
    v_mfma_f32_16x16x32_bf16 v[20:23], a[208:211], a[32:35], -4.0
    ds_read_b128 a[224:227], v62 offset:8192
    v_exp_f32 v24, v24
    v_mfma_f32_16x16x32_bf16 v[20:23], a[212:215], a[36:39], v[20:23]
    buffer_load_dwordx4 v0, s[12:15], s42 offen offset:2048 nt lds
    v_mfma_f32_16x16x32_bf16 v[20:23], a[216:219], a[40:43], v[20:23]
    s_mov_b32 m0, s79
    ds_read_b128 a[228:231], v63 offset:9216
    v_exp_f32 v25, v25
    v_mfma_f32_16x16x32_bf16 v[20:23], a[220:223], a[44:47], v[20:23]
    s_waitcnt lgkmcnt(8)
    ds_read_b128 a[232:235], v62 offset:10240
    v_exp_f32 v26, v26
    v_mfma_f32_16x16x32_bf16 v[160:163], a[144:147], v[96:99], v[160:163]
    s_waitcnt lgkmcnt(7)
    ds_read_b128 a[236:239], v63 offset:11264
    v_exp_f32 v27, v27
    v_mfma_f32_16x16x32_bf16 v[160:163], a[148:151], v[100:103], v[160:163]
    buffer_load_dwordx4 v0, s[12:15], s42 offen offset:3072 nt lds
    v_cvt_pk_bf16_f32 v80, v24, v25
    v_mfma_f32_16x16x32_bf16 v[164:167], a[148:151], v[108:111], v[164:167]
L_hop2:
    s_cbranch_execz L_hop6
    v_cvt_pk_bf16_f32 v81, v26, v27
    v_exp_f32 v28, v28
    v_mfma_f32_16x16x32_bf16 v[164:167], a[144:147], v[104:107], v[164:167]
    s_waitcnt lgkmcnt(6)
    ds_read_b64_tr_b16 a[160:161], v1 offset:16712
    v_exp_f32 v29, v29
    v_mfma_f32_16x16x32_bf16 v[180:183], a[152:155], v[104:107], v[180:183]
    s_waitcnt lgkmcnt(5)
    v_exp_f32 v30, v30
    v_cvt_pk_bf16_f32 v66, v28, v29
    v_mfma_f32_16x16x32_bf16 v[180:183], a[156:159], v[108:111], v[180:183]
    s_add_u32 s42, s42, 4096
    ds_read_b64_tr_b16 a[162:163], v1 offset:17224
    v_exp_f32 v31, v31
    v_mfma_f32_16x16x32_bf16 v[176:179], a[156:159], v[100:103], v[176:179]
    v_cvt_pk_bf16_f32 v67, v30, v31
    v_exp_f32 v16, v16
    v_mfma_f32_16x16x32_bf16 v[176:179], a[152:155], v[96:99], v[176:179]
    s_waitcnt lgkmcnt(5)
    ds_read_b64_tr_b16 a[164:165], v1 offset:17736
    v_exp_f32 v17, v17
    v_mfma_f32_16x16x32_bf16 v[24:27], a[224:227], a[0:3], -4.0
    s_waitcnt lgkmcnt(5)
    v_exp_f32 v18, v18
    v_cvt_pk_bf16_f32 v74, v16, v17
    v_mfma_f32_16x16x32_bf16 v[24:27], a[228:231], a[4:7], v[24:27]
    s_waitcnt lgkmcnt(4)
    v_exp_f32 v19, v19
    v_mfma_f32_16x16x32_bf16 v[24:27], a[232:235], a[8:11], v[24:27]
    s_waitcnt lgkmcnt(3)
    ds_read_b64_tr_b16 a[166:167], v1 offset:18248
    ds_read_b64_tr_b16 a[168:169], v1 offset:16720
    v_cvt_pk_bf16_f32 v75, v18, v19
    v_mfma_f32_16x16x32_bf16 v[24:27], a[236:239], a[12:15], v[24:27]
    s_mov_b32 m0, s99
    ds_read_b64_tr_b16 a[170:171], v1 offset:17232
    ds_read_b64_tr_b16 a[172:173], v1 offset:17744
    v_lshlrev_b32 v6, 16, v222
    v_mfma_f32_16x16x32_bf16 v[28:31], a[236:239], a[28:31], -4.0
    ds_read_b64_tr_b16 a[174:175], v1 offset:18256
    v_exp_f32 v20, v20
    v_mfma_f32_16x16x32_bf16 v[28:31], a[232:235], a[24:27], v[28:31]
    ds_read_b128 a[240:243], v62 offset:12288
    v_exp_f32 v21, v21
    v_mfma_f32_16x16x32_bf16 v[28:31], a[228:231], a[20:23], v[28:31]
    ds_read_b128 a[244:247], v63 offset:13312
    v_exp_f32 v22, v22
    v_mfma_f32_16x16x32_bf16 v[28:31], a[224:227], a[16:19], v[28:31]
    ds_read_b128 a[248:251], v62 offset:14336
    v_exp_f32 v23, v23
    v_mfma_f32_16x16x32_bf16 v[16:19], a[224:227], a[32:35], -4.0
    ds_read_b128 a[252:255], v63 offset:15360
    v_cvt_pk_bf16_f32 v82, v20, v21
    v_cvt_pk_bf16_f32 v83, v22, v23
    v_mfma_f32_16x16x32_bf16 v[16:19], a[228:231], a[36:39], v[16:19]
    ds_read_b64_tr_b16 a[176:177], v1 offset:16776
    v_exp_f32 v24, v24
    v_mfma_f32_16x16x32_bf16 v[16:19], a[232:235], a[40:43], v[16:19]
    ds_read_b64_tr_b16 a[178:179], v1 offset:17288
    v_exp_f32 v25, v25
    v_mfma_f32_16x16x32_bf16 v[16:19], a[236:239], a[44:47], v[16:19]
    v_exp_f32 v26, v26
    v_cvt_pk_bf16_f32 v68, v24, v25
    v_smfmac_f32_16x16x64_bf16 v[36:39], v[12:15], v[104:111], v57
    s_waitcnt lgkmcnt(12)
    v_exp_f32 v27, v27
    v_mfma_f32_16x16x32_bf16 v[196:199], a[160:163], v[104:107], v[196:199]
    s_waitcnt lgkmcnt(10)
    v_cvt_pk_bf16_f32 v69, v26, v27
    v_exp_f32 v28, v28
    v_mfma_f32_16x16x32_bf16 v[196:199], a[164:167], v[108:111], v[196:199]
    ds_read_b64_tr_b16 a[180:181], v1 offset:17800
    v_exp_f32 v29, v29
    v_mfma_f32_16x16x32_bf16 v[192:195], a[164:167], v[100:103], v[192:195]
    ds_read_b64_tr_b16 a[182:183], v1 offset:18312
    v_exp_f32 v30, v30
    v_mfma_f32_16x16x32_bf16 v[192:195], a[160:163], v[96:99], v[192:195]
    s_waitcnt lgkmcnt(10)
    v_exp_f32 v31, v31
    v_cvt_pk_bf16_f32 v76, v28, v29
    v_mfma_f32_16x16x32_bf16 v[208:211], a[168:171], v[96:99], v[208:211]
    s_waitcnt lgkmcnt(8)
    v_cvt_pk_bf16_f32 v77, v30, v31
    v_lshlrev_b32 v47, 16, v207
    v_and_b32 v204, s54, v204
    v_and_b32 v205, s54, v205
    v_and_b32 v206, s54, v206
    v_and_b32 v207, s54, v207
    v_pk_mul_f32 v[44:45], v[44:45], s[44:45] op_sel:[0,1] op_sel_hi:[1,1]
    v_pk_mul_f32 v[46:47], v[46:47], s[44:45] op_sel:[0,1] op_sel_hi:[1,1]
    v_pk_mul_f32 v[204:205], v[204:205], s[44:45] op_sel:[0,1] op_sel_hi:[1,1]
    v_pk_mul_f32 v[206:207], v[206:207], s[44:45] op_sel:[0,1] op_sel_hi:[1,1]
    v_mfma_f32_16x16x32_bf16 v[208:211], a[172:175], v[100:103], v[208:211]
    v_cvt_pk_bf16_f32 v204, v44, v204
    v_cvt_pk_bf16_f32 v205, v45, v205
    v_cvt_pk_bf16_f32 v206, v46, v206
    v_mfma_f32_16x16x32_bf16 v[212:215], a[172:175], v[108:111], v[212:215]
    v_cvt_pk_bf16_f32 v207, v47, v207
    v_lshlrev_b32 v7, 16, v223
    v_and_b32 v220, s54, v220
    v_and_b32 v221, s54, v221
    v_and_b32 v222, s54, v222
    v_and_b32 v223, s54, v223
    v_pk_mul_f32 v[4:5], v[4:5], s[44:45] op_sel:[0,1] op_sel_hi:[1,1]
    v_pk_mul_f32 v[6:7], v[6:7], s[44:45] op_sel:[0,1] op_sel_hi:[1,1]
    v_pk_mul_f32 v[220:221], v[220:221], s[44:45] op_sel:[0,1] op_sel_hi:[1,1]
    v_pk_mul_f32 v[222:223], v[222:223], s[44:45] op_sel:[0,1] op_sel_hi:[1,1]
    v_mfma_f32_16x16x32_bf16 v[212:215], a[168:171], v[104:107], v[212:215]
    s_waitcnt lgkmcnt(7)
    ds_write_b128 v50, v[204:207] offset:16384
    v_cvt_pk_bf16_f32 v220, v4, v220
    v_mfma_f32_16x16x32_bf16 v[20:23], a[240:243], a[0:3], -4.0
    s_waitcnt lgkmcnt(7)
    v_cvt_pk_bf16_f32 v221, v5, v221
    v_cvt_pk_bf16_f32 v222, v6, v222
    v_cvt_pk_bf16_f32 v223, v7, v223
    v_mfma_f32_16x16x32_bf16 v[20:23], a[244:247], a[4:7], v[20:23]
    s_waitcnt vmcnt(17) lgkmcnt(6)
    ds_write_b128 v50, v[220:223] offset:24576
    v_lshlrev_b32 v44, 16, v236
    v_mfma_f32_16x16x32_bf16 v[20:23], a[248:251], a[8:11], v[20:23]
    s_waitcnt vmcnt(16) lgkmcnt(6)
    v_lshlrev_b32 v45, 16, v237
    v_lshlrev_b32 v46, 16, v238
    v_lshlrev_b32 v4, 16, v252
    v_mfma_f32_16x16x32_bf16 v[20:23], a[252:255], a[12:15], v[20:23]
    v_lshlrev_b32 v47, 16, v239
    v_and_b32 v236, s54, v236
    v_and_b32 v237, s54, v237
    v_and_b32 v238, s54, v238
    v_and_b32 v239, s54, v239
    v_pk_mul_f32 v[44:45], v[44:45], s[44:45] op_sel:[0,1] op_sel_hi:[1,1]
    v_pk_mul_f32 v[46:47], v[46:47], s[44:45] op_sel:[0,1] op_sel_hi:[1,1]
    v_pk_mul_f32 v[236:237], v[236:237], s[44:45] op_sel:[0,1] op_sel_hi:[1,1]
    v_pk_mul_f32 v[238:239], v[238:239], s[44:45] op_sel:[0,1] op_sel_hi:[1,1]
    v_cvt_pk_bf16_f32 v236, v44, v236
    v_mfma_f32_16x16x32_bf16 v[24:27], a[252:255], a[28:31], -4.0
    v_cvt_pk_bf16_f32 v237, v45, v237
    v_cvt_pk_bf16_f32 v238, v46, v238
    v_cvt_pk_bf16_f32 v239, v47, v239
    v_mfma_f32_16x16x32_bf16 v[24:27], a[248:251], a[24:27], v[24:27]
    ds_write_b128 v51, v[236:239] offset:16384
    v_lshlrev_b32 v5, 16, v253
    v_mfma_f32_16x16x32_bf16 v[24:27], a[244:247], a[20:23], v[24:27]
    v_lshlrev_b32 v6, 16, v254
    v_lshlrev_b32 v7, 16, v255
    v_and_b32 v252, s54, v252
    v_and_b32 v253, s54, v253
    v_and_b32 v254, s54, v254
    v_and_b32 v255, s54, v255
    v_pk_mul_f32 v[4:5], v[4:5], s[44:45] op_sel:[0,1] op_sel_hi:[1,1]
    v_pk_mul_f32 v[6:7], v[6:7], s[44:45] op_sel:[0,1] op_sel_hi:[1,1]
    v_pk_mul_f32 v[252:253], v[252:253], s[44:45] op_sel:[0,1] op_sel_hi:[1,1]
    v_pk_mul_f32 v[254:255], v[254:255], s[44:45] op_sel:[0,1] op_sel_hi:[1,1]
    v_mfma_f32_16x16x32_bf16 v[24:27], a[240:243], a[16:19], v[24:27]
    v_cvt_pk_bf16_f32 v252, v4, v252
    v_cvt_pk_bf16_f32 v253, v5, v253
    v_cvt_pk_bf16_f32 v254, v6, v254
    v_cvt_pk_bf16_f32 v255, v7, v255
    v_mfma_f32_16x16x32_bf16 v[28:31], a[240:243], a[32:35], -4.0
    ds_write_b128 v51, v[252:255] offset:24576
    ds_read_b64_tr_b16 a[184:185], v1 offset:16784
    v_mfma_f32_16x16x32_bf16 v[28:31], a[244:247], a[36:39], v[28:31]
    ds_read_b64_tr_b16 a[186:187], v1 offset:17296
    ds_read_b64_tr_b16 a[188:189], v1 offset:17808
    v_mfma_f32_16x16x32_bf16 v[28:31], a[248:251], a[40:43], v[28:31]
    ds_read_b64_tr_b16 a[190:191], v1 offset:18320
    v_xor_b32 v56, 0x840, v2
    v_mfma_f32_16x16x32_bf16 v[28:31], a[252:255], a[44:47], v[28:31]
    s_waitcnt lgkmcnt(10)
    v_exp_f32 v16, v16
    v_mfma_f32_16x16x32_bf16 v[224:227], a[176:179], v[96:99], v[224:227]
    s_waitcnt lgkmcnt(8)
    v_exp_f32 v17, v17
    v_cndmask_b32 v59, v2, v56, vcc
    v_mfma_f32_16x16x32_bf16 v[224:227], a[180:183], v[100:103], v[224:227]
    v_exp_f32 v18, v18
    v_mfma_f32_16x16x32_bf16 v[228:231], a[180:183], v[108:111], v[228:231]
    s_waitcnt vmcnt(12) lgkmcnt(2)
    v_exp_f32 v19, v19
    v_mfma_f32_16x16x32_bf16 v[228:231], a[176:179], v[104:107], v[228:231]
    s_barrier
    ds_read_b128 a[224:227], v62 offset:16384
    ds_read_b128 a[228:231], v63 offset:17408
    ds_read_b128 a[232:235], v62 offset:18432
    v_mfma_f32_16x16x32_bf16 v[244:247], a[184:187], v[104:107], v[244:247]
    s_waitcnt lgkmcnt(3)
    ds_read_b128 a[236:239], v63 offset:19456
    v_cvt_pk_bf16_f32 v84, v16, v17
    v_mfma_f32_16x16x32_bf16 v[244:247], a[188:191], v[108:111], v[244:247]
    buffer_load_dwordx4 v[140:143], v0, s[16:19], s39 offen offset:0 nt
    v_cvt_pk_bf16_f32 v85, v18, v19
    v_mfma_f32_16x16x32_bf16 v[240:243], a[188:191], v[100:103], v[240:243]
    v_exp_f32 v20, v20
    v_mfma_f32_16x16x32_bf16 v[240:243], a[184:187], v[96:99], v[240:243]
    s_waitcnt lgkmcnt(3)
    ds_read_b64_tr_b16 a[128:129], v1 offset:49752
    v_exp_f32 v21, v21
    v_mfma_f32_16x16x32_bf16 v[16:19], a[224:227], a[0:3], -4.0
    s_waitcnt lgkmcnt(3)
    v_exp_f32 v22, v22
    v_mfma_f32_16x16x32_bf16 v[16:19], a[228:231], a[4:7], v[16:19]
    s_waitcnt lgkmcnt(2)
    buffer_load_dwordx4 v[156:159], v0, s[16:19], s39 offen offset:1024 nt
    v_mfma_f32_16x16x32_bf16 v[16:19], a[232:235], a[8:11], v[16:19]
    s_waitcnt lgkmcnt(1)
    v_exp_f32 v23, v23
    v_cvt_pk_bf16_f32 v70, v20, v21
    v_mfma_f32_16x16x32_bf16 v[16:19], a[236:239], a[12:15], v[16:19]
    v_cvt_pk_bf16_f32 v71, v22, v23
    v_exp_f32 v24, v24
    v_mfma_f32_16x16x32_bf16 v[20:23], a[236:239], a[28:31], -4.0
    ds_read_b64_tr_b16 a[130:131], v1 offset:50264
    v_exp_f32 v25, v25
    v_mfma_f32_16x16x32_bf16 v[20:23], a[232:235], a[24:27], v[20:23]
    buffer_load_dwordx4 v[172:175], v0, s[16:19], s39 offen offset:2048 nt
    v_mfma_f32_16x16x32_bf16 v[20:23], a[228:231], a[20:23], v[20:23]
    v_exp_f32 v26, v26
    v_exp_f32 v27, v27
    v_mfma_f32_16x16x32_bf16 v[20:23], a[224:227], a[16:19], v[20:23]
    ds_read_b64_tr_b16 a[132:133], v1 offset:50776
    ds_read_b64_tr_b16 a[134:135], v1 offset:51288
    v_cvt_pk_bf16_f32 v78, v24, v25
    v_cvt_pk_bf16_f32 v79, v26, v27
    v_mfma_f32_16x16x32_bf16 v[24:27], a[224:227], a[32:35], -4.0
    s_waitcnt vmcnt(10)
    ds_read_b64_tr_b16 a[140:141], v1 offset:50784
    ds_read_b64_tr_b16 a[142:143], v1 offset:51296
    v_lshlrev_b32 v44, 16, v88
    v_mfma_f32_16x16x32_bf16 v[24:27], a[228:231], a[36:39], v[24:27]
    buffer_load_dwordx4 v[188:191], v0, s[16:19], s39 offen offset:3072 nt
    v_mfma_f32_16x16x32_bf16 v[24:27], a[232:235], a[40:43], v[24:27]
    ds_read_b64_tr_b16 a[136:137], v1 offset:49760
    ds_read_b64_tr_b16 a[138:139], v1 offset:50272
    v_mfma_f32_16x16x32_bf16 v[24:27], a[236:239], a[44:47], v[24:27]
    v_exp_f32 v28, v28
    v_smfmac_f32_16x16x64_bf16 v[32:35], v[12:15], v[64:71], v57
    s_waitcnt lgkmcnt(6)
    v_exp_f32 v29, v29
    v_mfma_f32_16x16x32_bf16 v[128:131], a[128:131], v[64:67], v[128:131]
    s_waitcnt lgkmcnt(4)
    v_exp_f32 v30, v30
    v_mfma_f32_16x16x32_bf16 v[128:131], a[132:135], v[68:71], v[128:131]
    v_exp_f32 v31, v31
    v_mfma_f32_16x16x32_bf16 v[132:135], a[132:135], v[76:79], v[132:135]
    v_cvt_pk_bf16_f32 v86, v28, v29
    v_cvt_pk_bf16_f32 v87, v30, v31
    v_mfma_f32_16x16x32_bf16 v[132:135], a[128:131], v[72:75], v[132:135]
    ds_read_b128 a[224:227], v62 offset:20480
    v_exp_f32 v16, v16
    v_mfma_f32_16x16x32_bf16 v[136:139], a[128:131], v[80:83], 0
    ds_read_b128 a[228:231], v63 offset:21504
    v_lshlrev_b32 v45, 16, v89
    v_mfma_f32_16x16x32_bf16 v[136:139], a[132:135], v[84:87], v[136:139]
    s_waitcnt lgkmcnt(4)
    ds_read_b128 a[232:235], v62 offset:22528
    v_lshlrev_b32 v46, 16, v90
    v_mfma_f32_16x16x32_bf16 v[152:155], a[140:143], v[84:87], 0
    s_waitcnt vmcnt(10) lgkmcnt(3)
    ds_read_b128 a[236:239], v63 offset:23552
    v_lshlrev_b32 v4, 16, v92
    v_mfma_f32_16x16x32_bf16 v[152:155], a[136:139], v[80:83], v[152:155]
    ds_read_b64_tr_b16 a[144:145], v1 offset:49816
    v_exp_f32 v17, v17
    v_mfma_f32_16x16x32_bf16 v[148:151], a[136:139], v[72:75], v[148:151]
    v_exp_f32 v18, v18
    v_mfma_f32_16x16x32_bf16 v[148:151], a[140:143], v[76:79], v[148:151]
    v_exp_f32 v19, v19
    v_mfma_f32_16x16x32_bf16 v[144:147], a[140:143], v[68:71], v[144:147]
    ds_read_b64_tr_b16 a[146:147], v1 offset:50328
    v_cvt_pk_bf16_f32 v96, v16, v17
    v_cvt_pk_bf16_f32 v97, v18, v19
    v_mfma_f32_16x16x32_bf16 v[144:147], a[136:139], v[64:67], v[144:147]
    s_waitcnt lgkmcnt(5)
    v_exp_f32 v20, v20
    v_mfma_f32_16x16x32_bf16 v[28:31], a[224:227], a[0:3], -4.0
    s_waitcnt lgkmcnt(4)
    v_exp_f32 v21, v21
    v_mfma_f32_16x16x32_bf16 v[28:31], a[228:231], a[4:7], v[28:31]
    s_waitcnt lgkmcnt(3)
    v_exp_f32 v22, v22
    v_mfma_f32_16x16x32_bf16 v[28:31], a[232:235], a[8:11], v[28:31]
    s_waitcnt lgkmcnt(2)
    v_exp_f32 v23, v23
    v_cvt_pk_bf16_f32 v104, v20, v21
    v_mfma_f32_16x16x32_bf16 v[28:31], a[236:239], a[12:15], v[28:31]
    ds_read_b64_tr_b16 a[148:149], v1 offset:50840
    v_cvt_pk_bf16_f32 v105, v22, v23
    v_mfma_f32_16x16x32_bf16 v[16:19], a[236:239], a[28:31], -4.0
    ds_read_b64_tr_b16 a[150:151], v1 offset:51352
    ds_read_b64_tr_b16 a[156:157], v1 offset:50848
    v_mfma_f32_16x16x32_bf16 v[16:19], a[232:235], a[24:27], v[16:19]
    ds_read_b64_tr_b16 a[158:159], v1 offset:51360
    ds_read_b64_tr_b16 a[152:153], v1 offset:49824
    v_mfma_f32_16x16x32_bf16 v[16:19], a[228:231], a[20:23], v[16:19]
    ds_read_b64_tr_b16 a[154:155], v1 offset:50336
    v_exp_f32 v24, v24
    v_mfma_f32_16x16x32_bf16 v[16:19], a[224:227], a[16:19], v[16:19]
    v_exp_f32 v25, v25
    v_mfma_f32_16x16x32_bf16 v[20:23], a[224:227], a[32:35], -4.0
    ds_read_b128 a[224:227], v62 offset:24576
    v_cvt_pk_bf16_f32 v112, v24, v25
    v_mfma_f32_16x16x32_bf16 v[20:23], a[228:231], a[36:39], v[20:23]
    ds_read_b128 a[228:231], v63 offset:25600
    v_lshlrev_b32 v5, 16, v93
    v_mfma_f32_16x16x32_bf16 v[20:23], a[232:235], a[40:43], v[20:23]
    ds_read_b128 a[232:235], v62 offset:26624
    v_exp_f32 v26, v26
    v_mfma_f32_16x16x32_bf16 v[20:23], a[236:239], a[44:47], v[20:23]
    ds_read_b128 a[236:239], v63 offset:27648
    v_lshlrev_b32 v6, 16, v94
    v_smfmac_f32_16x16x64_bf16 v[36:39], v[12:15], v[72:79], v57
    s_waitcnt lgkmcnt(10)
    ds_read_b64_tr_b16 a[160:161], v1 offset:49880
    v_mfma_f32_16x16x32_bf16 v[164:167], a[144:147], v[72:75], v[164:167]
    s_waitcnt lgkmcnt(9)
    ds_read_b64_tr_b16 a[162:163], v1 offset:50392
    v_exp_f32 v27, v27
    v_mfma_f32_16x16x32_bf16 v[164:167], a[148:151], v[76:79], v[164:167]
    ds_read_b64_tr_b16 a[164:165], v1 offset:50904
    v_cvt_pk_bf16_f32 v113, v26, v27
    v_mfma_f32_16x16x32_bf16 v[160:163], a[148:151], v[68:71], v[160:163]
    v_exp_f32 v28, v28
    v_mfma_f32_16x16x32_bf16 v[160:163], a[144:147], v[64:67], v[160:163]
    v_exp_f32 v29, v29
    v_mfma_f32_16x16x32_bf16 v[168:171], a[144:147], v[80:83], 0
    v_exp_f32 v30, v30
    v_cvt_pk_bf16_f32 v98, v28, v29
    v_mfma_f32_16x16x32_bf16 v[168:171], a[148:151], v[84:87], v[168:171]
    s_waitcnt lgkmcnt(9)
    v_exp_f32 v31, v31
    v_mfma_f32_16x16x32_bf16 v[184:187], a[156:159], v[84:87], 0
    s_waitcnt lgkmcnt(7)
    ds_read_b64_tr_b16 a[166:167], v1 offset:51416
    v_cvt_pk_bf16_f32 v99, v30, v31
    v_mfma_f32_16x16x32_bf16 v[184:187], a[152:155], v[80:83], v[184:187]
    ds_read_b64_tr_b16 a[172:173], v1 offset:50912
    v_exp_f32 v16, v16
    v_mfma_f32_16x16x32_bf16 v[176:179], a[152:155], v[64:67], v[176:179]
    v_exp_f32 v17, v17
    v_mfma_f32_16x16x32_bf16 v[176:179], a[156:159], v[68:71], v[176:179]
    v_exp_f32 v18, v18
    v_mfma_f32_16x16x32_bf16 v[180:183], a[156:159], v[76:79], v[180:183]
    v_exp_f32 v19, v19
    v_mfma_f32_16x16x32_bf16 v[180:183], a[152:155], v[72:75], v[180:183]
    s_waitcnt lgkmcnt(8)
    ds_read_b64_tr_b16 a[174:175], v1 offset:51424
    v_cvt_pk_bf16_f32 v106, v16, v17
    v_cvt_pk_bf16_f32 v107, v18, v19
    v_mfma_f32_16x16x32_bf16 v[24:27], a[224:227], a[0:3], -4.0
    s_waitcnt lgkmcnt(8)
    ds_read_b64_tr_b16 a[168:169], v1 offset:49888
    ds_read_b64_tr_b16 a[170:171], v1 offset:50400
    v_mfma_f32_16x16x32_bf16 v[24:27], a[228:231], a[4:7], v[24:27]
    s_waitcnt lgkmcnt(9)
    v_exp_f32 v20, v20
    v_mfma_f32_16x16x32_bf16 v[24:27], a[232:235], a[8:11], v[24:27]
    s_waitcnt lgkmcnt(8)
    ds_read_b64_tr_b16 a[176:177], v1 offset:49944
    v_exp_f32 v21, v21
    v_mfma_f32_16x16x32_bf16 v[24:27], a[236:239], a[12:15], v[24:27]
    v_exp_f32 v22, v22
    v_mfma_f32_16x16x32_bf16 v[28:31], a[236:239], a[28:31], -4.0
    v_exp_f32 v23, v23
    v_mfma_f32_16x16x32_bf16 v[28:31], a[232:235], a[24:27], v[28:31]
    v_cvt_pk_bf16_f32 v114, v20, v21
    v_cvt_pk_bf16_f32 v115, v22, v23
    v_mfma_f32_16x16x32_bf16 v[28:31], a[228:231], a[20:23], v[28:31]
    ds_read_b64_tr_b16 a[178:179], v1 offset:50456
    v_lshlrev_b32 v47, 16, v91
    v_and_b32 v88, s54, v88
    v_and_b32 v89, s54, v89
    v_and_b32 v90, s54, v90
    v_and_b32 v91, s54, v91
    v_pk_mul_f32 v[44:45], v[44:45], s[44:45] op_sel:[0,1] op_sel_hi:[1,1]
    v_pk_mul_f32 v[46:47], v[46:47], s[44:45] op_sel:[0,1] op_sel_hi:[1,1]
    v_pk_mul_f32 v[88:89], v[88:89], s[44:45] op_sel:[0,1] op_sel_hi:[1,1]
    v_pk_mul_f32 v[90:91], v[90:91], s[44:45] op_sel:[0,1] op_sel_hi:[1,1]
    v_mfma_f32_16x16x32_bf16 v[28:31], a[224:227], a[16:19], v[28:31]
    v_exp_f32 v24, v24
    v_mfma_f32_16x16x32_bf16 v[16:19], a[224:227], a[32:35], -4.0
    ds_read_b128 a[224:227], v62 offset:28672
    v_cvt_pk_bf16_f32 v88, v44, v88
    v_mfma_f32_16x16x32_bf16 v[16:19], a[228:231], a[36:39], v[16:19]
    ds_read_b128 a[228:231], v63 offset:29696
    v_exp_f32 v25, v25
    v_mfma_f32_16x16x32_bf16 v[16:19], a[232:235], a[40:43], v[16:19]
    ds_read_b128 a[232:235], v62 offset:30720
    v_cvt_pk_bf16_f32 v100, v24, v25
    v_mfma_f32_16x16x32_bf16 v[16:19], a[236:239], a[44:47], v[16:19]
    ds_read_b128 a[236:239], v63 offset:31744
    v_cvt_pk_bf16_f32 v89, v45, v89
    v_smfmac_f32_16x16x64_bf16 v[40:43], v[12:15], v[80:87], v57
    s_waitcnt lgkmcnt(12)
    ds_read_b64_tr_b16 a[180:181], v1 offset:50968
    v_mfma_f32_16x16x32_bf16 v[200:203], a[160:163], v[80:83], 0
    s_waitcnt lgkmcnt(11)
    ds_read_b64_tr_b16 a[182:183], v1 offset:51480
    v_exp_f32 v26, v26
    v_mfma_f32_16x16x32_bf16 v[200:203], a[164:167], v[84:87], v[200:203]
    v_exp_f32 v27, v27
    v_mfma_f32_16x16x32_bf16 v[192:195], a[164:167], v[68:71], v[192:195]
    v_cvt_pk_bf16_f32 v101, v26, v27
    v_cvt_pk_bf16_f32 v90, v46, v90
    v_mfma_f32_16x16x32_bf16 v[192:195], a[160:163], v[64:67], v[192:195]
    v_exp_f32 v28, v28
    v_cvt_pk_bf16_f32 v91, v47, v91
    v_mfma_f32_16x16x32_bf16 v[196:199], a[160:163], v[72:75], v[196:199]
    ds_write_b128 v50, v[88:91] offset:32768
    v_mfma_f32_16x16x32_bf16 v[196:199], a[164:167], v[76:79], v[196:199]
    s_waitcnt lgkmcnt(11)
    v_exp_f32 v29, v29
    v_mfma_f32_16x16x32_bf16 v[212:215], a[172:175], v[76:79], v[212:215]
    s_waitcnt lgkmcnt(9)
    v_exp_f32 v30, v30
    v_cvt_pk_bf16_f32 v108, v28, v29
    v_mfma_f32_16x16x32_bf16 v[212:215], a[168:171], v[72:75], v[212:215]
    v_exp_f32 v31, v31
    v_mfma_f32_16x16x32_bf16 v[208:211], a[168:171], v[64:67], v[208:211]
    s_waitcnt vmcnt(9)
    v_cvt_pk_bf16_f32 v109, v30, v31
    v_lshlrev_b32 v44, 16, v120
    v_mfma_f32_16x16x32_bf16 v[208:211], a[172:175], v[68:71], v[208:211]
    v_lshlrev_b32 v7, 16, v95
    v_and_b32 v92, s54, v92
    v_and_b32 v93, s54, v93
    v_and_b32 v94, s54, v94
    v_and_b32 v95, s54, v95
    v_pk_mul_f32 v[4:5], v[4:5], s[44:45] op_sel:[0,1] op_sel_hi:[1,1]
    v_pk_mul_f32 v[6:7], v[6:7], s[44:45] op_sel:[0,1] op_sel_hi:[1,1]
    v_pk_mul_f32 v[92:93], v[92:93], s[44:45] op_sel:[0,1] op_sel_hi:[1,1]
    v_pk_mul_f32 v[94:95], v[94:95], s[44:45] op_sel:[0,1] op_sel_hi:[1,1]
    v_cvt_pk_bf16_f32 v92, v4, v92
    v_mfma_f32_16x16x32_bf16 v[216:219], a[172:175], v[84:87], 0
    v_cvt_pk_bf16_f32 v93, v5, v93
    v_cvt_pk_bf16_f32 v94, v6, v94
    v_mfma_f32_16x16x32_bf16 v[216:219], a[168:171], v[80:83], v[216:219]
    s_waitcnt lgkmcnt(6)
    v_cvt_pk_bf16_f32 v95, v7, v95
    v_lshlrev_b32 v45, 16, v121
    v_mfma_f32_16x16x32_bf16 v[20:23], a[224:227], a[0:3], -4.0
    s_waitcnt lgkmcnt(5)
    ds_write_b128 v50, v[92:95] offset:40960
    v_lshlrev_b32 v46, 16, v122
    v_mfma_f32_16x16x32_bf16 v[20:23], a[228:231], a[4:7], v[20:23]
    s_waitcnt lgkmcnt(5)
    v_lshlrev_b32 v47, 16, v123
    v_and_b32 v120, s54, v120
    v_and_b32 v121, s54, v121
    v_and_b32 v122, s54, v122
    v_and_b32 v123, s54, v123
    v_pk_mul_f32 v[44:45], v[44:45], s[44:45] op_sel:[0,1] op_sel_hi:[1,1]
    v_pk_mul_f32 v[46:47], v[46:47], s[44:45] op_sel:[0,1] op_sel_hi:[1,1]
    v_pk_mul_f32 v[120:121], v[120:121], s[44:45] op_sel:[0,1] op_sel_hi:[1,1]
    v_pk_mul_f32 v[122:123], v[122:123], s[44:45] op_sel:[0,1] op_sel_hi:[1,1]
    v_mfma_f32_16x16x32_bf16 v[20:23], a[232:235], a[8:11], v[20:23]
    s_waitcnt lgkmcnt(4)
    v_cvt_pk_bf16_f32 v120, v44, v120
    v_cvt_pk_bf16_f32 v121, v45, v121
    v_mfma_f32_16x16x32_bf16 v[20:23], a[236:239], a[12:15], v[20:23]
    s_waitcnt vmcnt(8)
    v_cvt_pk_bf16_f32 v122, v46, v122
    v_cvt_pk_bf16_f32 v123, v47, v123
    v_lshlrev_b32 v4, 16, v124
    v_mfma_f32_16x16x32_bf16 v[24:27], a[236:239], a[28:31], -4.0
    ds_write_b128 v51, v[120:123] offset:32768
    v_mfma_f32_16x16x32_bf16 v[24:27], a[232:235], a[24:27], v[24:27]
    v_lshlrev_b32 v5, 16, v125
    v_lshlrev_b32 v6, 16, v126
    v_mfma_f32_16x16x32_bf16 v[24:27], a[228:231], a[20:23], v[24:27]
    v_lshlrev_b32 v7, 16, v127
    v_and_b32 v124, s54, v124
    v_and_b32 v125, s54, v125
    v_and_b32 v126, s54, v126
    v_and_b32 v127, s54, v127
    v_pk_mul_f32 v[4:5], v[4:5], s[44:45] op_sel:[0,1] op_sel_hi:[1,1]
    v_pk_mul_f32 v[6:7], v[6:7], s[44:45] op_sel:[0,1] op_sel_hi:[1,1]
    v_pk_mul_f32 v[124:125], v[124:125], s[44:45] op_sel:[0,1] op_sel_hi:[1,1]
    v_pk_mul_f32 v[126:127], v[126:127], s[44:45] op_sel:[0,1] op_sel_hi:[1,1]
    v_cvt_pk_bf16_f32 v124, v4, v124
    v_mfma_f32_16x16x32_bf16 v[24:27], a[224:227], a[16:19], v[24:27]
    v_cvt_pk_bf16_f32 v125, v5, v125
    v_cvt_pk_bf16_f32 v126, v6, v126
    v_mfma_f32_16x16x32_bf16 v[28:31], a[224:227], a[32:35], -4.0
    ds_read_b64_tr_b16 a[184:185], v1 offset:49952
    v_cvt_pk_bf16_f32 v127, v7, v127
    v_mfma_f32_16x16x32_bf16 v[28:31], a[228:231], a[36:39], v[28:31]
    ds_write_b128 v51, v[124:127] offset:40960
    ds_read_b64_tr_b16 a[186:187], v1 offset:50464
    v_mfma_f32_16x16x32_bf16 v[28:31], a[232:235], a[40:43], v[28:31]
    ds_read_b64_tr_b16 a[188:189], v1 offset:50976
    ds_read_b64_tr_b16 a[190:191], v1 offset:51488
    v_mfma_f32_16x16x32_bf16 v[28:31], a[236:239], a[44:47], v[28:31]
    v_exp_f32 v16, v16
    v_mfma_f32_16x16x32_bf16 v[224:227], a[176:179], v[64:67], v[224:227]
    s_waitcnt lgkmcnt(8)
    v_exp_f32 v17, v17
    v_mfma_f32_16x16x32_bf16 v[224:227], a[180:183], v[68:71], v[224:227]
    v_exp_f32 v18, v18
    v_cvt_pk_bf16_f32 v116, v16, v17
    v_mfma_f32_16x16x32_bf16 v[228:231], a[180:183], v[76:79], v[228:231]
    v_exp_f32 v19, v19
    v_mfma_f32_16x16x32_bf16 v[228:231], a[176:179], v[72:75], v[228:231]
    v_exp_f32 v20, v20
    v_mfma_f32_16x16x32_bf16 v[232:235], a[176:179], v[80:83], 0
    s_waitcnt lgkmcnt(0)
    v_exp_f32 v21, v21
    v_mfma_f32_16x16x32_bf16 v[232:235], a[180:183], v[84:87], v[232:235]
    s_barrier
    ds_read_b128 a[224:227], v62 offset:32768
    buffer_load_dwordx4 v0, s[20:23], s38 offen offset:0 lds
    v_mfma_f32_16x16x32_bf16 v[248:251], a[188:191], v[84:87], 0
    ds_read_b128 a[228:231], v63 offset:33792
    v_cvt_pk_bf16_f32 v117, v18, v19
    v_mfma_f32_16x16x32_bf16 v[248:251], a[184:187], v[80:83], v[248:251]
    ds_read_b128 a[232:235], v62 offset:34816
    v_cvt_pk_bf16_f32 v102, v20, v21
    v_mfma_f32_16x16x32_bf16 v[244:247], a[184:187], v[72:75], v[244:247]
    s_waitcnt vmcnt(4)
    ds_read_b128 a[236:239], v63 offset:35840
    v_lshlrev_b32 v44, 16, v140
    v_mfma_f32_16x16x32_bf16 v[244:247], a[188:191], v[76:79], v[244:247]
    buffer_load_dwordx4 v0, s[20:23], s38 offen offset:1024 lds
    ds_read_b128 a[60:63], v3 offset:192
    v_mfma_f32_16x16x32_bf16 v[240:243], a[188:191], v[68:71], v[240:243]
    v_exp_f32 v22, v22
    v_mfma_f32_16x16x32_bf16 v[240:243], a[184:187], v[64:67], v[240:243]
    s_waitcnt lgkmcnt(4)
    v_exp_f32 v23, v23
    v_mfma_f32_16x16x32_bf16 v[16:19], a[224:227], a[0:3], -4.0
    s_waitcnt lgkmcnt(3)
    v_cvt_pk_bf16_f32 v103, v22, v23
    v_exp_f32 v24, v24
    v_mfma_f32_16x16x32_bf16 v[16:19], a[228:231], a[4:7], v[16:19]
    s_waitcnt lgkmcnt(2)
    buffer_load_dwordx4 v0, s[28:31], s38 offen offset:2056 lds
    v_mfma_f32_16x16x32_bf16 v[16:19], a[232:235], a[8:11], v[16:19]
    s_waitcnt lgkmcnt(1)
    v_exp_f32 v25, v25
    v_mfma_f32_16x16x32_bf16 v[16:19], a[236:239], a[12:15], v[16:19]
    ds_read_b128 a[56:59], v3 offset:128
    v_exp_f32 v26, v26
    v_mfma_f32_16x16x32_bf16 v[20:23], a[236:239], a[28:31], -4.0
    v_exp_f32 v27, v27
    v_mfma_f32_16x16x32_bf16 v[20:23], a[232:235], a[24:27], v[20:23]
    buffer_load_dwordx4 v0, s[28:31], s38 offen offset:3080 lds
    v_cvt_pk_bf16_f32 v110, v24, v25
    v_mfma_f32_16x16x32_bf16 v[20:23], a[228:231], a[20:23], v[20:23]
    s_mov_b32 m0, s76
    ds_read_b128 a[52:55], v3 offset:64
    v_cvt_pk_bf16_f32 v111, v26, v27
    v_lshlrev_b32 v45, 16, v141
    v_mfma_f32_16x16x32_bf16 v[20:23], a[224:227], a[16:19], v[20:23]
    ds_read_b128 a[48:51], v3 offset:0
    v_exp_f32 v28, v28
    v_mfma_f32_16x16x32_bf16 v[24:27], a[224:227], a[32:35], -4.0
    ds_read_b64_tr_b16 a[192:193], v1 offset:33168
    v_exp_f32 v29, v29
    v_mfma_f32_16x16x32_bf16 v[24:27], a[228:231], a[36:39], v[24:27]
    ds_read_b64_tr_b16 a[194:195], v1 offset:33680
    v_exp_f32 v30, v30
    v_mfma_f32_16x16x32_bf16 v[24:27], a[232:235], a[40:43], v[24:27]
    v_exp_f32 v31, v31
    v_cvt_pk_bf16_f32 v118, v28, v29
    v_mfma_f32_16x16x32_bf16 v[24:27], a[236:239], a[44:47], v[24:27]
    s_waitcnt lgkmcnt(5)
    ds_read_b64_tr_b16 a[244:245], v1 offset:34192
    ds_read_b64_tr_b16 a[246:247], v1 offset:34704
    v_cvt_pk_bf16_f32 v119, v30, v31
    v_mfma_f32_16x16x32_bf16 v[28:31], a[236:239], a[60:63], -4.0
    s_waitcnt lgkmcnt(6)
    ds_read_b64_tr_b16 a[252:253], v1 offset:34200
    ds_read_b64_tr_b16 a[254:255], v1 offset:34712
    v_mfma_f32_16x16x32_bf16 v[28:31], a[232:235], a[56:59], v[28:31]
    s_waitcnt lgkmcnt(7)
    ds_read_b64_tr_b16 a[196:197], v1 offset:33176
    ds_read_b64_tr_b16 a[198:199], v1 offset:33688
    v_mfma_f32_16x16x32_bf16 v[28:31], a[228:231], a[52:55], v[28:31]
    s_waitcnt lgkmcnt(8)
    buffer_load_dwordx4 v0, s[12:15], s42 offen offset:0 nt lds
    ds_read_b128 a[228:231], v63 offset:37888
    v_mfma_f32_16x16x32_bf16 v[28:31], a[224:227], a[48:51], v[28:31]
    s_mov_b32 m0, s77
    ds_read_b128 a[224:227], v62 offset:36864
    v_lshlrev_b32 v46, 16, v142
    v_smfmac_f32_16x16x64_bf16 v[32:35], v[12:15], v[96:103], v57
    s_waitcnt lgkmcnt(8)
    ds_read_b64_tr_b16 a[200:201], v1 offset:33232
    v_mfma_f32_16x16x32_bf16 v[128:131], a[192:195], v[96:99], v[128:131]
    s_waitcnt vmcnt(7) lgkmcnt(7)
    ds_read_b128 a[232:235], v62 offset:38912
    v_lshlrev_b32 v4, 16, v156
    v_mfma_f32_16x16x32_bf16 v[128:131], a[244:247], v[100:103], v[128:131]
    buffer_load_dwordx4 v0, s[12:15], s42 offen offset:1024 nt lds
    ds_read_b128 a[236:239], v63 offset:39936
    v_mfma_f32_16x16x32_bf16 v[132:135], a[244:247], v[108:111], v[132:135]
    s_mov_b32 m0, s78
    v_exp_f32 v16, v16
    v_mfma_f32_16x16x32_bf16 v[132:135], a[192:195], v[104:107], v[132:135]
    v_exp_f32 v17, v17
    v_mfma_f32_16x16x32_bf16 v[136:139], a[192:195], v[112:115], v[136:139]
    v_exp_f32 v18, v18
    v_cvt_pk_bf16_f32 v64, v16, v17
    v_mfma_f32_16x16x32_bf16 v[136:139], a[244:247], v[116:119], v[136:139]
    s_waitcnt lgkmcnt(7)
    buffer_load_dwordx4 v0, s[12:15], s42 offen offset:2048 nt lds
    v_mfma_f32_16x16x32_bf16 v[152:155], a[252:255], v[116:119], v[152:155]
    s_waitcnt lgkmcnt(5)
    v_exp_f32 v19, v19
    v_mfma_f32_16x16x32_bf16 v[152:155], a[196:199], v[112:115], v[152:155]
    s_mov_b32 m0, s79
    v_cvt_pk_bf16_f32 v65, v18, v19
    v_exp_f32 v20, v20
    v_mfma_f32_16x16x32_bf16 v[148:151], a[196:199], v[104:107], v[148:151]
    v_exp_f32 v21, v21
    v_mfma_f32_16x16x32_bf16 v[148:151], a[252:255], v[108:111], v[148:151]
    buffer_load_dwordx4 v0, s[12:15], s42 offen offset:3072 nt lds
    v_mfma_f32_16x16x32_bf16 v[144:147], a[252:255], v[100:103], v[144:147]
    v_exp_f32 v22, v22
    v_cvt_pk_bf16_f32 v72, v20, v21
    v_mfma_f32_16x16x32_bf16 v[144:147], a[196:199], v[96:99], v[144:147]
    s_waitcnt lgkmcnt(3)
    v_exp_f32 v23, v23
    v_mfma_f32_16x16x32_bf16 v[16:19], a[224:227], a[0:3], -4.0
L_hop3:
    s_cbranch_execz L_hop7
    s_add_u32 s42, s42, 4096
    ds_read_b64_tr_b16 a[202:203], v1 offset:33744
    v_cvt_pk_bf16_f32 v73, v22, v23
    v_mfma_f32_16x16x32_bf16 v[16:19], a[228:231], a[4:7], v[16:19]
    s_waitcnt lgkmcnt(2)
    ds_read_b64_tr_b16 a[244:245], v1 offset:34256
    v_exp_f32 v24, v24
    v_mfma_f32_16x16x32_bf16 v[16:19], a[232:235], a[8:11], v[16:19]
    s_waitcnt lgkmcnt(2)
    v_exp_f32 v25, v25
    v_mfma_f32_16x16x32_bf16 v[16:19], a[236:239], a[12:15], v[16:19]
    v_exp_f32 v26, v26
    v_mfma_f32_16x16x32_bf16 v[20:23], a[236:239], a[28:31], -4.0
    v_exp_f32 v27, v27
    v_cvt_pk_bf16_f32 v80, v24, v25
    v_mfma_f32_16x16x32_bf16 v[20:23], a[232:235], a[24:27], v[20:23]
    s_mov_b32 m0, s98
    ds_read_b64_tr_b16 a[246:247], v1 offset:34768
    v_cvt_pk_bf16_f32 v81, v26, v27
    v_mfma_f32_16x16x32_bf16 v[20:23], a[228:231], a[20:23], v[20:23]
    v_exp_f32 v28, v28
    v_mfma_f32_16x16x32_bf16 v[20:23], a[224:227], a[16:19], v[20:23]
    ds_read_b64_tr_b16 a[252:253], v1 offset:34264
    v_exp_f32 v29, v29
    v_mfma_f32_16x16x32_bf16 v[24:27], a[224:227], a[32:35], -4.0
    v_exp_f32 v30, v30
    v_mfma_f32_16x16x32_bf16 v[24:27], a[228:231], a[36:39], v[24:27]
    v_exp_f32 v31, v31
    v_mfma_f32_16x16x32_bf16 v[24:27], a[232:235], a[40:43], v[24:27]
    ds_read_b64_tr_b16 a[254:255], v1 offset:34776
    v_cvt_pk_bf16_f32 v88, v28, v29
    v_cvt_pk_bf16_f32 v89, v30, v31
    v_mfma_f32_16x16x32_bf16 v[24:27], a[236:239], a[44:47], v[24:27]
    ds_read_b64_tr_b16 a[204:205], v1 offset:33240
    ds_read_b64_tr_b16 a[206:207], v1 offset:33752
    v_mfma_f32_16x16x32_bf16 v[28:31], a[236:239], a[60:63], -4.0
    ds_read_b128 a[236:239], v63 offset:44032
    v_exp_f32 v16, v16
    v_mfma_f32_16x16x32_bf16 v[28:31], a[232:235], a[56:59], v[28:31]
    ds_read_b128 a[232:235], v62 offset:43008
    v_lshlrev_b32 v5, 16, v157
    v_mfma_f32_16x16x32_bf16 v[28:31], a[228:231], a[52:55], v[28:31]
    ds_read_b128 a[228:231], v63 offset:41984
    v_lshlrev_b32 v6, 16, v158
    v_mfma_f32_16x16x32_bf16 v[28:31], a[224:227], a[48:51], v[28:31]
    ds_read_b128 a[224:227], v62 offset:40960
    v_exp_f32 v17, v17
    v_smfmac_f32_16x16x64_bf16 v[36:39], v[12:15], v[104:111], v57
    s_waitcnt lgkmcnt(10)
    v_cvt_pk_bf16_f32 v66, v16, v17
    v_mfma_f32_16x16x32_bf16 v[164:167], a[200:203], v[104:107], v[164:167]
    s_waitcnt lgkmcnt(8)
    v_exp_f32 v18, v18
    v_mfma_f32_16x16x32_bf16 v[164:167], a[244:247], v[108:111], v[164:167]
    ds_read_b64_tr_b16 a[208:209], v1 offset:33296
    v_exp_f32 v19, v19
    v_mfma_f32_16x16x32_bf16 v[160:163], a[244:247], v[100:103], v[160:163]
    ds_read_b64_tr_b16 a[210:211], v1 offset:33808
    v_cvt_pk_bf16_f32 v67, v18, v19
    v_mfma_f32_16x16x32_bf16 v[160:163], a[200:203], v[96:99], v[160:163]
    v_exp_f32 v20, v20
    v_mfma_f32_16x16x32_bf16 v[168:171], a[200:203], v[112:115], v[168:171]
    ds_read_b64_tr_b16 a[212:213], v1 offset:33304
    v_exp_f32 v21, v21
    v_mfma_f32_16x16x32_bf16 v[168:171], a[244:247], v[116:119], v[168:171]
    s_waitcnt lgkmcnt(9)
    v_exp_f32 v22, v22
    v_mfma_f32_16x16x32_bf16 v[184:187], a[252:255], v[116:119], v[184:187]
    s_waitcnt lgkmcnt(7)
    v_exp_f32 v23, v23
    v_cvt_pk_bf16_f32 v74, v20, v21
    v_mfma_f32_16x16x32_bf16 v[184:187], a[204:207], v[112:115], v[184:187]
    ds_read_b64_tr_b16 a[244:245], v1 offset:34320
    v_cvt_pk_bf16_f32 v75, v22, v23
    v_mfma_f32_16x16x32_bf16 v[176:179], a[204:207], v[96:99], v[176:179]
    v_exp_f32 v24, v24
    v_mfma_f32_16x16x32_bf16 v[176:179], a[252:255], v[100:103], v[176:179]
    ds_read_b64_tr_b16 a[246:247], v1 offset:34832
    v_exp_f32 v25, v25
    v_mfma_f32_16x16x32_bf16 v[180:183], a[252:255], v[108:111], v[180:183]
    v_exp_f32 v26, v26
    v_mfma_f32_16x16x32_bf16 v[180:183], a[204:207], v[104:107], v[180:183]
    s_waitcnt lgkmcnt(5)
    v_exp_f32 v27, v27
    v_mfma_f32_16x16x32_bf16 v[16:19], a[224:227], a[0:3], -4.0
    ds_read_b64_tr_b16 a[252:253], v1 offset:34328
    v_cvt_pk_bf16_f32 v82, v24, v25
    v_cvt_pk_bf16_f32 v83, v26, v27
    v_mfma_f32_16x16x32_bf16 v[16:19], a[228:231], a[4:7], v[16:19]
    v_exp_f32 v28, v28
    v_mfma_f32_16x16x32_bf16 v[16:19], a[232:235], a[8:11], v[16:19]
    ds_read_b64_tr_b16 a[254:255], v1 offset:34840
    v_exp_f32 v29, v29
    v_mfma_f32_16x16x32_bf16 v[16:19], a[236:239], a[12:15], v[16:19]
    v_exp_f32 v30, v30
    v_mfma_f32_16x16x32_bf16 v[20:23], a[236:239], a[28:31], -4.0
    v_exp_f32 v31, v31
    v_mfma_f32_16x16x32_bf16 v[20:23], a[232:235], a[24:27], v[20:23]
    ds_read_b64_tr_b16 a[214:215], v1 offset:33816
    v_cvt_pk_bf16_f32 v90, v28, v29
    v_cvt_pk_bf16_f32 v91, v30, v31
    v_mfma_f32_16x16x32_bf16 v[20:23], a[228:231], a[20:23], v[20:23]
    ds_read_b64_tr_b16 a[216:217], v1 offset:33360
    ds_read_b64_tr_b16 a[218:219], v1 offset:33872
    v_mfma_f32_16x16x32_bf16 v[20:23], a[224:227], a[16:19], v[20:23]
    ds_read_b64_tr_b16 a[220:221], v1 offset:33368
    v_exp_f32 v16, v16
    v_mfma_f32_16x16x32_bf16 v[24:27], a[224:227], a[32:35], -4.0
    v_exp_f32 v17, v17
    v_mfma_f32_16x16x32_bf16 v[24:27], a[228:231], a[36:39], v[24:27]
    v_exp_f32 v18, v18
    v_mfma_f32_16x16x32_bf16 v[24:27], a[232:235], a[40:43], v[24:27]
    v_exp_f32 v19, v19
    v_cvt_pk_bf16_f32 v68, v16, v17
    v_mfma_f32_16x16x32_bf16 v[24:27], a[236:239], a[44:47], v[24:27]
    ds_read_b64_tr_b16 a[222:223], v1 offset:33880
    v_cvt_pk_bf16_f32 v69, v18, v19
    v_mfma_f32_16x16x32_bf16 v[28:31], a[236:239], a[60:63], -4.0
    v_exp_f32 v20, v20
    v_mfma_f32_16x16x32_bf16 v[28:31], a[232:235], a[56:59], v[28:31]
    ds_read_b128 a[232:235], v62 offset:47104
    v_exp_f32 v21, v21
    v_mfma_f32_16x16x32_bf16 v[28:31], a[228:231], a[52:55], v[28:31]
    ds_read_b128 a[228:231], v63 offset:46080
    v_cvt_pk_bf16_f32 v76, v20, v21
    v_mfma_f32_16x16x32_bf16 v[28:31], a[224:227], a[48:51], v[28:31]
    v_exp_f32 v22, v22
    v_smfmac_f32_16x16x64_bf16 v[40:43], v[12:15], v[112:119], v57
    s_waitcnt lgkmcnt(12)
    v_exp_f32 v23, v23
    v_mfma_f32_16x16x32_bf16 v[200:203], a[208:211], v[112:115], v[200:203]
    s_waitcnt lgkmcnt(9)
    ds_read_b128 a[224:227], v62 offset:45056
    v_cvt_pk_bf16_f32 v77, v22, v23
    v_mfma_f32_16x16x32_bf16 v[200:203], a[244:247], v[116:119], v[200:203]
    ds_read_b128 a[236:239], v63 offset:48128
    v_exp_f32 v24, v24
    v_mfma_f32_16x16x32_bf16 v[192:195], a[244:247], v[100:103], v[192:195]
    v_exp_f32 v25, v25
    v_mfma_f32_16x16x32_bf16 v[192:195], a[208:211], v[96:99], v[192:195]
    v_exp_f32 v26, v26
    v_cvt_pk_bf16_f32 v84, v24, v25
    v_mfma_f32_16x16x32_bf16 v[196:199], a[208:211], v[104:107], v[196:199]
    v_exp_f32 v27, v27
    v_mfma_f32_16x16x32_bf16 v[196:199], a[244:247], v[108:111], v[196:199]
    s_waitcnt lgkmcnt(9)
    ds_read_b64_tr_b16 a[244:245], v1 offset:34384
    v_cvt_pk_bf16_f32 v85, v26, v27
    v_mfma_f32_16x16x32_bf16 v[212:215], a[252:255], v[108:111], v[212:215]
    s_waitcnt lgkmcnt(9)
    ds_read_b64_tr_b16 a[246:247], v1 offset:34896
    v_exp_f32 v28, v28
    v_mfma_f32_16x16x32_bf16 v[212:215], a[212:215], v[104:107], v[212:215]
    v_exp_f32 v29, v29
    v_mfma_f32_16x16x32_bf16 v[208:211], a[212:215], v[96:99], v[208:211]
    v_exp_f32 v30, v30
    v_cvt_pk_bf16_f32 v92, v28, v29
    v_mfma_f32_16x16x32_bf16 v[208:211], a[252:255], v[100:103], v[208:211]
    v_exp_f32 v31, v31
    v_mfma_f32_16x16x32_bf16 v[216:219], a[252:255], v[116:119], v[216:219]
    ds_read_b64_tr_b16 a[252:253], v1 offset:34392
    v_cvt_pk_bf16_f32 v93, v30, v31
    v_mfma_f32_16x16x32_bf16 v[216:219], a[212:215], v[112:115], v[216:219]
    s_waitcnt lgkmcnt(4)
    v_lshlrev_b32 v47, 16, v143
    v_and_b32 v140, s54, v140
    v_and_b32 v141, s54, v141
    v_and_b32 v142, s54, v142
    v_and_b32 v143, s54, v143
    v_pk_mul_f32 v[44:45], v[44:45], s[44:45] op_sel:[0,1] op_sel_hi:[1,1]
    v_pk_mul_f32 v[46:47], v[46:47], s[44:45] op_sel:[0,1] op_sel_hi:[1,1]
    v_pk_mul_f32 v[140:141], v[140:141], s[44:45] op_sel:[0,1] op_sel_hi:[1,1]
    v_pk_mul_f32 v[142:143], v[142:143], s[44:45] op_sel:[0,1] op_sel_hi:[1,1]
    v_cvt_pk_bf16_f32 v140, v44, v140
    v_mfma_f32_16x16x32_bf16 v[16:19], a[224:227], a[0:3], -4.0
    v_cvt_pk_bf16_f32 v141, v45, v141
    v_cvt_pk_bf16_f32 v142, v46, v142
    v_mfma_f32_16x16x32_bf16 v[16:19], a[228:231], a[4:7], v[16:19]
    v_cvt_pk_bf16_f32 v143, v47, v143
    v_lshlrev_b32 v7, 16, v159
    v_and_b32 v156, s54, v156
    v_and_b32 v157, s54, v157
    v_and_b32 v158, s54, v158
    v_and_b32 v159, s54, v159
    v_pk_mul_f32 v[4:5], v[4:5], s[44:45] op_sel:[0,1] op_sel_hi:[1,1]
    v_pk_mul_f32 v[6:7], v[6:7], s[44:45] op_sel:[0,1] op_sel_hi:[1,1]
    v_pk_mul_f32 v[156:157], v[156:157], s[44:45] op_sel:[0,1] op_sel_hi:[1,1]
    v_pk_mul_f32 v[158:159], v[158:159], s[44:45] op_sel:[0,1] op_sel_hi:[1,1]
    v_mfma_f32_16x16x32_bf16 v[16:19], a[232:235], a[8:11], v[16:19]
    s_waitcnt lgkmcnt(3)
    ds_write_b128 v50, v[140:143] offset:49152
    v_mfma_f32_16x16x32_bf16 v[16:19], a[236:239], a[12:15], v[16:19]
    v_cvt_pk_bf16_f32 v156, v4, v156
    v_cvt_pk_bf16_f32 v157, v5, v157
    v_mfma_f32_16x16x32_bf16 v[20:23], a[236:239], a[28:31], -4.0
    s_waitcnt vmcnt(9)
    v_cvt_pk_bf16_f32 v158, v6, v158
    v_cvt_pk_bf16_f32 v159, v7, v159
    v_lshlrev_b32 v44, 16, v172
    v_mfma_f32_16x16x32_bf16 v[20:23], a[232:235], a[24:27], v[20:23]
    ds_write_b128 v50, v[156:159] offset:57344
    v_mfma_f32_16x16x32_bf16 v[20:23], a[228:231], a[20:23], v[20:23]
    s_waitcnt vmcnt(8)
    v_lshlrev_b32 v45, 16, v173
    v_lshlrev_b32 v46, 16, v174
    v_lshlrev_b32 v4, 16, v188
    v_mfma_f32_16x16x32_bf16 v[20:23], a[224:227], a[16:19], v[20:23]
    v_lshlrev_b32 v47, 16, v175
    v_and_b32 v172, s54, v172
    v_and_b32 v173, s54, v173
    v_and_b32 v174, s54, v174
    v_and_b32 v175, s54, v175
    v_pk_mul_f32 v[44:45], v[44:45], s[44:45] op_sel:[0,1] op_sel_hi:[1,1]
    v_pk_mul_f32 v[46:47], v[46:47], s[44:45] op_sel:[0,1] op_sel_hi:[1,1]
    v_pk_mul_f32 v[172:173], v[172:173], s[44:45] op_sel:[0,1] op_sel_hi:[1,1]
    v_pk_mul_f32 v[174:175], v[174:175], s[44:45] op_sel:[0,1] op_sel_hi:[1,1]
    v_mfma_f32_16x16x32_bf16 v[24:27], a[224:227], a[32:35], -4.0
    v_cvt_pk_bf16_f32 v172, v44, v172
    v_cvt_pk_bf16_f32 v173, v45, v173
    v_cvt_pk_bf16_f32 v174, v46, v174
    v_mfma_f32_16x16x32_bf16 v[24:27], a[228:231], a[36:39], v[24:27]
    v_cvt_pk_bf16_f32 v175, v47, v175
    v_lshlrev_b32 v5, 16, v189
    v_mfma_f32_16x16x32_bf16 v[24:27], a[232:235], a[40:43], v[24:27]
    ds_write_b128 v51, v[172:175] offset:49152
    v_mfma_f32_16x16x32_bf16 v[24:27], a[236:239], a[44:47], v[24:27]
    v_lshlrev_b32 v6, 16, v190
    v_lshlrev_b32 v7, 16, v191
    v_and_b32 v188, s54, v188
    v_and_b32 v189, s54, v189
    v_and_b32 v190, s54, v190
    v_and_b32 v191, s54, v191
    v_pk_mul_f32 v[4:5], v[4:5], s[44:45] op_sel:[0,1] op_sel_hi:[1,1]
    v_pk_mul_f32 v[6:7], v[6:7], s[44:45] op_sel:[0,1] op_sel_hi:[1,1]
    v_pk_mul_f32 v[188:189], v[188:189], s[44:45] op_sel:[0,1] op_sel_hi:[1,1]
    v_pk_mul_f32 v[190:191], v[190:191], s[44:45] op_sel:[0,1] op_sel_hi:[1,1]
    v_mfma_f32_16x16x32_bf16 v[28:31], a[236:239], a[60:63], -4.0
    v_cvt_pk_bf16_f32 v188, v4, v188
    v_cvt_pk_bf16_f32 v189, v5, v189
    v_mfma_f32_16x16x32_bf16 v[28:31], a[232:235], a[56:59], v[28:31]
    ds_read_b64_tr_b16 a[254:255], v1 offset:34904
    v_cvt_pk_bf16_f32 v190, v6, v190
    v_cvt_pk_bf16_f32 v191, v7, v191
    v_mfma_f32_16x16x32_bf16 v[28:31], a[228:231], a[52:55], v[28:31]
    ds_write_b128 v51, v[188:191] offset:57344
    v_mfma_f32_16x16x32_bf16 v[28:31], a[224:227], a[48:51], v[28:31]
    v_exp_f32 v16, v16
    v_mfma_f32_16x16x32_bf16 v[224:227], a[216:219], v[96:99], v[224:227]
    s_waitcnt lgkmcnt(6)
    v_exp_f32 v17, v17
    v_mfma_f32_16x16x32_bf16 v[224:227], a[244:247], v[100:103], v[224:227]
    v_exp_f32 v18, v18
    v_mfma_f32_16x16x32_bf16 v[228:231], a[244:247], v[108:111], v[228:231]
    v_exp_f32 v19, v19
    v_mfma_f32_16x16x32_bf16 v[228:231], a[216:219], v[104:107], v[228:231]
    v_cvt_pk_bf16_f32 v70, v16, v17
    v_cvt_pk_bf16_f32 v71, v18, v19
    v_mfma_f32_16x16x32_bf16 v[232:235], a[216:219], v[112:115], v[232:235]
    s_waitcnt vmcnt(4) lgkmcnt(0)
    v_exp_f32 v20, v20
    v_mfma_f32_16x16x32_bf16 v[232:235], a[244:247], v[116:119], v[232:235]
    s_barrier
    ds_read_b128 a[224:227], v62 offset:49152
    v_mov_b32 v44, 0
    v_mfma_f32_16x16x32_bf16 v[248:251], a[252:255], v[116:119], v[248:251]
    ds_read_b128 a[228:231], v63 offset:50176
    v_mov_b32 v45, 0
    v_mfma_f32_16x16x32_bf16 v[248:251], a[220:223], v[112:115], v[248:251]
    ds_read_b128 a[232:235], v62 offset:51200
    v_mfma_f32_16x16x32_bf16 v[244:247], a[220:223], v[104:107], v[244:247]
    ds_read_b128 a[236:239], v63 offset:52224
    v_mfma_f32_16x16x32_bf16 v[244:247], a[252:255], v[108:111], v[244:247]
    buffer_load_dwordx4 v0, s[20:23], s39 offen offset:0 lds
    v_mfma_f32_16x16x32_bf16 v[240:243], a[252:255], v[100:103], v[240:243]
    v_exp_f32 v21, v21
    v_mfma_f32_16x16x32_bf16 v[240:243], a[220:223], v[96:99], v[240:243]
    s_waitcnt lgkmcnt(3)
    v_exp_f32 v22, v22
    v_mfma_f32_16x16x32_bf16 v[16:19], a[224:227], a[0:3], -4.0
    s_waitcnt lgkmcnt(2)
    v_exp_f32 v23, v23
    v_cvt_pk_bf16_f32 v78, v20, v21
    v_mfma_f32_16x16x32_bf16 v[16:19], a[228:231], a[4:7], v[16:19]
    s_waitcnt lgkmcnt(1)
    buffer_load_dwordx4 v0, s[20:23], s39 offen offset:1024 lds
    v_mfma_f32_16x16x32_bf16 v[16:19], a[232:235], a[8:11], v[16:19]
    s_waitcnt lgkmcnt(0)
    ds_read_b64_tr_b16 a[240:241], v1 offset:49752
    v_cvt_pk_bf16_f32 v79, v22, v23
    v_mfma_f32_16x16x32_bf16 v[16:19], a[236:239], a[12:15], v[16:19]
    ds_read_b64_tr_b16 a[242:243], v1 offset:50264
    v_exp_f32 v24, v24
    v_mfma_f32_16x16x32_bf16 v[20:23], a[236:239], a[28:31], -4.0
    v_exp_f32 v25, v25
    v_mfma_f32_16x16x32_bf16 v[20:23], a[232:235], a[24:27], v[20:23]
    buffer_load_dwordx4 v0, s[28:31], s39 offen offset:2056 lds
    v_cvt_pk_bf16_f32 v86, v24, v25
    v_mfma_f32_16x16x32_bf16 v[20:23], a[228:231], a[20:23], v[20:23]
    v_exp_f32 v26, v26
    v_exp_f32 v27, v27
    v_mfma_f32_16x16x32_bf16 v[20:23], a[224:227], a[16:19], v[20:23]
    v_cvt_pk_bf16_f32 v87, v26, v27
    v_exp_f32 v28, v28
    v_mfma_f32_16x16x32_bf16 v[24:27], a[224:227], a[32:35], -4.0
    v_exp_f32 v29, v29
    v_mfma_f32_16x16x32_bf16 v[24:27], a[228:231], a[36:39], v[24:27]
    buffer_load_dwordx4 v0, s[28:31], s39 offen offset:3080 lds
    v_cvt_pk_bf16_f32 v94, v28, v29
    v_mfma_f32_16x16x32_bf16 v[24:27], a[232:235], a[40:43], v[24:27]
    v_exp_f32 v30, v30
    v_exp_f32 v31, v31
    v_mfma_f32_16x16x32_bf16 v[24:27], a[236:239], a[44:47], v[24:27]
    s_mov_b32 m0, s99
    ds_read_b64_tr_b16 a[244:245], v1 offset:50776
    ds_read_b64_tr_b16 a[246:247], v1 offset:51288
    v_cvt_pk_bf16_f32 v95, v30, v31
    v_mfma_f32_16x16x32_bf16 v[28:31], a[236:239], a[60:63], -4.0
    v_exp_f32 v16, v16
    v_mfma_f32_16x16x32_bf16 v[28:31], a[232:235], a[56:59], v[28:31]
    v_exp_f32 v17, v17
    v_mfma_f32_16x16x32_bf16 v[28:31], a[228:231], a[52:55], v[28:31]
    ds_read_b64_tr_b16 a[248:249], v1 offset:49760
    ds_read_b64_tr_b16 a[250:251], v1 offset:50272
    v_mfma_f32_16x16x32_bf16 v[28:31], a[224:227], a[48:51], v[28:31]
    v_exp_f32 v18, v18
    v_smfmac_f32_16x16x64_bf16 v[32:35], v[12:15], v[64:71], v57
    s_waitcnt lgkmcnt(4)
    ds_read_b64_tr_b16 a[252:253], v1 offset:50784
    v_mfma_f32_16x16x32_bf16 v[128:131], a[240:243], v[64:67], v[128:131]
    s_waitcnt lgkmcnt(3)
    v_exp_f32 v19, v19
    v_mfma_f32_16x16x32_bf16 v[128:131], a[244:247], v[68:71], v[128:131]
    ds_read_b64_tr_b16 a[254:255], v1 offset:51296
    v_cvt_pk_bf16_f32 v96, v16, v17
    v_mfma_f32_16x16x32_bf16 v[132:135], a[244:247], v[76:79], v[132:135]
    v_exp_f32 v20, v20
    v_mfma_f32_16x16x32_bf16 v[132:135], a[240:243], v[72:75], v[132:135]
    ds_read_b128 a[224:227], v62 offset:53248
    v_cvt_pk_bf16_f32 v97, v18, v19
    v_mfma_f32_16x16x32_bf16 v[136:139], a[240:243], v[80:83], v[136:139]
    v_exp_f32 v21, v21
    v_mfma_f32_16x16x32_bf16 v[136:139], a[244:247], v[84:87], v[136:139]
    ds_read_b128 a[228:231], v63 offset:54272
    v_cvt_pk_bf16_f32 v104, v20, v21
    v_mfma_f32_16x16x32_bf16 v[140:143], a[244:247], v[92:95], 0
    v_exp_f32 v22, v22
    v_mfma_f32_16x16x32_bf16 v[140:143], a[240:243], v[88:91], v[140:143]
    s_waitcnt lgkmcnt(4)
    v_exp_f32 v23, v23
    v_mfma_f32_16x16x32_bf16 v[156:159], a[248:251], v[88:91], 0
    s_waitcnt lgkmcnt(2)
    ds_read_b128 a[232:235], v62 offset:55296
    v_cvt_pk_bf16_f32 v105, v22, v23
    v_mfma_f32_16x16x32_bf16 v[156:159], a[252:255], v[92:95], v[156:159]
    v_exp_f32 v24, v24
    v_mfma_f32_16x16x32_bf16 v[152:155], a[252:255], v[84:87], v[152:155]
    v_exp_f32 v25, v25
    v_mfma_f32_16x16x32_bf16 v[152:155], a[248:251], v[80:83], v[152:155]
    ds_read_b128 a[236:239], v63 offset:56320
    v_cvt_pk_bf16_f32 v112, v24, v25
    v_mfma_f32_16x16x32_bf16 v[148:151], a[248:251], v[72:75], v[148:151]
    v_exp_f32 v26, v26
    v_mfma_f32_16x16x32_bf16 v[148:151], a[252:255], v[76:79], v[148:151]
    v_exp_f32 v27, v27
    v_mfma_f32_16x16x32_bf16 v[144:147], a[252:255], v[68:71], v[144:147]
    ds_read_b64_tr_b16 a[240:241], v1 offset:49816
    v_cvt_pk_bf16_f32 v113, v26, v27
    v_mfma_f32_16x16x32_bf16 v[144:147], a[248:251], v[64:67], v[144:147]
    s_waitcnt lgkmcnt(4)
    v_exp_f32 v28, v28
    v_mfma_f32_16x16x32_bf16 v[16:19], a[224:227], a[0:3], -4.0
    s_waitcnt lgkmcnt(3)
    v_exp_f32 v29, v29
    v_mfma_f32_16x16x32_bf16 v[16:19], a[228:231], a[4:7], v[16:19]
    s_waitcnt lgkmcnt(2)
    v_exp_f32 v30, v30
    v_mfma_f32_16x16x32_bf16 v[16:19], a[232:235], a[8:11], v[16:19]
    s_waitcnt lgkmcnt(1)
    v_exp_f32 v31, v31
    v_mfma_f32_16x16x32_bf16 v[16:19], a[236:239], a[12:15], v[16:19]
    ds_read_b64_tr_b16 a[242:243], v1 offset:50328
    v_cvt_pk_bf16_f32 v120, v28, v29
    v_mfma_f32_16x16x32_bf16 v[20:23], a[236:239], a[28:31], -4.0
    v_cvt_pk_bf16_f32 v121, v30, v31
    v_mfma_f32_16x16x32_bf16 v[20:23], a[232:235], a[24:27], v[20:23]
    ds_read_b64_tr_b16 a[244:245], v1 offset:50840
    ds_read_b64_tr_b16 a[246:247], v1 offset:51352
    v_mfma_f32_16x16x32_bf16 v[20:23], a[228:231], a[20:23], v[20:23]
    v_mfma_f32_16x16x32_bf16 v[20:23], a[224:227], a[16:19], v[20:23]
    ds_read_b64_tr_b16 a[248:249], v1 offset:49824
    ds_read_b64_tr_b16 a[250:251], v1 offset:50336
    v_mfma_f32_16x16x32_bf16 v[24:27], a[224:227], a[32:35], -4.0
    v_exp_f32 v16, v16
    v_mfma_f32_16x16x32_bf16 v[24:27], a[228:231], a[36:39], v[24:27]
    ds_read_b64_tr_b16 a[252:253], v1 offset:50848
    ds_read_b64_tr_b16 a[254:255], v1 offset:51360
    v_mfma_f32_16x16x32_bf16 v[24:27], a[232:235], a[40:43], v[24:27]
    v_exp_f32 v17, v17
    v_mfma_f32_16x16x32_bf16 v[24:27], a[236:239], a[44:47], v[24:27]
    v_exp_f32 v18, v18
    v_mfma_f32_16x16x32_bf16 v[28:31], a[236:239], a[60:63], -4.0
    ds_read_b128 a[236:239], v63 offset:60416
    v_cvt_pk_bf16_f32 v98, v16, v17
    v_mfma_f32_16x16x32_bf16 v[28:31], a[232:235], a[56:59], v[28:31]
    v_exp_f32 v19, v19
    v_mfma_f32_16x16x32_bf16 v[28:31], a[228:231], a[52:55], v[28:31]
    ds_read_b128 a[228:231], v63 offset:58368
    v_cvt_pk_bf16_f32 v99, v18, v19
    v_mfma_f32_16x16x32_bf16 v[28:31], a[224:227], a[48:51], v[28:31]
    v_exp_f32 v20, v20
    v_smfmac_f32_16x16x64_bf16 v[36:39], v[12:15], v[72:79], v57
    s_waitcnt lgkmcnt(8)
    v_mfma_f32_16x16x32_bf16 v[164:167], a[240:243], v[72:75], v[164:167]
    s_waitcnt lgkmcnt(6)
    v_exp_f32 v21, v21
    v_mfma_f32_16x16x32_bf16 v[164:167], a[244:247], v[76:79], v[164:167]
    ds_read_b128 a[224:227], v62 offset:57344
    v_cvt_pk_bf16_f32 v106, v20, v21
    v_mfma_f32_16x16x32_bf16 v[160:163], a[244:247], v[68:71], v[160:163]
    v_exp_f32 v22, v22
    v_mfma_f32_16x16x32_bf16 v[160:163], a[240:243], v[64:67], v[160:163]
    v_exp_f32 v23, v23
    v_mfma_f32_16x16x32_bf16 v[168:171], a[240:243], v[80:83], v[168:171]
    ds_read_b128 a[232:235], v62 offset:59392
    v_cvt_pk_bf16_f32 v107, v22, v23
    v_mfma_f32_16x16x32_bf16 v[168:171], a[244:247], v[84:87], v[168:171]
    v_exp_f32 v24, v24
    v_mfma_f32_16x16x32_bf16 v[172:175], a[244:247], v[92:95], 0
    v_exp_f32 v25, v25
    v_mfma_f32_16x16x32_bf16 v[172:175], a[240:243], v[88:91], v[172:175]
    s_waitcnt lgkmcnt(6)
    v_exp_f32 v26, v26
    v_mfma_f32_16x16x32_bf16 v[188:191], a[248:251], v[88:91], 0
    s_waitcnt lgkmcnt(4)
    v_exp_f32 v27, v27
    v_mfma_f32_16x16x32_bf16 v[188:191], a[252:255], v[92:95], v[188:191]
    v_cvt_pk_bf16_f32 v114, v24, v25
    v_cvt_pk_bf16_f32 v115, v26, v27
    v_mfma_f32_16x16x32_bf16 v[184:187], a[252:255], v[84:87], v[184:187]
    v_exp_f32 v28, v28
    v_mfma_f32_16x16x32_bf16 v[184:187], a[248:251], v[80:83], v[184:187]
    v_exp_f32 v29, v29
    v_mfma_f32_16x16x32_bf16 v[176:179], a[248:251], v[64:67], v[176:179]
    v_exp_f32 v30, v30
    v_mfma_f32_16x16x32_bf16 v[176:179], a[252:255], v[68:71], v[176:179]
    v_exp_f32 v31, v31
    v_mfma_f32_16x16x32_bf16 v[180:183], a[252:255], v[76:79], v[180:183]
    ds_read_b64_tr_b16 a[240:241], v1 offset:49880
    ds_read_b64_tr_b16 a[242:243], v1 offset:50392
    v_mfma_f32_16x16x32_bf16 v[180:183], a[248:251], v[72:75], v[180:183]
    s_waitcnt lgkmcnt(3)
    v_cvt_pk_bf16_f32 v122, v28, v29
    v_cvt_pk_bf16_f32 v123, v30, v31
    v_mfma_f32_16x16x32_bf16 v[16:19], a[224:227], a[0:3], -4.0
    ds_read_b64_tr_b16 a[244:245], v1 offset:50904
    ds_read_b64_tr_b16 a[246:247], v1 offset:51416
    v_mfma_f32_16x16x32_bf16 v[16:19], a[228:231], a[4:7], v[16:19]
    s_waitcnt lgkmcnt(4)
    v_mfma_f32_16x16x32_bf16 v[16:19], a[232:235], a[8:11], v[16:19]
    ds_read_b64_tr_b16 a[248:249], v1 offset:49888
    ds_read_b64_tr_b16 a[250:251], v1 offset:50400
    v_mfma_f32_16x16x32_bf16 v[16:19], a[236:239], a[12:15], v[16:19]
    v_mfma_f32_16x16x32_bf16 v[20:23], a[236:239], a[28:31], -4.0
    ds_read_b64_tr_b16 a[252:253], v1 offset:50912
    ds_read_b64_tr_b16 a[254:255], v1 offset:51424
    v_mfma_f32_16x16x32_bf16 v[20:23], a[232:235], a[24:27], v[20:23]
    v_mfma_f32_16x16x32_bf16 v[20:23], a[228:231], a[20:23], v[20:23]
    s_nop 0
    v_mfma_f32_16x16x32_bf16 v[20:23], a[224:227], a[16:19], v[20:23]
    s_nop 0
    v_exp_f32 v16, v16
    v_mfma_f32_16x16x32_bf16 v[24:27], a[224:227], a[32:35], -4.0
    v_exp_f32 v17, v17
    v_mfma_f32_16x16x32_bf16 v[24:27], a[228:231], a[36:39], v[24:27]
    v_exp_f32 v18, v18
    v_mfma_f32_16x16x32_bf16 v[24:27], a[232:235], a[40:43], v[24:27]
    v_exp_f32 v19, v19
    v_mfma_f32_16x16x32_bf16 v[24:27], a[236:239], a[44:47], v[24:27]
    v_cvt_pk_bf16_f32 v100, v16, v17
    v_cvt_pk_bf16_f32 v101, v18, v19
    v_mfma_f32_16x16x32_bf16 v[28:31], a[236:239], a[60:63], -4.0
    v_exp_f32 v20, v20
    v_mfma_f32_16x16x32_bf16 v[28:31], a[232:235], a[56:59], v[28:31]
    v_exp_f32 v21, v21
    v_mfma_f32_16x16x32_bf16 v[28:31], a[228:231], a[52:55], v[28:31]
    ds_read_b128 a[228:231], v63 offset:62464
    v_cvt_pk_bf16_f32 v108, v20, v21
    v_mfma_f32_16x16x32_bf16 v[28:31], a[224:227], a[48:51], v[28:31]
    v_exp_f32 v22, v22
    v_smfmac_f32_16x16x64_bf16 v[40:43], v[12:15], v[80:87], v57
    s_waitcnt lgkmcnt(7)
    v_mfma_f32_16x16x32_bf16 v[200:203], a[240:243], v[80:83], v[200:203]
    s_waitcnt lgkmcnt(5)
    v_exp_f32 v23, v23
    v_mfma_f32_16x16x32_bf16 v[200:203], a[244:247], v[84:87], v[200:203]
    ds_read_b128 a[224:227], v62 offset:61440
    v_cvt_pk_bf16_f32 v109, v22, v23
    v_mfma_f32_16x16x32_bf16 v[192:195], a[244:247], v[68:71], v[192:195]
    v_exp_f32 v24, v24
    v_mfma_f32_16x16x32_bf16 v[192:195], a[240:243], v[64:67], v[192:195]
    v_exp_f32 v25, v25
    v_mfma_f32_16x16x32_bf16 v[196:199], a[240:243], v[72:75], v[196:199]
    ds_read_b128 a[232:235], v62 offset:63488
    v_cvt_pk_bf16_f32 v116, v24, v25
    v_mfma_f32_16x16x32_bf16 v[196:199], a[244:247], v[76:79], v[196:199]
    v_exp_f32 v26, v26
    v_mfma_f32_16x16x32_bf16 v[204:207], a[244:247], v[92:95], 0
    v_exp_f32 v27, v27
    v_mfma_f32_16x16x32_bf16 v[204:207], a[240:243], v[88:91], v[204:207]
    s_waitcnt lgkmcnt(5)
    ds_read_b128 a[236:239], v63 offset:64512
    v_cvt_pk_bf16_f32 v117, v26, v27
    v_mfma_f32_16x16x32_bf16 v[220:223], a[248:251], v[88:91], 0
    s_waitcnt lgkmcnt(4)
    v_exp_f32 v28, v28
    v_mfma_f32_16x16x32_bf16 v[220:223], a[252:255], v[92:95], v[220:223]
    v_exp_f32 v29, v29
    v_mfma_f32_16x16x32_bf16 v[212:215], a[252:255], v[76:79], v[212:215]
    v_exp_f32 v30, v30
    v_mfma_f32_16x16x32_bf16 v[212:215], a[248:251], v[72:75], v[212:215]
    v_exp_f32 v31, v31
    v_mfma_f32_16x16x32_bf16 v[208:211], a[248:251], v[64:67], v[208:211]
    ds_read_b64_tr_b16 a[240:241], v1 offset:49944
    ds_read_b64_tr_b16 a[242:243], v1 offset:50456
    v_mfma_f32_16x16x32_bf16 v[208:211], a[252:255], v[68:71], v[208:211]
    v_cvt_pk_bf16_f32 v124, v28, v29
    v_cvt_pk_bf16_f32 v125, v30, v31
    v_mfma_f32_16x16x32_bf16 v[216:219], a[252:255], v[84:87], v[216:219]
    ds_read_b64_tr_b16 a[244:245], v1 offset:50968
    ds_read_b64_tr_b16 a[246:247], v1 offset:51480
    v_mfma_f32_16x16x32_bf16 v[216:219], a[248:251], v[80:83], v[216:219]
    s_waitcnt lgkmcnt(6)
    v_mfma_f32_16x16x32_bf16 v[16:19], a[224:227], a[0:3], -4.0
    s_waitcnt vmcnt(4)
    ds_read_b128 a[0:3], v3 offset:0
    v_mfma_f32_16x16x32_bf16 v[16:19], a[228:231], a[4:7], v[16:19]
    s_waitcnt lgkmcnt(6)
    v_mfma_f32_16x16x32_bf16 v[16:19], a[232:235], a[8:11], v[16:19]
    s_waitcnt lgkmcnt(5)
    ds_read_b128 a[4:7], v3 offset:64
    v_mfma_f32_16x16x32_bf16 v[16:19], a[236:239], a[12:15], v[16:19]
    v_mfma_f32_16x16x32_bf16 v[20:23], a[236:239], a[28:31], -4.0
    ds_read_b128 a[8:11], v3 offset:128
    v_mfma_f32_16x16x32_bf16 v[20:23], a[232:235], a[24:27], v[20:23]
    v_mfma_f32_16x16x32_bf16 v[20:23], a[228:231], a[20:23], v[20:23]
    s_nop 0
    ds_read_b128 a[12:15], v3 offset:192
    v_mfma_f32_16x16x32_bf16 v[20:23], a[224:227], a[16:19], v[20:23]
    s_nop 0
    v_exp_f32 v16, v16
    v_mfma_f32_16x16x32_bf16 v[24:27], a[224:227], a[32:35], -4.0
    ds_read_b64_tr_b16 a[248:249], v1 offset:49952
    ds_read_b64_tr_b16 a[250:251], v1 offset:50464
    v_mfma_f32_16x16x32_bf16 v[24:27], a[228:231], a[36:39], v[24:27]
    v_exp_f32 v17, v17
    v_mfma_f32_16x16x32_bf16 v[24:27], a[232:235], a[40:43], v[24:27]
    ds_read_b64_tr_b16 a[252:253], v1 offset:50976
    ds_read_b64_tr_b16 a[254:255], v1 offset:51488
    v_mfma_f32_16x16x32_bf16 v[24:27], a[236:239], a[44:47], v[24:27]
    v_exp_f32 v18, v18
    v_mfma_f32_16x16x32_bf16 v[28:31], a[236:239], a[60:63], -4.0
    v_exp_f32 v19, v19
    v_mfma_f32_16x16x32_bf16 v[28:31], a[232:235], a[56:59], v[28:31]
    v_exp_f32 v20, v20
    v_mfma_f32_16x16x32_bf16 v[28:31], a[228:231], a[52:55], v[28:31]
    v_exp_f32 v21, v21
    v_mfma_f32_16x16x32_bf16 v[28:31], a[224:227], a[48:51], v[28:31]
    v_exp_f32 v22, v22
    v_smfmac_f32_16x16x64_bf16 v[44:47], v[12:15], v[88:95], v57
    s_waitcnt lgkmcnt(10)
    v_cvt_pk_bf16_f32 v102, v16, v17
    v_mfma_f32_16x16x32_bf16 v[236:239], a[240:243], v[88:91], 0
    s_waitcnt lgkmcnt(8)
    v_exp_f32 v23, v23
    v_mfma_f32_16x16x32_bf16 v[236:239], a[244:247], v[92:95], v[236:239]
    v_exp_f32 v24, v24
    v_mfma_f32_16x16x32_bf16 v[224:227], a[244:247], v[68:71], v[224:227]
    v_exp_f32 v25, v25
    v_mfma_f32_16x16x32_bf16 v[224:227], a[240:243], v[64:67], v[224:227]
    v_exp_f32 v26, v26
    v_mfma_f32_16x16x32_bf16 v[228:231], a[240:243], v[72:75], v[228:231]
    v_exp_f32 v27, v27
    v_mfma_f32_16x16x32_bf16 v[228:231], a[244:247], v[76:79], v[228:231]
    v_cvt_pk_bf16_f32 v103, v18, v19
    v_cvt_pk_bf16_f32 v110, v20, v21
    v_mfma_f32_16x16x32_bf16 v[232:235], a[244:247], v[84:87], v[232:235]
    s_waitcnt vmcnt(0) lgkmcnt(0)
    v_exp_f32 v28, v28
    v_mfma_f32_16x16x32_bf16 v[232:235], a[240:243], v[80:83], v[232:235]
    s_barrier
    buffer_load_dwordx4 v0, s[20:23], s32 offen offset:0 lds
    v_mfma_f32_16x16x32_bf16 v[248:251], a[248:251], v[80:83], v[248:251]
    v_cvt_pk_bf16_f32 v111, v22, v23
    v_cvt_pk_bf16_f32 v118, v24, v25
    v_mfma_f32_16x16x32_bf16 v[248:251], a[252:255], v[84:87], v[248:251]
    v_exp_f32 v29, v29
    v_mfma_f32_16x16x32_bf16 v[244:247], a[252:255], v[76:79], v[244:247]
    ds_read_b64_tr_b16 a[240:241], v1 offset:33168
    v_cvt_pk_bf16_f32 v119, v26, v27
    v_mfma_f32_16x16x32_bf16 v[244:247], a[248:251], v[72:75], v[244:247]
    v_exp_f32 v30, v30
    v_mfma_f32_16x16x32_bf16 v[240:243], a[248:251], v[64:67], v[240:243]
    buffer_load_dwordx4 v0, s[20:23], s32 offen offset:1024 lds
    v_mfma_f32_16x16x32_bf16 v[240:243], a[252:255], v[68:71], v[240:243]
    v_exp_f32 v31, v31
    v_mfma_f32_16x16x32_bf16 v[252:255], a[252:255], v[92:95], 0
    ds_read_b64_tr_b16 a[242:243], v1 offset:33680
    v_mfma_f32_16x16x32_bf16 v[252:255], a[248:251], v[88:91], v[252:255]
    ds_read_b128 a[232:235], v60 offset:17632
L_loop:
    v_mfma_f32_16x16x32_bf16 v[16:19], a[64:67], a[16:19], -4.0
    v_cvt_pk_bf16_f32 v126, v28, v29
    v_cvt_pk_bf16_f32 v127, v30, v31
    v_mfma_f32_16x16x32_bf16 v[16:19], a[68:71], a[20:23], v[16:19]
    buffer_load_dwordx4 v0, s[28:31], s32 offen offset:2056 lds
    v_mfma_f32_16x16x32_bf16 v[16:19], a[72:75], a[24:27], v[16:19]
L_hop4:
    s_cbranch_execz L_hop8
    ds_read_b64_tr_b16 a[244:245], v1 offset:34192
    ds_read_b64_tr_b16 a[246:247], v1 offset:34704
    v_mfma_f32_16x16x32_bf16 v[16:19], a[76:79], a[28:31], v[16:19]
    v_mfma_f32_16x16x32_bf16 v[20:23], a[76:79], a[44:47], -4.0
    ds_read_b64_tr_b16 a[248:249], v1 offset:33176
    ds_read_b64_tr_b16 a[250:251], v1 offset:33688
    v_mfma_f32_16x16x32_bf16 v[20:23], a[72:75], a[40:43], v[20:23]
    v_mfma_f32_16x16x32_bf16 v[20:23], a[68:71], a[36:39], v[20:23]
    buffer_load_dwordx4 v0, s[28:31], s32 offen offset:3080 lds
    v_mfma_f32_16x16x32_bf16 v[20:23], a[64:67], a[32:35], v[20:23]
    s_mov_b32 m0, s76
    ds_read_b64_tr_b16 a[252:253], v1 offset:34200
    ds_read_b64_tr_b16 a[254:255], v1 offset:34712
    v_mfma_f32_16x16x32_bf16 v[24:27], a[64:67], a[48:51], -4.0
    v_exp_f32 v16, v16
    v_mfma_f32_16x16x32_bf16 v[24:27], a[68:71], a[52:55], v[24:27]
    v_exp_f32 v17, v17
    v_mfma_f32_16x16x32_bf16 v[24:27], a[72:75], a[56:59], v[24:27]
    v_exp_f32 v18, v18
    v_mfma_f32_16x16x32_bf16 v[24:27], a[76:79], a[60:63], v[24:27]
    buffer_load_dwordx4 v0, s[12:15], s42 offen offset:0 nt lds
    v_mfma_f32_16x16x32_bf16 v[28:31], a[76:79], a[12:15], -4.0
    s_mov_b32 m0, s77
    v_exp_f32 v19, v19
    v_mfma_f32_16x16x32_bf16 v[28:31], a[72:75], a[8:11], v[28:31]
    v_cvt_pk_bf16_f32 v72, v16, v17
    v_cvt_pk_bf16_f32 v73, v18, v19
    v_mfma_f32_16x16x32_bf16 v[28:31], a[68:71], a[4:7], v[28:31]
    v_exp_f32 v20, v20
    v_mfma_f32_16x16x32_bf16 v[28:31], a[64:67], a[0:3], v[28:31]
    v_exp_f32 v21, v21
    v_smfmac_f32_16x16x64_bf16 v[32:35], v[12:15], v[96:103], v57
    s_waitcnt lgkmcnt(6)
    v_cvt_pk_bf16_f32 v80, v20, v21
    v_mfma_f32_16x16x32_bf16 v[128:131], a[240:243], v[96:99], v[128:131]
    s_waitcnt lgkmcnt(4)
    buffer_load_dwordx4 v0, s[12:15], s42 offen offset:1024 nt lds
    v_mfma_f32_16x16x32_bf16 v[128:131], a[244:247], v[100:103], v[128:131]
    v_exp_f32 v22, v22
    v_mfma_f32_16x16x32_bf16 v[132:135], a[244:247], v[108:111], v[132:135]
    v_exp_f32 v23, v23
    v_mfma_f32_16x16x32_bf16 v[132:135], a[240:243], v[104:107], v[132:135]
    s_mov_b32 m0, s78
    ds_read_b128 a[236:239], v61 offset:18656
    v_cvt_pk_bf16_f32 v81, v22, v23
    v_mfma_f32_16x16x32_bf16 v[136:139], a[240:243], v[112:115], v[136:139]
    v_exp_f32 v24, v24
    v_mfma_f32_16x16x32_bf16 v[136:139], a[244:247], v[116:119], v[136:139]
    buffer_load_dwordx4 v0, s[12:15], s42 offen offset:2048 nt lds
    v_mfma_f32_16x16x32_bf16 v[140:143], a[244:247], v[124:127], v[140:143]
    s_mov_b32 m0, s79
    v_exp_f32 v25, v25
    v_mfma_f32_16x16x32_bf16 v[140:143], a[240:243], v[120:123], v[140:143]
    s_waitcnt lgkmcnt(3)
    v_exp_f32 v26, v26
    v_mfma_f32_16x16x32_bf16 v[156:159], a[248:251], v[120:123], v[156:159]
    s_waitcnt lgkmcnt(1)
    v_exp_f32 v27, v27
    v_mfma_f32_16x16x32_bf16 v[156:159], a[252:255], v[124:127], v[156:159]
    v_cvt_pk_bf16_f32 v88, v24, v25
    v_cvt_pk_bf16_f32 v89, v26, v27
    v_mfma_f32_16x16x32_bf16 v[152:155], a[252:255], v[116:119], v[152:155]
    v_exp_f32 v28, v28
    v_mfma_f32_16x16x32_bf16 v[152:155], a[248:251], v[112:115], v[152:155]
    buffer_load_dwordx4 v0, s[12:15], s42 offen offset:3072 nt lds
    v_mfma_f32_16x16x32_bf16 v[148:151], a[248:251], v[104:107], v[148:151]
    v_exp_f32 v29, v29
    v_mfma_f32_16x16x32_bf16 v[148:151], a[252:255], v[108:111], v[148:151]
    v_exp_f32 v30, v30
    v_mfma_f32_16x16x32_bf16 v[144:147], a[252:255], v[100:103], v[144:147]
    v_exp_f32 v31, v31
    v_mfma_f32_16x16x32_bf16 v[144:147], a[248:251], v[96:99], v[144:147]
    s_add_u32 s42, s42, 4096
    ds_read_b64_tr_b16 a[240:241], v1 offset:33232
    ds_read_b64_tr_b16 a[242:243], v1 offset:33744
    v_mfma_f32_16x16x32_bf16 v[16:19], a[80:83], a[0:3], -4.0
    v_cvt_pk_bf16_f32 v64, v28, v29
    v_cvt_pk_bf16_f32 v65, v30, v31
    v_mfma_f32_16x16x32_bf16 v[16:19], a[84:87], a[4:7], v[16:19]
    s_mov_b32 m0, s98
    ds_read_b64_tr_b16 a[244:245], v1 offset:34256
    ds_read_b64_tr_b16 a[246:247], v1 offset:34768
    v_mfma_f32_16x16x32_bf16 v[16:19], a[88:91], a[8:11], v[16:19]
    v_add_f32 v32, v32, v33
    v_mov_b32 v33, 0
    v_mfma_f32_16x16x32_bf16 v[16:19], a[92:95], a[12:15], v[16:19]
    v_rcp_f32 v48, v32
    v_mfma_f32_16x16x32_bf16 v[20:23], a[92:95], a[28:31], -4.0
    ds_read_b64_tr_b16 a[248:249], v1 offset:33240
    ds_read_b64_tr_b16 a[250:251], v1 offset:33752
    v_mfma_f32_16x16x32_bf16 v[20:23], a[88:91], a[24:27], v[20:23]
    v_max3_u32 v58, v58, v32, v48
    v_mov_b32 v32, 0
    v_mfma_f32_16x16x32_bf16 v[20:23], a[84:87], a[20:23], v[20:23]
    ds_read_b64_tr_b16 a[252:253], v1 offset:34264
    ds_read_b64_tr_b16 a[254:255], v1 offset:34776
    v_mfma_f32_16x16x32_bf16 v[20:23], a[80:83], a[16:19], v[20:23]
    v_exp_f32 v16, v16
    v_mfma_f32_16x16x32_bf16 v[24:27], a[80:83], a[32:35], -4.0
    v_exp_f32 v17, v17
    v_mfma_f32_16x16x32_bf16 v[24:27], a[84:87], a[36:39], v[24:27]
    v_exp_f32 v18, v18
    v_mfma_f32_16x16x32_bf16 v[24:27], a[88:91], a[40:43], v[24:27]
    v_exp_f32 v19, v19
    v_mfma_f32_16x16x32_bf16 v[24:27], a[92:95], a[44:47], v[24:27]
    v_cvt_pk_bf16_f32 v66, v16, v17
    v_cvt_pk_bf16_f32 v67, v18, v19
    v_mfma_f32_16x16x32_bf16 v[28:31], a[92:95], a[60:63], -4.0
    v_exp_f32 v20, v20
    v_mfma_f32_16x16x32_bf16 v[28:31], a[88:91], a[56:59], v[28:31]
    v_exp_f32 v21, v21
    v_mfma_f32_16x16x32_bf16 v[28:31], a[84:87], a[52:55], v[28:31]
    v_exp_f32 v22, v22
    v_mfma_f32_16x16x32_bf16 v[28:31], a[80:83], a[48:51], v[28:31]
    v_exp_f32 v23, v23
    v_smfmac_f32_16x16x64_bf16 v[36:39], v[12:15], v[104:111], v57
    s_waitcnt lgkmcnt(6)
    v_cvt_pk_bf16_f32 v74, v20, v21
    v_mfma_f32_16x16x32_bf16 v[164:167], a[240:243], v[104:107], v[164:167]
    s_waitcnt lgkmcnt(4)
    v_cvt_pk_bf16_f32 v75, v22, v23
    v_mul_f32 v128, v128, v48
    v_mfma_f32_16x16x32_bf16 v[164:167], a[244:247], v[108:111], v[164:167]
    v_exp_f32 v24, v24
    v_mfma_f32_16x16x32_bf16 v[160:163], a[244:247], v[100:103], v[160:163]
    v_exp_f32 v25, v25
    v_mfma_f32_16x16x32_bf16 v[160:163], a[240:243], v[96:99], v[160:163]
    v_exp_f32 v26, v26
    v_mfma_f32_16x16x32_bf16 v[168:171], a[240:243], v[112:115], v[168:171]
    v_exp_f32 v27, v27
    v_mfma_f32_16x16x32_bf16 v[168:171], a[244:247], v[116:119], v[168:171]
    v_cvt_pk_bf16_f32 v82, v24, v25
    v_cvt_pk_bf16_f32 v83, v26, v27
    v_mfma_f32_16x16x32_bf16 v[172:175], a[244:247], v[124:127], v[172:175]
    v_exp_f32 v28, v28
    v_mfma_f32_16x16x32_bf16 v[172:175], a[240:243], v[120:123], v[172:175]
    s_waitcnt lgkmcnt(2)
    v_exp_f32 v29, v29
    v_mfma_f32_16x16x32_bf16 v[188:191], a[248:251], v[120:123], v[188:191]
    s_waitcnt lgkmcnt(0)
    v_exp_f32 v30, v30
    v_mfma_f32_16x16x32_bf16 v[188:191], a[252:255], v[124:127], v[188:191]
    v_exp_f32 v31, v31
    v_mfma_f32_16x16x32_bf16 v[184:187], a[252:255], v[116:119], v[184:187]
    ds_read_b64_tr_b16 a[240:241], v1 offset:33296
    ds_read_b64_tr_b16 a[242:243], v1 offset:33808
    v_mfma_f32_16x16x32_bf16 v[184:187], a[248:251], v[112:115], v[184:187]
    v_cvt_pk_bf16_f32 v90, v28, v29
    v_cvt_pk_bf16_f32 v91, v30, v31
    v_mfma_f32_16x16x32_bf16 v[176:179], a[248:251], v[96:99], v[176:179]
    ds_read_b64_tr_b16 a[244:245], v1 offset:34320
    ds_read_b64_tr_b16 a[246:247], v1 offset:34832
    v_mfma_f32_16x16x32_bf16 v[176:179], a[252:255], v[100:103], v[176:179]
    v_mul_f32 v129, v129, v48
    v_mul_f32 v130, v130, v48
    v_mfma_f32_16x16x32_bf16 v[180:183], a[252:255], v[108:111], v[180:183]
    ds_read_b64_tr_b16 a[252:253], v1 offset:34328
    ds_read_b64_tr_b16 a[254:255], v1 offset:34840
    v_mfma_f32_16x16x32_bf16 v[180:183], a[248:251], v[104:107], v[180:183]
    v_mul_f32 v131, v131, v48
    v_mul_f32 v144, v144, v48
    v_mfma_f32_16x16x32_bf16 v[16:19], a[96:99], a[0:3], -4.0
    ds_read_b64_tr_b16 a[248:249], v1 offset:33304
    ds_read_b64_tr_b16 a[250:251], v1 offset:33816
    v_mfma_f32_16x16x32_bf16 v[16:19], a[100:103], a[4:7], v[16:19]
    v_mul_f32 v145, v145, v48
    v_mul_f32 v146, v146, v48
    v_mfma_f32_16x16x32_bf16 v[16:19], a[104:107], a[8:11], v[16:19]
    v_mul_f32 v147, v147, v48
    v_cvt_pk_bf16_f32 v147, v146, v147
    v_mfma_f32_16x16x32_bf16 v[16:19], a[108:111], a[12:15], v[16:19]
    v_cvt_pk_bf16_f32 v146, v144, v145
    v_cvt_pk_bf16_f32 v144, v128, v129
    v_mfma_f32_16x16x32_bf16 v[20:23], a[108:111], a[28:31], -4.0
    v_cvt_pk_bf16_f32 v145, v130, v131
    v_mul_f32 v160, v160, v48
    v_mfma_f32_16x16x32_bf16 v[20:23], a[104:107], a[24:27], v[20:23]
    v_mul_f32 v161, v161, v48
    v_mul_f32 v162, v162, v48
    v_mfma_f32_16x16x32_bf16 v[20:23], a[100:103], a[20:23], v[20:23]
    v_mul_f32 v163, v163, v48
    v_mul_f32 v176, v176, v48
    v_mfma_f32_16x16x32_bf16 v[20:23], a[96:99], a[16:19], v[20:23]
    v_exp_f32 v16, v16
    v_mfma_f32_16x16x32_bf16 v[24:27], a[96:99], a[32:35], -4.0
    v_exp_f32 v17, v17
    v_mfma_f32_16x16x32_bf16 v[24:27], a[100:103], a[36:39], v[24:27]
    v_exp_f32 v18, v18
    v_mfma_f32_16x16x32_bf16 v[24:27], a[104:107], a[40:43], v[24:27]
    v_exp_f32 v19, v19
    v_mfma_f32_16x16x32_bf16 v[24:27], a[108:111], a[44:47], v[24:27]
    v_cvt_pk_bf16_f32 v68, v16, v17
    v_cvt_pk_bf16_f32 v69, v18, v19
    v_mfma_f32_16x16x32_bf16 v[28:31], a[108:111], a[60:63], -4.0
    v_exp_f32 v20, v20
    v_mfma_f32_16x16x32_bf16 v[28:31], a[104:107], a[56:59], v[28:31]
    v_exp_f32 v21, v21
    v_mfma_f32_16x16x32_bf16 v[28:31], a[100:103], a[52:55], v[28:31]
    v_exp_f32 v22, v22
    v_mfma_f32_16x16x32_bf16 v[28:31], a[96:99], a[48:51], v[28:31]
    v_exp_f32 v23, v23
    v_smfmac_f32_16x16x64_bf16 v[40:43], v[12:15], v[112:119], v57
    s_waitcnt lgkmcnt(6)
    v_cvt_pk_bf16_f32 v76, v20, v21
    v_mfma_f32_16x16x32_bf16 v[200:203], a[240:243], v[112:115], v[200:203]
    s_waitcnt lgkmcnt(4)
    v_cvt_pk_bf16_f32 v77, v22, v23
    v_mul_f32 v177, v177, v48
    v_mfma_f32_16x16x32_bf16 v[200:203], a[244:247], v[116:119], v[200:203]
    v_exp_f32 v24, v24
    v_mfma_f32_16x16x32_bf16 v[192:195], a[244:247], v[100:103], v[192:195]
    v_exp_f32 v25, v25
    v_mfma_f32_16x16x32_bf16 v[192:195], a[240:243], v[96:99], v[192:195]
    v_exp_f32 v26, v26
    v_mfma_f32_16x16x32_bf16 v[196:199], a[240:243], v[104:107], v[196:199]
    v_exp_f32 v27, v27
    v_mfma_f32_16x16x32_bf16 v[196:199], a[244:247], v[108:111], v[196:199]
    v_cvt_pk_bf16_f32 v84, v24, v25
    v_cvt_pk_bf16_f32 v85, v26, v27
    v_mfma_f32_16x16x32_bf16 v[204:207], a[244:247], v[124:127], v[204:207]
    v_exp_f32 v28, v28
    v_mfma_f32_16x16x32_bf16 v[204:207], a[240:243], v[120:123], v[204:207]
    s_waitcnt lgkmcnt(0)
    v_exp_f32 v29, v29
    v_mfma_f32_16x16x32_bf16 v[220:223], a[248:251], v[120:123], v[220:223]
    v_exp_f32 v30, v30
    v_mfma_f32_16x16x32_bf16 v[220:223], a[252:255], v[124:127], v[220:223]
    v_exp_f32 v31, v31
    v_mfma_f32_16x16x32_bf16 v[212:215], a[252:255], v[108:111], v[212:215]
    ds_read_b64_tr_b16 a[240:241], v1 offset:33360
    ds_read_b64_tr_b16 a[242:243], v1 offset:33872
    v_mfma_f32_16x16x32_bf16 v[212:215], a[248:251], v[104:107], v[212:215]
    v_cvt_pk_bf16_f32 v92, v28, v29
    v_cvt_pk_bf16_f32 v93, v30, v31
    v_mfma_f32_16x16x32_bf16 v[208:211], a[248:251], v[96:99], v[208:211]
    ds_read_b64_tr_b16 a[244:245], v1 offset:34384
    ds_read_b64_tr_b16 a[246:247], v1 offset:34896
    v_mfma_f32_16x16x32_bf16 v[208:211], a[252:255], v[100:103], v[208:211]
    v_mul_f32 v178, v178, v48
    v_mul_f32 v179, v179, v48
    v_mfma_f32_16x16x32_bf16 v[216:219], a[252:255], v[116:119], v[216:219]
    ds_read_b64_tr_b16 a[252:253], v1 offset:34392
    ds_read_b64_tr_b16 a[254:255], v1 offset:34904
    v_mfma_f32_16x16x32_bf16 v[216:219], a[248:251], v[112:115], v[216:219]
    v_cvt_pk_bf16_f32 v179, v178, v179
    v_cvt_pk_bf16_f32 v178, v176, v177
    v_mfma_f32_16x16x32_bf16 v[16:19], a[112:115], a[0:3], -4.0
    ds_read_b64_tr_b16 a[248:249], v1 offset:33368
    ds_read_b64_tr_b16 a[250:251], v1 offset:33880
    v_mfma_f32_16x16x32_bf16 v[16:19], a[116:119], a[4:7], v[16:19]
    v_cvt_pk_bf16_f32 v176, v160, v161
    v_cvt_pk_bf16_f32 v177, v162, v163
    v_mfma_f32_16x16x32_bf16 v[16:19], a[120:123], a[8:11], v[16:19]
    ds_read_b128 a[224:227], v60 offset:19680
    v_cndmask_b32_dpp v162, v146, v178, vcc row_ror:8 row_mask:0xf bank_mask:0xf
    v_mfma_f32_16x16x32_bf16 v[16:19], a[124:127], a[12:15], v[16:19]
    v_cndmask_b32_dpp v160, v144, v176, vcc row_ror:8 row_mask:0xf bank_mask:0xf
    v_mov_b32_dpp v144, v176 row_ror:8 row_mask:0xf bank_mask:0xc
    v_mfma_f32_16x16x32_bf16 v[20:23], a[124:127], a[28:31], -4.0
    ds_read_b128 a[228:231], v61 offset:20704
    v_cndmask_b32_dpp v161, v145, v177, vcc row_ror:8 row_mask:0xf bank_mask:0xf
    v_mfma_f32_16x16x32_bf16 v[20:23], a[120:123], a[24:27], v[20:23]
    v_mov_b32_dpp v145, v177 row_ror:8 row_mask:0xf bank_mask:0xc
    v_mov_b32_dpp v146, v178 row_ror:8 row_mask:0xf bank_mask:0xc
    v_mfma_f32_16x16x32_bf16 v[20:23], a[116:119], a[20:23], v[20:23]
    v_cndmask_b32_dpp v163, v147, v179, vcc row_ror:8 row_mask:0xf bank_mask:0xf
    v_mov_b32_dpp v147, v179 row_ror:8 row_mask:0xf bank_mask:0xc
    v_mfma_f32_16x16x32_bf16 v[20:23], a[112:115], a[16:19], v[20:23]
    v_exp_f32 v16, v16
    v_mfma_f32_16x16x32_bf16 v[24:27], a[112:115], a[32:35], -4.0
    v_exp_f32 v17, v17
    v_mfma_f32_16x16x32_bf16 v[24:27], a[116:119], a[36:39], v[24:27]
    v_exp_f32 v18, v18
    v_mfma_f32_16x16x32_bf16 v[24:27], a[120:123], a[40:43], v[24:27]
    v_exp_f32 v19, v19
    v_mfma_f32_16x16x32_bf16 v[24:27], a[124:127], a[44:47], v[24:27]
    v_exp_f32 v20, v20
    v_mfma_f32_16x16x32_bf16 v[28:31], a[124:127], a[60:63], -4.0
    v_exp_f32 v21, v21
    v_mfma_f32_16x16x32_bf16 v[28:31], a[120:123], a[56:59], v[28:31]
    v_exp_f32 v22, v22
    v_mfma_f32_16x16x32_bf16 v[28:31], a[116:119], a[52:55], v[28:31]
    buffer_store_dwordx4 v[144:147], v2, s[24:27], s43 offen offset:0 sc1
    v_mfma_f32_16x16x32_bf16 v[28:31], a[112:115], a[48:51], v[28:31]
    v_cvt_pk_bf16_f32 v70, v16, v17
    v_cvt_pk_bf16_f32 v71, v18, v19
    v_smfmac_f32_16x16x64_bf16 v[44:47], v[12:15], v[120:127], v57
    s_waitcnt lgkmcnt(8)
    v_cvt_pk_bf16_f32 v78, v20, v21
    v_mfma_f32_16x16x32_bf16 v[236:239], a[240:243], v[120:123], v[236:239]
    s_waitcnt lgkmcnt(6)
    v_exp_f32 v23, v23
    v_mfma_f32_16x16x32_bf16 v[236:239], a[244:247], v[124:127], v[236:239]
    v_cvt_pk_bf16_f32 v79, v22, v23
    v_mul_f32 v192, v192, v48
    v_mfma_f32_16x16x32_bf16 v[224:227], a[244:247], v[100:103], v[224:227]
    v_exp_f32 v24, v24
    v_mfma_f32_16x16x32_bf16 v[224:227], a[240:243], v[96:99], v[224:227]
    v_exp_f32 v25, v25
    v_mfma_f32_16x16x32_bf16 v[228:231], a[240:243], v[104:107], v[228:231]
    v_exp_f32 v26, v26
    v_mfma_f32_16x16x32_bf16 v[228:231], a[244:247], v[108:111], v[228:231]
    v_exp_f32 v27, v27
    v_mfma_f32_16x16x32_bf16 v[232:235], a[244:247], v[116:119], v[232:235]
    s_waitcnt vmcnt(5) lgkmcnt(2)
    v_cvt_pk_bf16_f32 v86, v24, v25
    v_cvt_pk_bf16_f32 v87, v26, v27
    v_mfma_f32_16x16x32_bf16 v[232:235], a[240:243], v[112:115], v[232:235]
    s_barrier
    v_exp_f32 v28, v28
    v_mfma_f32_16x16x32_bf16 v[248:251], a[248:251], v[112:115], v[248:251]
    buffer_load_dwordx4 v0, s[20:23], s33 offen offset:0 lds
    v_mfma_f32_16x16x32_bf16 v[248:251], a[252:255], v[116:119], v[248:251]
    v_exp_f32 v29, v29
    v_mfma_f32_16x16x32_bf16 v[244:247], a[252:255], v[108:111], v[244:247]
    v_exp_f32 v30, v30
    v_mfma_f32_16x16x32_bf16 v[244:247], a[248:251], v[104:107], v[244:247]
    v_exp_f32 v31, v31
    v_mfma_f32_16x16x32_bf16 v[240:243], a[248:251], v[96:99], v[240:243]
    ds_read_b64_tr_b16 a[240:241], v1 offset:49752
    ds_read_b64_tr_b16 a[242:243], v1 offset:50264
    v_mfma_f32_16x16x32_bf16 v[240:243], a[252:255], v[100:103], v[240:243]
    buffer_load_dwordx4 v0, s[20:23], s33 offen offset:1024 lds
    v_mfma_f32_16x16x32_bf16 v[252:255], a[252:255], v[124:127], v[252:255]
    v_cvt_pk_bf16_f32 v94, v28, v29
    v_cvt_pk_bf16_f32 v95, v30, v31
    v_mfma_f32_16x16x32_bf16 v[252:255], a[248:251], v[120:123], v[252:255]
    ds_read_b64_tr_b16 a[244:245], v1 offset:50776
    ds_read_b64_tr_b16 a[246:247], v1 offset:51288
    v_mfma_f32_16x16x32_bf16 v[16:19], v[52:55], a[0:3], -4.0
    v_mul_f32 v193, v193, v48
    v_mul_f32 v194, v194, v48
    v_mfma_f32_16x16x32_bf16 v[16:19], v[8:11], a[4:7], v[16:19]
    ds_read_b64_tr_b16 a[248:249], v1 offset:49760
    ds_read_b64_tr_b16 a[250:251], v1 offset:50272
    v_mfma_f32_16x16x32_bf16 v[16:19], a[232:235], a[8:11], v[16:19]
    buffer_load_dwordx4 v0, s[28:31], s33 offen offset:2056 lds
    v_mfma_f32_16x16x32_bf16 v[16:19], a[236:239], a[12:15], v[16:19]
    ds_read_b64_tr_b16 a[252:253], v1 offset:50784
    ds_read_b64_tr_b16 a[254:255], v1 offset:51296
    v_mfma_f32_16x16x32_bf16 v[20:23], a[236:239], a[28:31], -4.0
    v_mul_f32 v195, v195, v48
    v_mul_f32 v208, v208, v48
    v_mfma_f32_16x16x32_bf16 v[20:23], a[232:235], a[24:27], v[20:23]
    v_mul_f32 v209, v209, v48
    v_mul_f32 v210, v210, v48
    v_mfma_f32_16x16x32_bf16 v[20:23], v[8:11], a[20:23], v[20:23]
    v_mul_f32 v211, v211, v48
    v_cvt_pk_bf16_f32 v211, v210, v211
    v_mfma_f32_16x16x32_bf16 v[20:23], v[52:55], a[16:19], v[20:23]
    v_exp_f32 v16, v16
    v_mfma_f32_16x16x32_bf16 v[24:27], v[52:55], a[32:35], -4.0
    v_exp_f32 v17, v17
    v_mfma_f32_16x16x32_bf16 v[24:27], v[8:11], a[36:39], v[24:27]
    buffer_load_dwordx4 v0, s[28:31], s33 offen offset:3080 lds
    v_mfma_f32_16x16x32_bf16 v[24:27], a[232:235], a[40:43], v[24:27]
    v_exp_f32 v18, v18
    v_mfma_f32_16x16x32_bf16 v[24:27], a[236:239], a[44:47], v[24:27]
    v_exp_f32 v19, v19
    v_mfma_f32_16x16x32_bf16 v[28:31], a[236:239], a[60:63], -4.0
    s_mov_b32 m0, s99
    ds_read_b128 a[236:239], v61 offset:22752
    v_cvt_pk_bf16_f32 v96, v16, v17
    v_mfma_f32_16x16x32_bf16 v[28:31], a[232:235], a[56:59], v[28:31]
    v_exp_f32 v20, v20
    v_mfma_f32_16x16x32_bf16 v[28:31], v[8:11], a[52:55], v[28:31]
    buffer_store_dwordx4 v[160:163], v2, s[24:27], s43 offen offset:2048 sc1
    v_mfma_f32_16x16x32_bf16 v[28:31], v[52:55], a[48:51], v[28:31]
    ds_read_b128 a[232:235], v60 offset:21728
    v_cvt_pk_bf16_f32 v97, v18, v19
    v_smfmac_f32_16x16x64_bf16 v[32:35], v[12:15], v[64:71], v57
    s_waitcnt lgkmcnt(8)
    v_cvt_pk_bf16_f32 v210, v208, v209
    v_mfma_f32_16x16x32_bf16 v[128:131], a[240:243], v[64:67], 0
    s_waitcnt lgkmcnt(6)
    v_exp_f32 v21, v21
    v_mfma_f32_16x16x32_bf16 v[128:131], a[244:247], v[68:71], v[128:131]
    v_exp_f32 v22, v22
    v_mfma_f32_16x16x32_bf16 v[132:135], a[244:247], v[76:79], v[132:135]
    v_exp_f32 v23, v23
    v_mfma_f32_16x16x32_bf16 v[132:135], a[240:243], v[72:75], v[132:135]
    v_cvt_pk_bf16_f32 v104, v20, v21
    v_cvt_pk_bf16_f32 v105, v22, v23
    v_mfma_f32_16x16x32_bf16 v[136:139], a[240:243], v[80:83], v[136:139]
    v_exp_f32 v24, v24
    v_mfma_f32_16x16x32_bf16 v[136:139], a[244:247], v[84:87], v[136:139]
    v_exp_f32 v25, v25
    v_mfma_f32_16x16x32_bf16 v[140:143], a[244:247], v[92:95], v[140:143]
    v_exp_f32 v26, v26
    v_mfma_f32_16x16x32_bf16 v[140:143], a[240:243], v[88:91], v[140:143]
    s_waitcnt lgkmcnt(4)
    v_exp_f32 v27, v27
    v_mfma_f32_16x16x32_bf16 v[156:159], a[248:251], v[88:91], v[156:159]
    s_waitcnt lgkmcnt(2)
    v_cvt_pk_bf16_f32 v112, v24, v25
    v_cvt_pk_bf16_f32 v113, v26, v27
    v_mfma_f32_16x16x32_bf16 v[156:159], a[252:255], v[92:95], v[156:159]
    v_exp_f32 v28, v28
    v_mfma_f32_16x16x32_bf16 v[152:155], a[252:255], v[84:87], v[152:155]
    v_exp_f32 v29, v29
    v_mfma_f32_16x16x32_bf16 v[152:155], a[248:251], v[80:83], v[152:155]
    v_exp_f32 v30, v30
    v_mfma_f32_16x16x32_bf16 v[148:151], a[248:251], v[72:75], v[148:151]
    v_exp_f32 v31, v31
    v_mfma_f32_16x16x32_bf16 v[148:151], a[252:255], v[76:79], v[148:151]
    ds_read_b64_tr_b16 a[240:241], v1 offset:49816
    ds_read_b64_tr_b16 a[242:243], v1 offset:50328
    v_mfma_f32_16x16x32_bf16 v[144:147], a[252:255], v[68:71], 0
    v_cvt_pk_bf16_f32 v120, v28, v29
    v_cvt_pk_bf16_f32 v121, v30, v31
    v_mfma_f32_16x16x32_bf16 v[144:147], a[248:251], v[64:67], v[144:147]
    ds_read_b64_tr_b16 a[244:245], v1 offset:50840
    ds_read_b64_tr_b16 a[246:247], v1 offset:51352
    v_mfma_f32_16x16x32_bf16 v[16:19], a[224:227], a[0:3], -4.0
    v_cvt_pk_bf16_f32 v208, v192, v193
    v_cvt_pk_bf16_f32 v209, v194, v195
    v_mfma_f32_16x16x32_bf16 v[16:19], a[228:231], a[4:7], v[16:19]
    s_waitcnt lgkmcnt(4)
    ds_read_b64_tr_b16 a[248:249], v1 offset:49824
    ds_read_b64_tr_b16 a[250:251], v1 offset:50336
    v_mfma_f32_16x16x32_bf16 v[16:19], a[232:235], a[8:11], v[16:19]
    v_mul_f32 v224, v224, v48
    v_mul_f32 v225, v225, v48
    v_mfma_f32_16x16x32_bf16 v[16:19], a[236:239], a[12:15], v[16:19]
    ds_read_b64_tr_b16 a[252:253], v1 offset:50848
    ds_read_b64_tr_b16 a[254:255], v1 offset:51360
    v_mfma_f32_16x16x32_bf16 v[20:23], a[236:239], a[28:31], -4.0
    v_mul_f32 v226, v226, v48
    v_mul_f32 v227, v227, v48
    v_mfma_f32_16x16x32_bf16 v[20:23], a[232:235], a[24:27], v[20:23]
    v_mul_f32 v240, v240, v48
    v_mul_f32 v241, v241, v48
    v_mfma_f32_16x16x32_bf16 v[20:23], a[228:231], a[20:23], v[20:23]
    v_mul_f32 v242, v242, v48
    v_mul_f32 v243, v243, v48
    v_mfma_f32_16x16x32_bf16 v[20:23], a[224:227], a[16:19], v[20:23]
    v_exp_f32 v16, v16
    v_mfma_f32_16x16x32_bf16 v[24:27], a[224:227], a[32:35], -4.0
    v_exp_f32 v17, v17
    v_mfma_f32_16x16x32_bf16 v[24:27], a[228:231], a[36:39], v[24:27]
    v_exp_f32 v18, v18
    v_mfma_f32_16x16x32_bf16 v[24:27], a[232:235], a[40:43], v[24:27]
    v_exp_f32 v19, v19
    v_mfma_f32_16x16x32_bf16 v[24:27], a[236:239], a[44:47], v[24:27]
    v_cvt_pk_bf16_f32 v98, v16, v17
    v_cvt_pk_bf16_f32 v99, v18, v19
    v_mfma_f32_16x16x32_bf16 v[28:31], a[236:239], a[60:63], -4.0
    v_exp_f32 v20, v20
    v_mfma_f32_16x16x32_bf16 v[28:31], a[232:235], a[56:59], v[28:31]
    ds_read_b128 a[232:235], v60 offset:25824
    v_cvt_pk_bf16_f32 v243, v242, v243
    v_mfma_f32_16x16x32_bf16 v[28:31], a[228:231], a[52:55], v[28:31]
    v_exp_f32 v21, v21
    v_mfma_f32_16x16x32_bf16 v[28:31], a[224:227], a[48:51], v[28:31]
    ds_read_b128 a[224:227], v60 offset:23776
    v_cvt_pk_bf16_f32 v106, v20, v21
    v_smfmac_f32_16x16x64_bf16 v[36:39], v[12:15], v[72:79], v57
    s_waitcnt lgkmcnt(8)
    v_cvt_pk_bf16_f32 v242, v240, v241
    v_mfma_f32_16x16x32_bf16 v[164:167], a[240:243], v[72:75], v[164:167]
    s_waitcnt lgkmcnt(6)
    v_exp_f32 v22, v22
    v_mfma_f32_16x16x32_bf16 v[164:167], a[244:247], v[76:79], v[164:167]
    ds_read_b128 a[228:231], v61 offset:24800
    v_cvt_pk_bf16_f32 v240, v224, v225
    v_mfma_f32_16x16x32_bf16 v[160:163], a[244:247], v[68:71], 0
    v_exp_f32 v23, v23
    v_mfma_f32_16x16x32_bf16 v[160:163], a[240:243], v[64:67], v[160:163]
    ds_read_b128 a[236:239], v61 offset:26848
    v_cvt_pk_bf16_f32 v107, v22, v23
    v_mfma_f32_16x16x32_bf16 v[168:171], a[240:243], v[80:83], v[168:171]
    v_exp_f32 v24, v24
    v_mfma_f32_16x16x32_bf16 v[168:171], a[244:247], v[84:87], v[168:171]
    v_exp_f32 v25, v25
    v_mfma_f32_16x16x32_bf16 v[172:175], a[244:247], v[92:95], v[172:175]
    v_exp_f32 v26, v26
    v_mfma_f32_16x16x32_bf16 v[172:175], a[240:243], v[88:91], v[172:175]
    s_waitcnt lgkmcnt(6)
    v_exp_f32 v27, v27
    v_mfma_f32_16x16x32_bf16 v[188:191], a[248:251], v[88:91], v[188:191]
    s_waitcnt lgkmcnt(4)
    v_cvt_pk_bf16_f32 v114, v24, v25
    v_cvt_pk_bf16_f32 v115, v26, v27
    v_mfma_f32_16x16x32_bf16 v[188:191], a[252:255], v[92:95], v[188:191]
    v_exp_f32 v28, v28
    v_mfma_f32_16x16x32_bf16 v[184:187], a[252:255], v[84:87], v[184:187]
    v_exp_f32 v29, v29
    v_mfma_f32_16x16x32_bf16 v[184:187], a[248:251], v[80:83], v[184:187]
    v_exp_f32 v30, v30
    v_mfma_f32_16x16x32_bf16 v[176:179], a[248:251], v[64:67], 0
    v_exp_f32 v31, v31
    v_mfma_f32_16x16x32_bf16 v[176:179], a[252:255], v[68:71], v[176:179]
    ds_read_b64_tr_b16 a[240:241], v1 offset:49880
    ds_read_b64_tr_b16 a[242:243], v1 offset:50392
    v_mfma_f32_16x16x32_bf16 v[180:183], a[252:255], v[76:79], v[180:183]
    v_cvt_pk_bf16_f32 v122, v28, v29
    v_cvt_pk_bf16_f32 v123, v30, v31
    v_mfma_f32_16x16x32_bf16 v[180:183], a[248:251], v[72:75], v[180:183]
    s_waitcnt lgkmcnt(4)
    ds_read_b64_tr_b16 a[244:245], v1 offset:50904
    ds_read_b64_tr_b16 a[246:247], v1 offset:51416
    v_mfma_f32_16x16x32_bf16 v[16:19], a[224:227], a[0:3], -4.0
    s_waitcnt lgkmcnt(5)
    v_cvt_pk_bf16_f32 v241, v226, v227
    v_cndmask_b32_dpp v224, v208, v240, vcc row_ror:8 row_mask:0xf bank_mask:0xf
    v_mfma_f32_16x16x32_bf16 v[16:19], a[228:231], a[4:7], v[16:19]
    ds_read_b64_tr_b16 a[248:249], v1 offset:49888
    ds_read_b64_tr_b16 a[250:251], v1 offset:50400
    v_mfma_f32_16x16x32_bf16 v[16:19], a[232:235], a[8:11], v[16:19]
    s_waitcnt lgkmcnt(6)
    v_mov_b32_dpp v208, v240 row_ror:8 row_mask:0xf bank_mask:0xc
    v_cndmask_b32_dpp v225, v209, v241, vcc row_ror:8 row_mask:0xf bank_mask:0xf
    v_mfma_f32_16x16x32_bf16 v[16:19], a[236:239], a[12:15], v[16:19]
    ds_read_b64_tr_b16 a[252:253], v1 offset:50912
    ds_read_b64_tr_b16 a[254:255], v1 offset:51424
    v_mfma_f32_16x16x32_bf16 v[20:23], a[236:239], a[28:31], -4.0
    v_mov_b32_dpp v209, v241 row_ror:8 row_mask:0xf bank_mask:0xc
    v_cndmask_b32_dpp v226, v210, v242, vcc row_ror:8 row_mask:0xf bank_mask:0xf
    v_mfma_f32_16x16x32_bf16 v[20:23], a[232:235], a[24:27], v[20:23]
    v_mov_b32_dpp v210, v242 row_ror:8 row_mask:0xf bank_mask:0xc
    v_cndmask_b32_dpp v227, v211, v243, vcc row_ror:8 row_mask:0xf bank_mask:0xf
    v_mfma_f32_16x16x32_bf16 v[20:23], a[228:231], a[20:23], v[20:23]
    buffer_store_dwordx4 v[224:227], v2, s[24:27], s43 offen offset:2176 sc1
    v_mfma_f32_16x16x32_bf16 v[20:23], a[224:227], a[16:19], v[20:23]
    v_exp_f32 v16, v16
    v_mfma_f32_16x16x32_bf16 v[24:27], a[224:227], a[32:35], -4.0
    v_exp_f32 v17, v17
    v_mfma_f32_16x16x32_bf16 v[24:27], a[228:231], a[36:39], v[24:27]
    v_exp_f32 v18, v18
    v_mfma_f32_16x16x32_bf16 v[24:27], a[232:235], a[40:43], v[24:27]
    v_exp_f32 v19, v19
    v_mfma_f32_16x16x32_bf16 v[24:27], a[236:239], a[44:47], v[24:27]
    v_mov_b32_dpp v211, v243 row_ror:8 row_mask:0xf bank_mask:0xc
    v_cvt_pk_bf16_f32 v100, v16, v17
    v_mfma_f32_16x16x32_bf16 v[28:31], a[236:239], a[60:63], -4.0
    v_exp_f32 v20, v20
    v_mfma_f32_16x16x32_bf16 v[28:31], a[232:235], a[56:59], v[28:31]
    ds_read_b128 a[232:235], v60 offset:29920
    v_cvt_pk_bf16_f32 v101, v18, v19
    v_mfma_f32_16x16x32_bf16 v[28:31], a[228:231], a[52:55], v[28:31]
    v_exp_f32 v21, v21
    v_mfma_f32_16x16x32_bf16 v[28:31], a[224:227], a[48:51], v[28:31]
    ds_read_b128 a[224:227], v60 offset:27872
    v_cvt_pk_bf16_f32 v108, v20, v21
    v_smfmac_f32_16x16x64_bf16 v[40:43], v[12:15], v[80:87], v57
    s_waitcnt lgkmcnt(8)
    v_mfma_f32_16x16x32_bf16 v[200:203], a[240:243], v[80:83], v[200:203]
    s_waitcnt lgkmcnt(6)
    v_exp_f32 v22, v22
    v_mfma_f32_16x16x32_bf16 v[200:203], a[244:247], v[84:87], v[200:203]
    v_exp_f32 v23, v23
    v_mfma_f32_16x16x32_bf16 v[192:195], a[244:247], v[68:71], 0
    ds_read_b128 a[228:231], v61 offset:28896
    v_cvt_pk_bf16_f32 v109, v22, v23
    v_mfma_f32_16x16x32_bf16 v[192:195], a[240:243], v[64:67], v[192:195]
    v_exp_f32 v24, v24
    v_mfma_f32_16x16x32_bf16 v[196:199], a[240:243], v[72:75], v[196:199]
    v_exp_f32 v25, v25
    v_mfma_f32_16x16x32_bf16 v[196:199], a[244:247], v[76:79], v[196:199]
    buffer_store_dwordx4 v[208:211], v2, s[24:27], s43 offen offset:128 sc1
    v_mfma_f32_16x16x32_bf16 v[204:207], a[244:247], v[92:95], v[204:207]
    s_add_u32 s43, s43, 4096
    ds_read_b128 a[236:239], v61 offset:30944
    v_cvt_pk_bf16_f32 v116, v24, v25
    v_mfma_f32_16x16x32_bf16 v[204:207], a[240:243], v[88:91], v[204:207]
    s_waitcnt lgkmcnt(6)
    v_exp_f32 v26, v26
    v_mfma_f32_16x16x32_bf16 v[220:223], a[248:251], v[88:91], v[220:223]
    s_waitcnt lgkmcnt(4)
    v_exp_f32 v27, v27
    v_mfma_f32_16x16x32_bf16 v[220:223], a[252:255], v[92:95], v[220:223]
    ds_read_b64_tr_b16 a[240:241], v1 offset:49944
    v_cvt_pk_bf16_f32 v117, v26, v27
    v_mfma_f32_16x16x32_bf16 v[212:215], a[252:255], v[76:79], v[212:215]
    v_exp_f32 v28, v28
    v_mfma_f32_16x16x32_bf16 v[212:215], a[248:251], v[72:75], v[212:215]
    v_exp_f32 v29, v29
    v_mfma_f32_16x16x32_bf16 v[208:211], a[248:251], v[64:67], 0
    v_exp_f32 v30, v30
    v_mfma_f32_16x16x32_bf16 v[208:211], a[252:255], v[68:71], v[208:211]
    v_exp_f32 v31, v31
    v_mfma_f32_16x16x32_bf16 v[216:219], a[252:255], v[84:87], v[216:219]
    ds_read_b64_tr_b16 a[242:243], v1 offset:50456
    v_cvt_pk_bf16_f32 v124, v28, v29
    v_mfma_f32_16x16x32_bf16 v[216:219], a[248:251], v[80:83], v[216:219]
    s_waitcnt lgkmcnt(4)
    v_cvt_pk_bf16_f32 v125, v30, v31
    v_mfma_f32_16x16x32_bf16 v[16:19], a[224:227], a[16:19], -4.0
    s_waitcnt vmcnt(8) lgkmcnt(3)
    ds_read_b128 a[16:19], v3 offset:0
    v_mfma_f32_16x16x32_bf16 v[16:19], a[228:231], a[20:23], v[16:19]
    v_mfma_f32_16x16x32_bf16 v[16:19], a[232:235], a[24:27], v[16:19]
    s_waitcnt lgkmcnt(3)
    ds_read_b128 a[20:23], v3 offset:64
    v_mfma_f32_16x16x32_bf16 v[16:19], a[236:239], a[28:31], v[16:19]
    v_mfma_f32_16x16x32_bf16 v[20:23], a[236:239], a[12:15], -4.0
    ds_read_b128 a[24:27], v3 offset:128
    v_mfma_f32_16x16x32_bf16 v[20:23], a[232:235], a[8:11], v[20:23]
    v_mfma_f32_16x16x32_bf16 v[20:23], a[228:231], a[4:7], v[20:23]
    s_nop 0
    ds_read_b128 a[28:31], v3 offset:192
    v_mfma_f32_16x16x32_bf16 v[20:23], a[224:227], a[0:3], v[20:23]
    s_nop 0
    v_exp_f32 v16, v16
    v_mfma_f32_16x16x32_bf16 v[24:27], a[224:227], a[32:35], -4.0
    ds_read_b64_tr_b16 a[244:245], v1 offset:50968
    ds_read_b64_tr_b16 a[246:247], v1 offset:51480
    v_mfma_f32_16x16x32_bf16 v[24:27], a[228:231], a[36:39], v[24:27]
L_hop5:
    s_cbranch_execz L_hop9
    v_exp_f32 v17, v17
    v_mfma_f32_16x16x32_bf16 v[24:27], a[232:235], a[40:43], v[24:27]
    ds_read_b64_tr_b16 a[248:249], v1 offset:49952
    ds_read_b64_tr_b16 a[250:251], v1 offset:50464
    v_mfma_f32_16x16x32_bf16 v[24:27], a[236:239], a[44:47], v[24:27]
    v_exp_f32 v18, v18
    v_mfma_f32_16x16x32_bf16 v[28:31], a[236:239], a[60:63], -4.0
    ds_read_b64_tr_b16 a[252:253], v1 offset:50976
    ds_read_b64_tr_b16 a[254:255], v1 offset:51488
    v_mfma_f32_16x16x32_bf16 v[28:31], a[232:235], a[56:59], v[28:31]
    v_exp_f32 v19, v19
    v_mfma_f32_16x16x32_bf16 v[28:31], a[228:231], a[52:55], v[28:31]
    ds_read_b128 a[228:231], v61 offset:32992
    v_cvt_pk_bf16_f32 v110, v16, v17
    v_mfma_f32_16x16x32_bf16 v[28:31], a[224:227], a[48:51], v[28:31]
    v_exp_f32 v20, v20
    v_smfmac_f32_16x16x64_bf16 v[44:47], v[12:15], v[88:95], v57
    s_waitcnt lgkmcnt(11)
    v_cvt_pk_bf16_f32 v111, v18, v19
    v_mfma_f32_16x16x32_bf16 v[236:239], a[240:243], v[88:91], v[236:239]
    s_waitcnt lgkmcnt(5)
    v_exp_f32 v21, v21
    v_mfma_f32_16x16x32_bf16 v[236:239], a[244:247], v[92:95], v[236:239]
    ds_read_b128 a[224:227], v60 offset:31968
    v_cvt_pk_bf16_f32 v102, v20, v21
    v_mfma_f32_16x16x32_bf16 v[224:227], a[244:247], v[68:71], 0
    v_exp_f32 v22, v22
    v_mfma_f32_16x16x32_bf16 v[224:227], a[240:243], v[64:67], v[224:227]
    v_exp_f32 v23, v23
    v_mfma_f32_16x16x32_bf16 v[228:231], a[240:243], v[72:75], v[228:231]
    ds_read_b128 a[232:235], v60 offset:34016
    v_cvt_pk_bf16_f32 v103, v22, v23
    v_mfma_f32_16x16x32_bf16 v[228:231], a[244:247], v[76:79], v[228:231]
    v_exp_f32 v24, v24
    v_mfma_f32_16x16x32_bf16 v[232:235], a[244:247], v[84:87], v[232:235]
    s_waitcnt vmcnt(3) lgkmcnt(3)
    v_exp_f32 v25, v25
    v_mfma_f32_16x16x32_bf16 v[232:235], a[240:243], v[80:83], v[232:235]
    s_barrier
    buffer_load_dwordx4 v0, s[20:23], s34 offen offset:0 lds
    v_mfma_f32_16x16x32_bf16 v[248:251], a[248:251], v[80:83], v[248:251]
    ds_read_b128 a[236:239], v61 offset:35040
    v_cvt_pk_bf16_f32 v118, v24, v25
    v_mfma_f32_16x16x32_bf16 v[248:251], a[252:255], v[84:87], v[248:251]
    v_exp_f32 v26, v26
    v_mfma_f32_16x16x32_bf16 v[244:247], a[252:255], v[76:79], v[244:247]
    v_exp_f32 v27, v27
    v_mfma_f32_16x16x32_bf16 v[244:247], a[248:251], v[72:75], v[244:247]
    ds_read_b64_tr_b16 a[240:241], v1 offset:33168
    v_cvt_pk_bf16_f32 v119, v26, v27
    v_mfma_f32_16x16x32_bf16 v[240:243], a[248:251], v[64:67], 0
    v_exp_f32 v28, v28
    v_mfma_f32_16x16x32_bf16 v[240:243], a[252:255], v[68:71], v[240:243]
    buffer_load_dwordx4 v0, s[20:23], s34 offen offset:1024 lds
    v_mfma_f32_16x16x32_bf16 v[252:255], a[252:255], v[92:95], v[252:255]
    v_exp_f32 v29, v29
    v_mfma_f32_16x16x32_bf16 v[252:255], a[248:251], v[88:91], v[252:255]
    s_waitcnt lgkmcnt(3)
    v_exp_f32 v30, v30
    v_mfma_f32_16x16x32_bf16 v[16:19], a[224:227], a[0:3], -4.0
    v_exp_f32 v31, v31
    v_mfma_f32_16x16x32_bf16 v[16:19], a[228:231], a[4:7], v[16:19]
    s_waitcnt lgkmcnt(2)
    ds_read_b64_tr_b16 a[242:243], v1 offset:33680
    v_cvt_pk_bf16_f32 v126, v28, v29
    v_mfma_f32_16x16x32_bf16 v[16:19], a[232:235], a[8:11], v[16:19]
    s_waitcnt lgkmcnt(2)
    buffer_load_dwordx4 v0, s[28:31], s34 offen offset:2056 lds
    v_mfma_f32_16x16x32_bf16 v[16:19], a[236:239], a[12:15], v[16:19]
    ds_read_b64_tr_b16 a[244:245], v1 offset:34192
    v_cvt_pk_bf16_f32 v127, v30, v31
    v_mfma_f32_16x16x32_bf16 v[20:23], a[236:239], a[44:47], -4.0
    v_mfma_f32_16x16x32_bf16 v[20:23], a[232:235], a[40:43], v[20:23]
    ds_read_b64_tr_b16 a[246:247], v1 offset:34704
    ds_read_b64_tr_b16 a[248:249], v1 offset:33176
    v_mfma_f32_16x16x32_bf16 v[20:23], a[228:231], a[36:39], v[20:23]
    v_mfma_f32_16x16x32_bf16 v[20:23], a[224:227], a[32:35], v[20:23]
    buffer_load_dwordx4 v0, s[28:31], s34 offen offset:3080 lds
    v_mfma_f32_16x16x32_bf16 v[24:27], a[224:227], a[48:51], -4.0
    s_mov_b32 m0, s76
    ds_read_b64_tr_b16 a[250:251], v1 offset:33688
    ds_read_b64_tr_b16 a[252:253], v1 offset:34200
    v_mfma_f32_16x16x32_bf16 v[24:27], a[228:231], a[52:55], v[24:27]
    v_exp_f32 v16, v16
    v_mfma_f32_16x16x32_bf16 v[24:27], a[232:235], a[56:59], v[24:27]
    v_exp_f32 v17, v17
    v_mfma_f32_16x16x32_bf16 v[24:27], a[236:239], a[60:63], v[24:27]
    ds_read_b64_tr_b16 a[254:255], v1 offset:34712
    v_cvt_pk_bf16_f32 v64, v16, v17
    v_mfma_f32_16x16x32_bf16 v[28:31], a[236:239], a[28:31], -4.0
    v_exp_f32 v18, v18
    v_mfma_f32_16x16x32_bf16 v[28:31], a[232:235], a[24:27], v[28:31]
    buffer_load_dwordx4 v0, s[12:15], s42 offen offset:0 nt lds
    v_mfma_f32_16x16x32_bf16 v[28:31], a[228:231], a[20:23], v[28:31]
    v_exp_f32 v19, v19
    v_mfma_f32_16x16x32_bf16 v[28:31], a[224:227], a[16:19], v[28:31]
    s_mov_b32 m0, s77
    ds_read_b128 a[224:227], v60 offset:36064
    v_cvt_pk_bf16_f32 v65, v18, v19
    v_smfmac_f32_16x16x64_bf16 v[36:39], v[12:15], v[104:111], v57
    s_waitcnt lgkmcnt(7)
    v_mfma_f32_16x16x32_bf16 v[132:135], a[240:243], v[104:107], v[132:135]
    s_waitcnt lgkmcnt(5)
    v_exp_f32 v20, v20
    v_mfma_f32_16x16x32_bf16 v[132:135], a[244:247], v[108:111], v[132:135]
    buffer_load_dwordx4 v0, s[12:15], s42 offen offset:1024 nt lds
    v_mfma_f32_16x16x32_bf16 v[128:131], a[244:247], v[100:103], v[128:131]
    v_exp_f32 v21, v21
    v_mfma_f32_16x16x32_bf16 v[128:131], a[240:243], v[96:99], v[128:131]
    s_mov_b32 m0, s78
    ds_read_b128 a[228:231], v61 offset:37088
    v_cvt_pk_bf16_f32 v80, v20, v21
    v_mfma_f32_16x16x32_bf16 v[136:139], a[240:243], v[112:115], v[136:139]
    v_exp_f32 v22, v22
    v_mfma_f32_16x16x32_bf16 v[136:139], a[244:247], v[116:119], v[136:139]
    ds_read_b128 a[232:235], v60 offset:38112
    v_add_f32 v36, v36, v37
    v_mfma_f32_16x16x32_bf16 v[140:143], a[244:247], v[124:127], v[140:143]
    v_exp_f32 v23, v23
    v_mfma_f32_16x16x32_bf16 v[140:143], a[240:243], v[120:123], v[140:143]
    s_waitcnt lgkmcnt(5)
    buffer_load_dwordx4 v0, s[12:15], s42 offen offset:2048 nt lds
    v_mfma_f32_16x16x32_bf16 v[156:159], a[248:251], v[120:123], v[156:159]
    s_waitcnt lgkmcnt(3)
    ds_read_b128 a[236:239], v61 offset:39136
    v_cvt_pk_bf16_f32 v81, v22, v23
    v_mfma_f32_16x16x32_bf16 v[156:159], a[252:255], v[124:127], v[156:159]
    s_mov_b32 m0, s79
    v_exp_f32 v24, v24
    v_mfma_f32_16x16x32_bf16 v[152:155], a[252:255], v[116:119], v[152:155]
    v_exp_f32 v25, v25
    v_mfma_f32_16x16x32_bf16 v[152:155], a[248:251], v[112:115], v[152:155]
    v_exp_f32 v26, v26
    v_mfma_f32_16x16x32_bf16 v[144:147], a[248:251], v[96:99], v[144:147]
    buffer_load_dwordx4 v0, s[12:15], s42 offen offset:3072 nt lds
    v_mfma_f32_16x16x32_bf16 v[144:147], a[252:255], v[100:103], v[144:147]
    v_exp_f32 v27, v27
    v_mfma_f32_16x16x32_bf16 v[148:151], a[252:255], v[108:111], v[148:151]
    v_cvt_pk_bf16_f32 v88, v24, v25
    v_cvt_pk_bf16_f32 v89, v26, v27
    v_mfma_f32_16x16x32_bf16 v[148:151], a[248:251], v[104:107], v[148:151]
    s_waitcnt lgkmcnt(3)
    v_exp_f32 v28, v28
    v_mfma_f32_16x16x32_bf16 v[16:19], a[224:227], a[0:3], -4.0
    s_waitcnt lgkmcnt(2)
    v_exp_f32 v29, v29
    v_mfma_f32_16x16x32_bf16 v[16:19], a[228:231], a[4:7], v[16:19]
    s_waitcnt lgkmcnt(1)
    v_exp_f32 v30, v30
    v_mfma_f32_16x16x32_bf16 v[16:19], a[232:235], a[8:11], v[16:19]
    s_waitcnt lgkmcnt(0)
    v_exp_f32 v31, v31
    v_mfma_f32_16x16x32_bf16 v[16:19], a[236:239], a[12:15], v[16:19]
    s_add_u32 s42, s42, 4096
    ds_read_b64_tr_b16 a[240:241], v1 offset:33232
    ds_read_b64_tr_b16 a[242:243], v1 offset:33744
    v_mfma_f32_16x16x32_bf16 v[20:23], a[236:239], a[28:31], -4.0
    v_rcp_f32 v50, v36
    v_mfma_f32_16x16x32_bf16 v[20:23], a[232:235], a[24:27], v[20:23]
    v_cvt_pk_bf16_f32 v72, v28, v29
    v_cvt_pk_bf16_f32 v73, v30, v31
    v_mfma_f32_16x16x32_bf16 v[20:23], a[228:231], a[20:23], v[20:23]
    s_mov_b32 m0, s98
    ds_read_b64_tr_b16 a[244:245], v1 offset:34256
    ds_read_b64_tr_b16 a[246:247], v1 offset:34768
    v_mfma_f32_16x16x32_bf16 v[20:23], a[224:227], a[16:19], v[20:23]
    v_exp_f32 v16, v16
    v_mfma_f32_16x16x32_bf16 v[24:27], a[224:227], a[32:35], -4.0
    v_exp_f32 v17, v17
    v_mfma_f32_16x16x32_bf16 v[24:27], a[228:231], a[36:39], v[24:27]
    ds_read_b64_tr_b16 a[248:249], v1 offset:33240
    ds_read_b64_tr_b16 a[250:251], v1 offset:33752
    v_mfma_f32_16x16x32_bf16 v[24:27], a[232:235], a[40:43], v[24:27]
    v_exp_f32 v18, v18
    v_mfma_f32_16x16x32_bf16 v[24:27], a[236:239], a[44:47], v[24:27]
    ds_read_b64_tr_b16 a[252:253], v1 offset:34264
    ds_read_b64_tr_b16 a[254:255], v1 offset:34776
    v_mfma_f32_16x16x32_bf16 v[28:31], a[236:239], a[60:63], -4.0
    v_exp_f32 v19, v19
    v_mfma_f32_16x16x32_bf16 v[28:31], a[232:235], a[56:59], v[28:31]
    ds_read_b128 a[232:235], v60 offset:42208
    v_cvt_pk_bf16_f32 v66, v16, v17
    v_mfma_f32_16x16x32_bf16 v[28:31], a[228:231], a[52:55], v[28:31]
    v_exp_f32 v20, v20
    v_mfma_f32_16x16x32_bf16 v[28:31], a[224:227], a[48:51], v[28:31]
    ds_read_b128 a[224:227], v60 offset:40160
    v_cvt_pk_bf16_f32 v67, v18, v19
    v_smfmac_f32_16x16x64_bf16 v[32:35], v[12:15], v[96:103], v57
    s_waitcnt lgkmcnt(8)
    v_mul_f32 v132, v132, v50
    v_mfma_f32_16x16x32_bf16 v[160:163], a[240:243], v[96:99], v[160:163]
    s_waitcnt lgkmcnt(6)
    ds_read_b128 a[228:231], v61 offset:41184
    v_mul_f32 v133, v133, v50
    v_mfma_f32_16x16x32_bf16 v[160:163], a[244:247], v[100:103], v[160:163]
    v_exp_f32 v21, v21
    v_mfma_f32_16x16x32_bf16 v[164:167], a[244:247], v[108:111], v[164:167]
    ds_read_b128 a[236:239], v61 offset:43232
    v_cvt_pk_bf16_f32 v74, v20, v21
    v_mfma_f32_16x16x32_bf16 v[164:167], a[240:243], v[104:107], v[164:167]
    v_exp_f32 v22, v22
    v_mfma_f32_16x16x32_bf16 v[168:171], a[240:243], v[112:115], v[168:171]
    v_exp_f32 v23, v23
    v_mfma_f32_16x16x32_bf16 v[168:171], a[244:247], v[116:119], v[168:171]
    v_cvt_pk_bf16_f32 v75, v22, v23
    v_mul_f32 v134, v134, v50
    v_mfma_f32_16x16x32_bf16 v[172:175], a[244:247], v[124:127], v[172:175]
    v_exp_f32 v24, v24
    v_mfma_f32_16x16x32_bf16 v[172:175], a[240:243], v[120:123], v[172:175]
    s_waitcnt lgkmcnt(6)
    v_exp_f32 v25, v25
    v_mfma_f32_16x16x32_bf16 v[188:191], a[248:251], v[120:123], v[188:191]
    s_waitcnt lgkmcnt(4)
    v_exp_f32 v26, v26
    v_mfma_f32_16x16x32_bf16 v[188:191], a[252:255], v[124:127], v[188:191]
    v_exp_f32 v27, v27
    v_mfma_f32_16x16x32_bf16 v[184:187], a[252:255], v[116:119], v[184:187]
    v_cvt_pk_bf16_f32 v82, v24, v25
    v_cvt_pk_bf16_f32 v83, v26, v27
    v_mfma_f32_16x16x32_bf16 v[184:187], a[248:251], v[112:115], v[184:187]
    v_exp_f32 v28, v28
    v_mfma_f32_16x16x32_bf16 v[180:183], a[248:251], v[104:107], v[180:183]
    v_exp_f32 v29, v29
    v_mfma_f32_16x16x32_bf16 v[180:183], a[252:255], v[108:111], v[180:183]
    v_exp_f32 v30, v30
    v_mfma_f32_16x16x32_bf16 v[176:179], a[252:255], v[100:103], v[176:179]
    v_exp_f32 v31, v31
    v_mfma_f32_16x16x32_bf16 v[176:179], a[248:251], v[96:99], v[176:179]
    s_waitcnt lgkmcnt(2)
    ds_read_b64_tr_b16 a[240:241], v1 offset:33296
    ds_read_b64_tr_b16 a[242:243], v1 offset:33808
    v_mfma_f32_16x16x32_bf16 v[16:19], a[224:227], a[0:3], -4.0
    s_waitcnt lgkmcnt(3)
    v_cvt_pk_bf16_f32 v90, v28, v29
    v_cvt_pk_bf16_f32 v91, v30, v31
    v_mfma_f32_16x16x32_bf16 v[16:19], a[228:231], a[4:7], v[16:19]
    ds_read_b64_tr_b16 a[244:245], v1 offset:34320
    ds_read_b64_tr_b16 a[246:247], v1 offset:34832
    v_mfma_f32_16x16x32_bf16 v[16:19], a[232:235], a[8:11], v[16:19]
    s_waitcnt lgkmcnt(4)
    v_mul_f32 v135, v135, v50
    v_mul_f32 v148, v148, v50
    v_mfma_f32_16x16x32_bf16 v[16:19], a[236:239], a[12:15], v[16:19]
    ds_read_b64_tr_b16 a[248:249], v1 offset:33304
    ds_read_b64_tr_b16 a[250:251], v1 offset:33816
    v_mfma_f32_16x16x32_bf16 v[20:23], a[236:239], a[28:31], -4.0
    v_mul_f32 v149, v149, v50
    v_mul_f32 v150, v150, v50
    v_mfma_f32_16x16x32_bf16 v[20:23], a[232:235], a[24:27], v[20:23]
    ds_read_b64_tr_b16 a[252:253], v1 offset:34328
    ds_read_b64_tr_b16 a[254:255], v1 offset:34840
    v_mfma_f32_16x16x32_bf16 v[20:23], a[228:231], a[20:23], v[20:23]
    v_mul_f32 v151, v151, v50
    v_cvt_pk_bf16_f32 v151, v150, v151
    v_mfma_f32_16x16x32_bf16 v[20:23], a[224:227], a[16:19], v[20:23]
    v_exp_f32 v16, v16
    v_mfma_f32_16x16x32_bf16 v[24:27], a[224:227], a[32:35], -4.0
    v_exp_f32 v17, v17
    v_mfma_f32_16x16x32_bf16 v[24:27], a[228:231], a[36:39], v[24:27]
    v_exp_f32 v18, v18
    v_mfma_f32_16x16x32_bf16 v[24:27], a[232:235], a[40:43], v[24:27]
    v_exp_f32 v19, v19
    v_mfma_f32_16x16x32_bf16 v[24:27], a[236:239], a[44:47], v[24:27]
    v_cvt_pk_bf16_f32 v68, v16, v17
    v_cvt_pk_bf16_f32 v69, v18, v19
    v_mfma_f32_16x16x32_bf16 v[28:31], a[236:239], a[60:63], -4.0
    v_exp_f32 v20, v20
    v_mfma_f32_16x16x32_bf16 v[28:31], a[232:235], a[56:59], v[28:31]
    ds_read_b128 a[232:235], v60 offset:46304
    v_cvt_pk_bf16_f32 v150, v148, v149
    v_mfma_f32_16x16x32_bf16 v[28:31], a[228:231], a[52:55], v[28:31]
    v_exp_f32 v21, v21
    v_mfma_f32_16x16x32_bf16 v[28:31], a[224:227], a[48:51], v[28:31]
    ds_read_b128 a[224:227], v60 offset:44256
    v_cvt_pk_bf16_f32 v76, v20, v21
    v_smfmac_f32_16x16x64_bf16 v[40:43], v[12:15], v[112:119], v57
    s_waitcnt lgkmcnt(8)
    v_cvt_pk_bf16_f32 v148, v132, v133
    v_mfma_f32_16x16x32_bf16 v[200:203], a[240:243], v[112:115], v[200:203]
    s_waitcnt lgkmcnt(6)
    v_exp_f32 v22, v22
    v_mfma_f32_16x16x32_bf16 v[200:203], a[244:247], v[116:119], v[200:203]
    ds_read_b128 a[228:231], v61 offset:45280
    v_cvt_pk_bf16_f32 v149, v134, v135
    v_mfma_f32_16x16x32_bf16 v[196:199], a[244:247], v[108:111], v[196:199]
    v_exp_f32 v23, v23
    v_mfma_f32_16x16x32_bf16 v[196:199], a[240:243], v[104:107], v[196:199]
    ds_read_b128 a[236:239], v61 offset:47328
    v_cvt_pk_bf16_f32 v77, v22, v23
    v_mfma_f32_16x16x32_bf16 v[192:195], a[240:243], v[96:99], v[192:195]
    v_exp_f32 v24, v24
    v_mfma_f32_16x16x32_bf16 v[192:195], a[244:247], v[100:103], v[192:195]
    v_exp_f32 v25, v25
    v_mfma_f32_16x16x32_bf16 v[204:207], a[244:247], v[124:127], v[204:207]
    v_exp_f32 v26, v26
    v_mfma_f32_16x16x32_bf16 v[204:207], a[240:243], v[120:123], v[204:207]
    s_waitcnt lgkmcnt(6)
    v_exp_f32 v27, v27
    v_mfma_f32_16x16x32_bf16 v[220:223], a[248:251], v[120:123], v[220:223]
    s_waitcnt lgkmcnt(4)
    v_cvt_pk_bf16_f32 v84, v24, v25
    v_cvt_pk_bf16_f32 v85, v26, v27
    v_mfma_f32_16x16x32_bf16 v[220:223], a[252:255], v[124:127], v[220:223]
    v_exp_f32 v28, v28
    v_mfma_f32_16x16x32_bf16 v[208:211], a[252:255], v[100:103], v[208:211]
    v_exp_f32 v29, v29
    v_mfma_f32_16x16x32_bf16 v[208:211], a[248:251], v[96:99], v[208:211]
    v_exp_f32 v30, v30
    v_mfma_f32_16x16x32_bf16 v[212:215], a[248:251], v[104:107], v[212:215]
    v_exp_f32 v31, v31
    v_mfma_f32_16x16x32_bf16 v[212:215], a[252:255], v[108:111], v[212:215]
    ds_read_b64_tr_b16 a[240:241], v1 offset:33360
    ds_read_b64_tr_b16 a[242:243], v1 offset:33872
    v_mfma_f32_16x16x32_bf16 v[216:219], a[252:255], v[116:119], v[216:219]
    v_cvt_pk_bf16_f32 v92, v28, v29
    v_cvt_pk_bf16_f32 v93, v30, v31
    v_mfma_f32_16x16x32_bf16 v[216:219], a[248:251], v[112:115], v[216:219]
    s_waitcnt lgkmcnt(4)
    ds_read_b64_tr_b16 a[244:245], v1 offset:34384
    ds_read_b64_tr_b16 a[246:247], v1 offset:34896
    v_mfma_f32_16x16x32_bf16 v[16:19], a[224:227], a[0:3], -4.0
    s_waitcnt lgkmcnt(5)
    v_mul_f32 v164, v164, v50
    v_mul_f32 v165, v165, v50
    v_mfma_f32_16x16x32_bf16 v[16:19], a[228:231], a[4:7], v[16:19]
    ds_read_b64_tr_b16 a[248:249], v1 offset:33368
    ds_read_b64_tr_b16 a[250:251], v1 offset:33880
    v_mfma_f32_16x16x32_bf16 v[16:19], a[232:235], a[8:11], v[16:19]
    s_waitcnt lgkmcnt(6)
    v_mul_f32 v166, v166, v50
    v_mul_f32 v167, v167, v50
    v_mfma_f32_16x16x32_bf16 v[16:19], a[236:239], a[12:15], v[16:19]
    ds_read_b64_tr_b16 a[252:253], v1 offset:34392
    ds_read_b64_tr_b16 a[254:255], v1 offset:34904
    v_mfma_f32_16x16x32_bf16 v[20:23], a[236:239], a[28:31], -4.0
    v_mul_f32 v180, v180, v50
    v_mul_f32 v181, v181, v50
    v_mfma_f32_16x16x32_bf16 v[20:23], a[232:235], a[24:27], v[20:23]
    v_mul_f32 v182, v182, v50
    v_mul_f32 v183, v183, v50
    v_mfma_f32_16x16x32_bf16 v[20:23], a[228:231], a[20:23], v[20:23]
    v_cvt_pk_bf16_f32 v183, v182, v183
    v_cvt_pk_bf16_f32 v182, v180, v181
    v_mfma_f32_16x16x32_bf16 v[20:23], a[224:227], a[16:19], v[20:23]
    v_exp_f32 v16, v16
    v_mfma_f32_16x16x32_bf16 v[24:27], a[224:227], a[32:35], -4.0
    v_exp_f32 v17, v17
    v_mfma_f32_16x16x32_bf16 v[24:27], a[228:231], a[36:39], v[24:27]
    v_exp_f32 v18, v18
    v_mfma_f32_16x16x32_bf16 v[24:27], a[232:235], a[40:43], v[24:27]
    v_exp_f32 v19, v19
    v_mfma_f32_16x16x32_bf16 v[24:27], a[236:239], a[44:47], v[24:27]
    v_cvt_pk_bf16_f32 v70, v16, v17
    v_cvt_pk_bf16_f32 v71, v18, v19
    v_mfma_f32_16x16x32_bf16 v[28:31], a[236:239], a[60:63], -4.0
    v_exp_f32 v20, v20
    v_mfma_f32_16x16x32_bf16 v[28:31], a[232:235], a[56:59], v[28:31]
    ds_read_b128 a[232:235], v60 offset:50400
    v_cvt_pk_bf16_f32 v180, v164, v165
    v_mfma_f32_16x16x32_bf16 v[28:31], a[228:231], a[52:55], v[28:31]
    v_exp_f32 v21, v21
    v_mfma_f32_16x16x32_bf16 v[28:31], a[224:227], a[48:51], v[28:31]
    ds_read_b128 a[224:227], v60 offset:48352
    v_cvt_pk_bf16_f32 v78, v20, v21
    v_smfmac_f32_16x16x64_bf16 v[44:47], v[12:15], v[120:127], v57
    s_waitcnt lgkmcnt(8)
    v_cvt_pk_bf16_f32 v181, v166, v167
    v_mfma_f32_16x16x32_bf16 v[236:239], a[240:243], v[120:123], v[236:239]
    s_waitcnt lgkmcnt(6)
    v_exp_f32 v22, v22
    v_mfma_f32_16x16x32_bf16 v[236:239], a[244:247], v[124:127], v[236:239]
    ds_read_b128 a[228:231], v61 offset:49376
    v_cndmask_b32_dpp v164, v148, v180, vcc row_ror:8 row_mask:0xf bank_mask:0xf
    v_mfma_f32_16x16x32_bf16 v[228:231], a[244:247], v[108:111], v[228:231]
    v_exp_f32 v23, v23
    v_mfma_f32_16x16x32_bf16 v[228:231], a[240:243], v[104:107], v[228:231]
    ds_read_b128 a[236:239], v61 offset:51424
    v_cvt_pk_bf16_f32 v79, v22, v23
    v_mfma_f32_16x16x32_bf16 v[224:227], a[240:243], v[96:99], v[224:227]
    v_exp_f32 v24, v24
    v_mfma_f32_16x16x32_bf16 v[224:227], a[244:247], v[100:103], v[224:227]
    v_exp_f32 v25, v25
    v_mfma_f32_16x16x32_bf16 v[232:235], a[244:247], v[116:119], v[232:235]
    s_waitcnt vmcnt(4) lgkmcnt(4)
    v_exp_f32 v26, v26
    v_mfma_f32_16x16x32_bf16 v[232:235], a[240:243], v[112:115], v[232:235]
    s_barrier
    buffer_load_dwordx4 v0, s[20:23], s35 offen offset:0 lds
    v_mfma_f32_16x16x32_bf16 v[248:251], a[248:251], v[112:115], v[248:251]
    v_exp_f32 v27, v27
    v_mfma_f32_16x16x32_bf16 v[248:251], a[252:255], v[116:119], v[248:251]
    v_cvt_pk_bf16_f32 v86, v24, v25
    v_cvt_pk_bf16_f32 v87, v26, v27
    v_mfma_f32_16x16x32_bf16 v[240:243], a[252:255], v[100:103], v[240:243]
    v_exp_f32 v28, v28
    v_mfma_f32_16x16x32_bf16 v[240:243], a[248:251], v[96:99], v[240:243]
    v_exp_f32 v29, v29
    v_mfma_f32_16x16x32_bf16 v[244:247], a[248:251], v[104:107], v[244:247]
    buffer_load_dwordx4 v0, s[20:23], s35 offen offset:1024 lds
    v_mfma_f32_16x16x32_bf16 v[244:247], a[252:255], v[108:111], v[244:247]
    v_exp_f32 v30, v30
    v_mfma_f32_16x16x32_bf16 v[252:255], a[252:255], v[124:127], v[252:255]
    v_exp_f32 v31, v31
    v_mfma_f32_16x16x32_bf16 v[252:255], a[248:251], v[120:123], v[252:255]
    s_waitcnt lgkmcnt(2)
    ds_read_b64_tr_b16 a[240:241], v1 offset:49752
    ds_read_b64_tr_b16 a[242:243], v1 offset:50264
    v_mfma_f32_16x16x32_bf16 v[16:19], a[224:227], a[0:3], -4.0
    s_waitcnt lgkmcnt(3)
    v_cvt_pk_bf16_f32 v94, v28, v29
    v_cvt_pk_bf16_f32 v95, v30, v31
    v_mfma_f32_16x16x32_bf16 v[16:19], a[228:231], a[4:7], v[16:19]
    buffer_load_dwordx4 v0, s[28:31], s35 offen offset:2056 lds
    v_mfma_f32_16x16x32_bf16 v[16:19], a[232:235], a[8:11], v[16:19]
    s_waitcnt lgkmcnt(2)
    ds_read_b64_tr_b16 a[244:245], v1 offset:50776
    ds_read_b64_tr_b16 a[246:247], v1 offset:51288
    v_mfma_f32_16x16x32_bf16 v[16:19], a[236:239], a[12:15], v[16:19]
    v_mov_b32_dpp v148, v180 row_ror:8 row_mask:0xf bank_mask:0xc
    v_cndmask_b32_dpp v165, v149, v181, vcc row_ror:8 row_mask:0xf bank_mask:0xf
    v_mfma_f32_16x16x32_bf16 v[20:23], a[236:239], a[28:31], -4.0
    ds_read_b64_tr_b16 a[248:249], v1 offset:49760
    ds_read_b64_tr_b16 a[250:251], v1 offset:50272
    v_mfma_f32_16x16x32_bf16 v[20:23], a[232:235], a[24:27], v[20:23]
    v_mov_b32_dpp v149, v181 row_ror:8 row_mask:0xf bank_mask:0xc
    v_cndmask_b32_dpp v166, v150, v182, vcc row_ror:8 row_mask:0xf bank_mask:0xf
    v_mfma_f32_16x16x32_bf16 v[20:23], a[228:231], a[20:23], v[20:23]
    buffer_load_dwordx4 v0, s[28:31], s35 offen offset:3080 lds
    v_mfma_f32_16x16x32_bf16 v[20:23], a[224:227], a[16:19], v[20:23]
    v_exp_f32 v16, v16
    v_mfma_f32_16x16x32_bf16 v[24:27], a[224:227], a[32:35], -4.0
    v_exp_f32 v17, v17
    v_mfma_f32_16x16x32_bf16 v[24:27], a[228:231], a[36:39], v[24:27]
    v_exp_f32 v18, v18
    v_mfma_f32_16x16x32_bf16 v[24:27], a[232:235], a[40:43], v[24:27]
    v_exp_f32 v19, v19
    v_mfma_f32_16x16x32_bf16 v[24:27], a[236:239], a[44:47], v[24:27]
    s_mov_b32 m0, s76
    ds_read_b64_tr_b16 a[252:253], v1 offset:50784
    ds_read_b64_tr_b16 a[254:255], v1 offset:51296
    v_mfma_f32_16x16x32_bf16 v[28:31], a[236:239], a[60:63], -4.0
    v_exp_f32 v20, v20
    v_mfma_f32_16x16x32_bf16 v[28:31], a[232:235], a[56:59], v[28:31]
    v_mov_b32_dpp v150, v182 row_ror:8 row_mask:0xf bank_mask:0xc
    v_cndmask_b32_dpp v167, v151, v183, vcc row_ror:8 row_mask:0xf bank_mask:0xf
    v_mfma_f32_16x16x32_bf16 v[28:31], a[228:231], a[52:55], v[28:31]
    v_exp_f32 v21, v21
    v_mfma_f32_16x16x32_bf16 v[28:31], a[224:227], a[48:51], v[28:31]
    buffer_store_dwordx4 v[164:167], v2, s[24:27], s43 offen offset:2048 sc1
    v_smfmac_f32_16x16x64_bf16 v[32:35], v[12:15], v[64:71], v57
    s_waitcnt lgkmcnt(6)
    v_mov_b32_dpp v151, v183 row_ror:8 row_mask:0xf bank_mask:0xc
    v_mfma_f32_16x16x32_bf16 v[128:131], a[240:243], v[64:67], v[128:131]
    s_waitcnt lgkmcnt(4)
    ds_read_b128 a[224:227], v60 offset:52448
    v_cvt_pk_bf16_f32 v96, v16, v17
    v_mfma_f32_16x16x32_bf16 v[128:131], a[244:247], v[68:71], v[128:131]
    v_exp_f32 v22, v22
    v_mfma_f32_16x16x32_bf16 v[132:135], a[244:247], v[76:79], 0
    ds_read_b128 a[228:231], v61 offset:53472
    v_cvt_pk_bf16_f32 v97, v18, v19
    v_mfma_f32_16x16x32_bf16 v[132:135], a[240:243], v[72:75], v[132:135]
    v_exp_f32 v23, v23
    v_mfma_f32_16x16x32_bf16 v[136:139], a[240:243], v[80:83], v[136:139]
    ds_read_b128 a[232:235], v60 offset:54496
    v_cvt_pk_bf16_f32 v104, v20, v21
    v_mfma_f32_16x16x32_bf16 v[136:139], a[244:247], v[84:87], v[136:139]
    v_exp_f32 v24, v24
    v_mfma_f32_16x16x32_bf16 v[140:143], a[244:247], v[92:95], v[140:143]
    ds_read_b128 a[236:239], v61 offset:55520
    v_cvt_pk_bf16_f32 v105, v22, v23
    v_mfma_f32_16x16x32_bf16 v[140:143], a[240:243], v[88:91], v[140:143]
    s_waitcnt lgkmcnt(6)
    v_exp_f32 v25, v25
    v_mfma_f32_16x16x32_bf16 v[156:159], a[248:251], v[88:91], v[156:159]
    s_waitcnt lgkmcnt(4)
    v_exp_f32 v26, v26
    v_mfma_f32_16x16x32_bf16 v[156:159], a[252:255], v[92:95], v[156:159]
    v_exp_f32 v27, v27
    v_mfma_f32_16x16x32_bf16 v[152:155], a[252:255], v[84:87], v[152:155]
    buffer_store_dwordx4 v[148:151], v2, s[24:27], s43 offen offset:0 sc1
    v_mfma_f32_16x16x32_bf16 v[152:155], a[248:251], v[80:83], v[152:155]
    v_cvt_pk_bf16_f32 v112, v24, v25
    v_cvt_pk_bf16_f32 v113, v26, v27
    v_mfma_f32_16x16x32_bf16 v[148:151], a[248:251], v[72:75], 0
    v_exp_f32 v28, v28
    v_mfma_f32_16x16x32_bf16 v[148:151], a[252:255], v[76:79], v[148:151]
    v_exp_f32 v29, v29
    v_mfma_f32_16x16x32_bf16 v[144:147], a[252:255], v[68:71], v[144:147]
    v_exp_f32 v30, v30
    v_mfma_f32_16x16x32_bf16 v[144:147], a[248:251], v[64:67], v[144:147]
    s_waitcnt lgkmcnt(3)
    v_exp_f32 v31, v31
    v_mfma_f32_16x16x32_bf16 v[16:19], a[224:227], a[0:3], -4.0
    s_waitcnt lgkmcnt(2)
    ds_read_b64_tr_b16 a[240:241], v1 offset:49816
    ds_read_b64_tr_b16 a[242:243], v1 offset:50328
    v_mfma_f32_16x16x32_bf16 v[16:19], a[228:231], a[4:7], v[16:19]
    s_waitcnt lgkmcnt(3)
    v_cvt_pk_bf16_f32 v120, v28, v29
    v_cvt_pk_bf16_f32 v121, v30, v31
    v_mfma_f32_16x16x32_bf16 v[16:19], a[232:235], a[8:11], v[16:19]
    s_waitcnt lgkmcnt(2)
    ds_read_b64_tr_b16 a[244:245], v1 offset:50840
    ds_read_b64_tr_b16 a[246:247], v1 offset:51352
    v_mfma_f32_16x16x32_bf16 v[16:19], a[236:239], a[12:15], v[16:19]
    v_max3_u32 v58, v58, v36, v50
    v_mov_b32 v36, 0
    v_mfma_f32_16x16x32_bf16 v[20:23], a[236:239], a[28:31], -4.0
    ds_read_b64_tr_b16 a[248:249], v1 offset:49824
    v_mov_b32 v37, 0
    v_mfma_f32_16x16x32_bf16 v[20:23], a[232:235], a[24:27], v[20:23]
    v_mul_f32 v196, v196, v50
    v_mul_f32 v197, v197, v50
    v_mfma_f32_16x16x32_bf16 v[20:23], a[228:231], a[20:23], v[20:23]
    ds_read_b64_tr_b16 a[250:251], v1 offset:50336
    ds_read_b64_tr_b16 a[252:253], v1 offset:50848
    v_mfma_f32_16x16x32_bf16 v[20:23], a[224:227], a[16:19], v[20:23]
    v_exp_f32 v16, v16
    v_mfma_f32_16x16x32_bf16 v[24:27], a[224:227], a[32:35], -4.0
    v_exp_f32 v17, v17
    v_mfma_f32_16x16x32_bf16 v[24:27], a[228:231], a[36:39], v[24:27]
    v_exp_f32 v18, v18
    v_mfma_f32_16x16x32_bf16 v[24:27], a[232:235], a[40:43], v[24:27]
    ds_read_b64_tr_b16 a[254:255], v1 offset:51360
    v_cvt_pk_bf16_f32 v98, v16, v17
    v_mfma_f32_16x16x32_bf16 v[24:27], a[236:239], a[44:47], v[24:27]
    v_exp_f32 v19, v19
    v_mfma_f32_16x16x32_bf16 v[28:31], a[236:239], a[60:63], -4.0
    ds_read_b128 a[236:239], v61 offset:59616
    v_cvt_pk_bf16_f32 v99, v18, v19
    v_mfma_f32_16x16x32_bf16 v[28:31], a[232:235], a[56:59], v[28:31]
    v_exp_f32 v20, v20
    v_mfma_f32_16x16x32_bf16 v[28:31], a[228:231], a[52:55], v[28:31]
    ds_read_b128 a[228:231], v61 offset:57568
    v_mul_f32 v198, v198, v50
    v_mfma_f32_16x16x32_bf16 v[28:31], a[224:227], a[48:51], v[28:31]
    v_exp_f32 v21, v21
    v_smfmac_f32_16x16x64_bf16 v[36:39], v[12:15], v[72:79], v57
    s_waitcnt lgkmcnt(8)
    v_cvt_pk_bf16_f32 v106, v20, v21
    v_mfma_f32_16x16x32_bf16 v[164:167], a[240:243], v[72:75], 0
    s_waitcnt lgkmcnt(6)
    ds_read_b128 a[224:227], v60 offset:56544
    v_mul_f32 v199, v199, v50
    v_mfma_f32_16x16x32_bf16 v[164:167], a[244:247], v[76:79], v[164:167]
    v_exp_f32 v22, v22
    v_mfma_f32_16x16x32_bf16 v[160:163], a[244:247], v[68:71], v[160:163]
    ds_read_b128 a[232:235], v60 offset:58592
    v_mul_f32 v212, v212, v50
    v_mfma_f32_16x16x32_bf16 v[160:163], a[240:243], v[64:67], v[160:163]
    v_exp_f32 v23, v23
    v_mfma_f32_16x16x32_bf16 v[168:171], a[240:243], v[80:83], v[168:171]
    v_cvt_pk_bf16_f32 v107, v22, v23
    v_mul_f32 v213, v213, v50
    v_mfma_f32_16x16x32_bf16 v[168:171], a[244:247], v[84:87], v[168:171]
    v_exp_f32 v24, v24
    v_mfma_f32_16x16x32_bf16 v[172:175], a[244:247], v[92:95], v[172:175]
    v_exp_f32 v25, v25
    v_mfma_f32_16x16x32_bf16 v[172:175], a[240:243], v[88:91], v[172:175]
    s_waitcnt lgkmcnt(6)
    v_exp_f32 v26, v26
    v_mfma_f32_16x16x32_bf16 v[188:191], a[248:251], v[88:91], v[188:191]
    s_waitcnt lgkmcnt(4)
    v_exp_f32 v27, v27
    v_mfma_f32_16x16x32_bf16 v[188:191], a[252:255], v[92:95], v[188:191]
    v_cvt_pk_bf16_f32 v114, v24, v25
    v_cvt_pk_bf16_f32 v115, v26, v27
    v_mfma_f32_16x16x32_bf16 v[184:187], a[252:255], v[84:87], v[184:187]
    v_exp_f32 v28, v28
    v_mfma_f32_16x16x32_bf16 v[184:187], a[248:251], v[80:83], v[184:187]
    v_exp_f32 v29, v29
    v_mfma_f32_16x16x32_bf16 v[176:179], a[248:251], v[64:67], v[176:179]
    v_exp_f32 v30, v30
    v_mfma_f32_16x16x32_bf16 v[176:179], a[252:255], v[68:71], v[176:179]
    v_exp_f32 v31, v31
    v_mfma_f32_16x16x32_bf16 v[180:183], a[252:255], v[76:79], 0
    ds_read_b64_tr_b16 a[240:241], v1 offset:49880
    ds_read_b64_tr_b16 a[242:243], v1 offset:50392
    v_mfma_f32_16x16x32_bf16 v[180:183], a[248:251], v[72:75], v[180:183]
    s_waitcnt lgkmcnt(3)
    v_cvt_pk_bf16_f32 v122, v28, v29
    v_cvt_pk_bf16_f32 v123, v30, v31
    v_mfma_f32_16x16x32_bf16 v[16:19], a[224:227], a[0:3], -4.0
    ds_read_b64_tr_b16 a[244:245], v1 offset:50904
    ds_read_b64_tr_b16 a[246:247], v1 offset:51416
    v_mfma_f32_16x16x32_bf16 v[16:19], a[228:231], a[4:7], v[16:19]
    s_waitcnt lgkmcnt(4)
    v_mul_f32 v214, v214, v50
    v_mul_f32 v215, v215, v50
    v_mfma_f32_16x16x32_bf16 v[16:19], a[232:235], a[8:11], v[16:19]
    ds_read_b64_tr_b16 a[248:249], v1 offset:49888
    ds_read_b64_tr_b16 a[250:251], v1 offset:50400
    v_mfma_f32_16x16x32_bf16 v[16:19], a[236:239], a[12:15], v[16:19]
    v_cvt_pk_bf16_f32 v215, v214, v215
    v_cvt_pk_bf16_f32 v214, v212, v213
    v_mfma_f32_16x16x32_bf16 v[20:23], a[236:239], a[28:31], -4.0
    ds_read_b64_tr_b16 a[252:253], v1 offset:50912
    ds_read_b64_tr_b16 a[254:255], v1 offset:51424
    v_mfma_f32_16x16x32_bf16 v[20:23], a[232:235], a[24:27], v[20:23]
    v_cvt_pk_bf16_f32 v212, v196, v197
    v_cvt_pk_bf16_f32 v213, v198, v199
    v_mfma_f32_16x16x32_bf16 v[20:23], a[228:231], a[20:23], v[20:23]
    v_mul_f32 v228, v228, v50
    v_mul_f32 v229, v229, v50
    v_mfma_f32_16x16x32_bf16 v[20:23], a[224:227], a[16:19], v[20:23]
    v_exp_f32 v16, v16
    v_mfma_f32_16x16x32_bf16 v[24:27], a[224:227], a[32:35], -4.0
L_hop6:
    s_cbranch_execz L_hop10
    v_exp_f32 v17, v17
    v_mfma_f32_16x16x32_bf16 v[24:27], a[228:231], a[36:39], v[24:27]
    v_exp_f32 v18, v18
    v_mfma_f32_16x16x32_bf16 v[24:27], a[232:235], a[40:43], v[24:27]
    v_exp_f32 v19, v19
    v_mfma_f32_16x16x32_bf16 v[24:27], a[236:239], a[44:47], v[24:27]
    v_mul_f32 v230, v230, v50
    v_mul_f32 v231, v231, v50
    v_mfma_f32_16x16x32_bf16 v[28:31], a[236:239], a[60:63], -4.0
    v_mul_f32 v244, v244, v50
    v_mul_f32 v245, v245, v50
    v_mfma_f32_16x16x32_bf16 v[28:31], a[232:235], a[56:59], v[28:31]
    v_mul_f32 v246, v246, v50
    v_mul_f32 v247, v247, v50
    v_mfma_f32_16x16x32_bf16 v[28:31], a[228:231], a[52:55], v[28:31]
    v_cvt_pk_bf16_f32 v247, v246, v247
    v_cvt_pk_bf16_f32 v246, v244, v245
    v_mfma_f32_16x16x32_bf16 v[28:31], a[224:227], a[48:51], v[28:31]
    v_exp_f32 v20, v20
    v_smfmac_f32_16x16x64_bf16 v[40:43], v[12:15], v[80:87], v57
    s_waitcnt lgkmcnt(6)
    v_cvt_pk_bf16_f32 v244, v228, v229
    v_mfma_f32_16x16x32_bf16 v[200:203], a[240:243], v[80:83], v[200:203]
    s_waitcnt lgkmcnt(4)
    v_cvt_pk_bf16_f32 v245, v230, v231
    v_cndmask_b32_dpp v230, v214, v246, vcc row_ror:8 row_mask:0xf bank_mask:0xf
    v_mfma_f32_16x16x32_bf16 v[200:203], a[244:247], v[84:87], v[200:203]
    v_exp_f32 v21, v21
    v_mfma_f32_16x16x32_bf16 v[192:195], a[244:247], v[68:71], v[192:195]
    v_cndmask_b32_dpp v228, v212, v244, vcc row_ror:8 row_mask:0xf bank_mask:0xf
    v_mov_b32_dpp v212, v244 row_ror:8 row_mask:0xf bank_mask:0xc
    v_mfma_f32_16x16x32_bf16 v[192:195], a[240:243], v[64:67], v[192:195]
    v_exp_f32 v22, v22
    v_mfma_f32_16x16x32_bf16 v[196:199], a[240:243], v[72:75], 0
    v_cndmask_b32_dpp v229, v213, v245, vcc row_ror:8 row_mask:0xf bank_mask:0xf
    v_mov_b32_dpp v213, v245 row_ror:8 row_mask:0xf bank_mask:0xc
    v_mfma_f32_16x16x32_bf16 v[196:199], a[244:247], v[76:79], v[196:199]
    v_exp_f32 v23, v23
    v_mfma_f32_16x16x32_bf16 v[204:207], a[244:247], v[92:95], v[204:207]
    v_mov_b32_dpp v214, v246 row_ror:8 row_mask:0xf bank_mask:0xc
    v_cndmask_b32_dpp v231, v215, v247, vcc row_ror:8 row_mask:0xf bank_mask:0xf
    v_mfma_f32_16x16x32_bf16 v[204:207], a[240:243], v[88:91], v[204:207]
    s_waitcnt lgkmcnt(2)
    ds_read_b128 a[224:227], v60 offset:60640
    v_mov_b32_dpp v215, v247 row_ror:8 row_mask:0xf bank_mask:0xc
    v_mfma_f32_16x16x32_bf16 v[220:223], a[248:251], v[88:91], v[220:223]
    s_waitcnt lgkmcnt(1)
    buffer_store_dwordx4 v[212:215], v2, s[24:27], s43 offen offset:128 sc1
    v_mfma_f32_16x16x32_bf16 v[220:223], a[252:255], v[92:95], v[220:223]
    ds_read_b128 a[228:231], v61 offset:61664
    v_cvt_pk_bf16_f32 v100, v16, v17
    v_mfma_f32_16x16x32_bf16 v[212:215], a[252:255], v[76:79], 0
    v_exp_f32 v24, v24
    v_mfma_f32_16x16x32_bf16 v[212:215], a[248:251], v[72:75], v[212:215]
    ds_read_b128 a[232:235], v60 offset:62688
    v_cvt_pk_bf16_f32 v101, v18, v19
    v_mfma_f32_16x16x32_bf16 v[208:211], a[248:251], v[64:67], v[208:211]
    ds_read_b128 a[236:239], v61 offset:63712
    v_cvt_pk_bf16_f32 v108, v20, v21
    v_mfma_f32_16x16x32_bf16 v[208:211], a[252:255], v[68:71], v[208:211]
    v_exp_f32 v25, v25
    v_mfma_f32_16x16x32_bf16 v[216:219], a[252:255], v[84:87], v[216:219]
    v_exp_f32 v26, v26
    v_mfma_f32_16x16x32_bf16 v[216:219], a[248:251], v[80:83], v[216:219]
    s_waitcnt lgkmcnt(3)
    v_cvt_pk_bf16_f32 v109, v22, v23
    v_cvt_pk_bf16_f32 v116, v24, v25
    v_mfma_f32_16x16x32_bf16 v[16:19], a[224:227], a[32:35], -4.0
    s_waitcnt lgkmcnt(2)
    v_exp_f32 v27, v27
    v_mfma_f32_16x16x32_bf16 v[16:19], a[228:231], a[36:39], v[16:19]
    s_waitcnt vmcnt(7) lgkmcnt(1)
    ds_read_b128 a[32:35], v3 offset:0
    v_cvt_pk_bf16_f32 v117, v26, v27
    v_mfma_f32_16x16x32_bf16 v[16:19], a[232:235], a[40:43], v[16:19]
    s_waitcnt lgkmcnt(1)
    v_exp_f32 v28, v28
    v_mfma_f32_16x16x32_bf16 v[16:19], a[236:239], a[44:47], v[16:19]
    v_exp_f32 v29, v29
    v_mfma_f32_16x16x32_bf16 v[20:23], a[236:239], a[12:15], -4.0
    ds_read_b128 a[36:39], v3 offset:64
    v_cvt_pk_bf16_f32 v124, v28, v29
    v_mfma_f32_16x16x32_bf16 v[20:23], a[232:235], a[8:11], v[20:23]
    v_exp_f32 v30, v30
    v_mfma_f32_16x16x32_bf16 v[20:23], a[228:231], a[4:7], v[20:23]
    v_exp_f32 v31, v31
    v_mfma_f32_16x16x32_bf16 v[20:23], a[224:227], a[0:3], v[20:23]
    ds_read_b128 a[40:43], v3 offset:128
    v_cvt_pk_bf16_f32 v125, v30, v31
    v_mfma_f32_16x16x32_bf16 v[24:27], a[224:227], a[16:19], -4.0
    v_exp_f32 v16, v16
    v_mfma_f32_16x16x32_bf16 v[24:27], a[228:231], a[20:23], v[24:27]
    buffer_store_dwordx4 v[228:231], v2, s[24:27], s43 offen offset:2176 sc1
    v_mfma_f32_16x16x32_bf16 v[24:27], a[232:235], a[24:27], v[24:27]
    s_add_u32 s43, s43, 4096
    ds_read_b64_tr_b16 a[240:241], v1 offset:49944
    ds_read_b64_tr_b16 a[242:243], v1 offset:50456
    v_mfma_f32_16x16x32_bf16 v[24:27], a[236:239], a[28:31], v[24:27]
    ds_read_b64_tr_b16 a[244:245], v1 offset:50968
    ds_read_b64_tr_b16 a[246:247], v1 offset:51480
    v_mfma_f32_16x16x32_bf16 v[28:31], a[236:239], a[60:63], -4.0
    v_exp_f32 v17, v17
    v_mfma_f32_16x16x32_bf16 v[28:31], a[232:235], a[56:59], v[28:31]
    v_exp_f32 v18, v18
    v_mfma_f32_16x16x32_bf16 v[28:31], a[228:231], a[52:55], v[28:31]
    ds_read_b128 a[44:47], v3 offset:192
    v_cvt_pk_bf16_f32 v118, v16, v17
    v_mfma_f32_16x16x32_bf16 v[28:31], a[224:227], a[48:51], v[28:31]
    v_exp_f32 v19, v19
    v_smfmac_f32_16x16x64_bf16 v[44:47], v[12:15], v[88:95], v57
    s_waitcnt lgkmcnt(3)
    ds_read_b64_tr_b16 a[248:249], v1 offset:49952
    v_mfma_f32_16x16x32_bf16 v[236:239], a[240:243], v[88:91], v[236:239]
    s_waitcnt lgkmcnt(2)
    v_exp_f32 v20, v20
    v_mfma_f32_16x16x32_bf16 v[236:239], a[244:247], v[92:95], v[236:239]
    ds_read_b64_tr_b16 a[250:251], v1 offset:50464
    ds_read_b64_tr_b16 a[252:253], v1 offset:50976
    v_mfma_f32_16x16x32_bf16 v[224:227], a[244:247], v[68:71], v[224:227]
    ds_read_b64_tr_b16 a[254:255], v1 offset:51488
    v_cvt_pk_bf16_f32 v119, v18, v19
    v_mfma_f32_16x16x32_bf16 v[224:227], a[240:243], v[64:67], v[224:227]
    v_exp_f32 v21, v21
    v_mfma_f32_16x16x32_bf16 v[228:231], a[240:243], v[72:75], 0
    v_exp_f32 v22, v22
    v_mfma_f32_16x16x32_bf16 v[228:231], a[244:247], v[76:79], v[228:231]
    s_waitcnt lgkmcnt(4)
    buffer_load_dwordx4 v0, s[12:15], s42 offen offset:0 nt lds
    v_mfma_f32_16x16x32_bf16 v[232:235], a[244:247], v[84:87], v[232:235]
    s_waitcnt vmcnt(5) lgkmcnt(2)
    ds_read_b128 a[224:227], v62 offset:0
    v_cvt_pk_bf16_f32 v102, v20, v21
    v_mfma_f32_16x16x32_bf16 v[232:235], a[240:243], v[80:83], v[232:235]
    s_barrier
    v_exp_f32 v23, v23
    v_mfma_f32_16x16x32_bf16 v[248:251], a[248:251], v[80:83], v[248:251]
    s_waitcnt lgkmcnt(1)
    ds_read_b128 a[228:231], v63 offset:1024
    v_cvt_pk_bf16_f32 v103, v22, v23
    v_mfma_f32_16x16x32_bf16 v[248:251], a[252:255], v[84:87], v[248:251]
    s_mov_b32 m0, s77
    v_exp_f32 v24, v24
    v_mfma_f32_16x16x32_bf16 v[244:247], a[252:255], v[76:79], 0
    buffer_load_dwordx4 v0, s[12:15], s42 offen offset:1024 nt lds
    v_mfma_f32_16x16x32_bf16 v[244:247], a[248:251], v[72:75], v[244:247]
    s_mov_b32 m0, s78
    ds_read_b128 a[232:235], v62 offset:2048
    v_mfma_f32_16x16x32_bf16 v[240:243], a[248:251], v[64:67], v[240:243]
    ds_read_b128 a[236:239], v63 offset:3072
    v_mfma_f32_16x16x32_bf16 v[240:243], a[252:255], v[68:71], v[240:243]
    v_exp_f32 v25, v25
    v_mfma_f32_16x16x32_bf16 v[252:255], a[252:255], v[92:95], v[252:255]
    v_exp_f32 v26, v26
    v_mfma_f32_16x16x32_bf16 v[252:255], a[248:251], v[88:91], v[252:255]
    s_waitcnt lgkmcnt(3)
    buffer_load_dwordx4 v0, s[12:15], s42 offen offset:2048 nt lds
    v_mfma_f32_16x16x32_bf16 v[16:19], a[224:227], a[0:3], -4.0
    s_waitcnt lgkmcnt(2)
    v_exp_f32 v27, v27
    v_mfma_f32_16x16x32_bf16 v[16:19], a[228:231], a[4:7], v[16:19]
    s_waitcnt lgkmcnt(1)
    v_cvt_pk_bf16_f32 v110, v24, v25
    v_cvt_pk_bf16_f32 v111, v26, v27
    v_mfma_f32_16x16x32_bf16 v[16:19], a[232:235], a[8:11], v[16:19]
    s_waitcnt lgkmcnt(0)
    v_exp_f32 v28, v28
    v_mfma_f32_16x16x32_bf16 v[16:19], a[236:239], a[12:15], v[16:19]
    s_mov_b32 m0, s79
    v_exp_f32 v29, v29
    v_mfma_f32_16x16x32_bf16 v[20:23], a[236:239], a[28:31], -4.0
    buffer_load_dwordx4 v0, s[12:15], s42 offen offset:3072 nt lds
    v_mfma_f32_16x16x32_bf16 v[20:23], a[232:235], a[24:27], v[20:23]
    v_exp_f32 v30, v30
    v_mfma_f32_16x16x32_bf16 v[20:23], a[228:231], a[20:23], v[20:23]
    v_exp_f32 v31, v31
    v_mfma_f32_16x16x32_bf16 v[20:23], a[224:227], a[16:19], v[20:23]
    s_add_u32 s42, s42, 4096
    ds_read_b64_tr_b16 a[240:241], v1 offset:33168
    ds_read_b64_tr_b16 a[242:243], v1 offset:33680
    v_mfma_f32_16x16x32_bf16 v[24:27], a[224:227], a[48:51], -4.0
    v_exp_f32 v16, v16
    v_mfma_f32_16x16x32_bf16 v[24:27], a[228:231], a[52:55], v[24:27]
    v_cvt_pk_bf16_f32 v126, v28, v29
    v_cvt_pk_bf16_f32 v127, v30, v31
    v_mfma_f32_16x16x32_bf16 v[24:27], a[232:235], a[56:59], v[24:27]
    s_mov_b32 m0, s98
    ds_read_b64_tr_b16 a[244:245], v1 offset:34192
    ds_read_b64_tr_b16 a[246:247], v1 offset:34704
    v_mfma_f32_16x16x32_bf16 v[24:27], a[236:239], a[60:63], v[24:27]
    v_exp_f32 v17, v17
    v_mfma_f32_16x16x32_bf16 v[28:31], a[236:239], a[44:47], -4.0
    v_exp_f32 v18, v18
    v_mfma_f32_16x16x32_bf16 v[28:31], a[232:235], a[40:43], v[28:31]
    ds_read_b64_tr_b16 a[248:249], v1 offset:33176
    ds_read_b64_tr_b16 a[250:251], v1 offset:33688
    v_mfma_f32_16x16x32_bf16 v[28:31], a[228:231], a[36:39], v[28:31]
    v_exp_f32 v19, v19
    v_mfma_f32_16x16x32_bf16 v[28:31], a[224:227], a[32:35], v[28:31]
    ds_read_b64_tr_b16 a[252:253], v1 offset:34200
    ds_read_b64_tr_b16 a[254:255], v1 offset:34712
    v_smfmac_f32_16x16x64_bf16 v[40:43], v[12:15], v[112:119], v57
    s_waitcnt lgkmcnt(6)
    v_cvt_pk_bf16_f32 v64, v16, v17
    v_mfma_f32_16x16x32_bf16 v[136:139], a[240:243], v[112:115], v[136:139]
    s_waitcnt lgkmcnt(4)
    v_exp_f32 v20, v20
    v_mfma_f32_16x16x32_bf16 v[136:139], a[244:247], v[116:119], v[136:139]
    ds_read_b128 a[224:227], v62 offset:4096
    v_cvt_pk_bf16_f32 v65, v18, v19
    v_mfma_f32_16x16x32_bf16 v[128:131], a[244:247], v[100:103], v[128:131]
    v_exp_f32 v21, v21
    v_mfma_f32_16x16x32_bf16 v[128:131], a[240:243], v[96:99], v[128:131]
    ds_read_b128 a[228:231], v63 offset:5120
    v_cvt_pk_bf16_f32 v72, v20, v21
    v_mfma_f32_16x16x32_bf16 v[132:135], a[240:243], v[104:107], v[132:135]
    v_exp_f32 v22, v22
    v_mfma_f32_16x16x32_bf16 v[132:135], a[244:247], v[108:111], v[132:135]
    ds_read_b128 a[232:235], v62 offset:6144
    v_add_f32 v40, v40, v41
    v_mfma_f32_16x16x32_bf16 v[140:143], a[244:247], v[124:127], v[140:143]
    v_exp_f32 v23, v23
    v_mfma_f32_16x16x32_bf16 v[140:143], a[240:243], v[120:123], v[140:143]
    s_waitcnt lgkmcnt(5)
    ds_read_b128 a[236:239], v63 offset:7168
    v_cvt_pk_bf16_f32 v73, v22, v23
    v_mfma_f32_16x16x32_bf16 v[156:159], a[248:251], v[120:123], v[156:159]
    s_waitcnt lgkmcnt(4)
    v_exp_f32 v24, v24
    v_mfma_f32_16x16x32_bf16 v[156:159], a[252:255], v[124:127], v[156:159]
    v_exp_f32 v25, v25
    v_mfma_f32_16x16x32_bf16 v[148:151], a[252:255], v[108:111], v[148:151]
    v_exp_f32 v26, v26
    v_mfma_f32_16x16x32_bf16 v[148:151], a[248:251], v[104:107], v[148:151]
    v_exp_f32 v27, v27
    v_mfma_f32_16x16x32_bf16 v[144:147], a[248:251], v[96:99], v[144:147]
    v_cvt_pk_bf16_f32 v88, v24, v25
    v_cvt_pk_bf16_f32 v89, v26, v27
    v_mfma_f32_16x16x32_bf16 v[144:147], a[252:255], v[100:103], v[144:147]
    v_exp_f32 v28, v28
    v_mfma_f32_16x16x32_bf16 v[152:155], a[252:255], v[116:119], v[152:155]
    v_exp_f32 v29, v29
    v_mfma_f32_16x16x32_bf16 v[152:155], a[248:251], v[112:115], v[152:155]
    s_waitcnt lgkmcnt(3)
    v_exp_f32 v30, v30
    v_mfma_f32_16x16x32_bf16 v[16:19], a[224:227], a[0:3], -4.0
    s_waitcnt lgkmcnt(2)
    v_exp_f32 v31, v31
    v_mfma_f32_16x16x32_bf16 v[16:19], a[228:231], a[4:7], v[16:19]
    s_waitcnt lgkmcnt(1)
    ds_read_b64_tr_b16 a[240:241], v1 offset:33232
    ds_read_b64_tr_b16 a[242:243], v1 offset:33744
    v_mfma_f32_16x16x32_bf16 v[16:19], a[232:235], a[8:11], v[16:19]
    s_waitcnt lgkmcnt(2)
    v_rcp_f32 v48, v40
    v_mfma_f32_16x16x32_bf16 v[16:19], a[236:239], a[12:15], v[16:19]
    v_cvt_pk_bf16_f32 v80, v28, v29
    v_cvt_pk_bf16_f32 v81, v30, v31
    v_mfma_f32_16x16x32_bf16 v[20:23], a[236:239], a[28:31], -4.0
    ds_read_b64_tr_b16 a[244:245], v1 offset:34256
    ds_read_b64_tr_b16 a[246:247], v1 offset:34768
    v_mfma_f32_16x16x32_bf16 v[20:23], a[232:235], a[24:27], v[20:23]
    v_mul_f32 v136, v136, v48
    v_mul_f32 v137, v137, v48
    v_mfma_f32_16x16x32_bf16 v[20:23], a[228:231], a[20:23], v[20:23]
    ds_read_b64_tr_b16 a[248:249], v1 offset:33240
    ds_read_b64_tr_b16 a[250:251], v1 offset:33752
    v_mfma_f32_16x16x32_bf16 v[20:23], a[224:227], a[16:19], v[20:23]
    v_exp_f32 v16, v16
    v_mfma_f32_16x16x32_bf16 v[24:27], a[224:227], a[32:35], -4.0
    v_exp_f32 v17, v17
    v_mfma_f32_16x16x32_bf16 v[24:27], a[228:231], a[36:39], v[24:27]
    ds_read_b64_tr_b16 a[252:253], v1 offset:34264
    ds_read_b64_tr_b16 a[254:255], v1 offset:34776
    v_mfma_f32_16x16x32_bf16 v[24:27], a[232:235], a[40:43], v[24:27]
    v_exp_f32 v18, v18
    v_mfma_f32_16x16x32_bf16 v[24:27], a[236:239], a[44:47], v[24:27]
    v_exp_f32 v19, v19
    v_mfma_f32_16x16x32_bf16 v[28:31], a[236:239], a[60:63], -4.0
    ds_read_b128 a[236:239], v63 offset:11264
    v_cvt_pk_bf16_f32 v66, v16, v17
    v_mfma_f32_16x16x32_bf16 v[28:31], a[232:235], a[56:59], v[28:31]
    v_exp_f32 v20, v20
    v_mfma_f32_16x16x32_bf16 v[28:31], a[228:231], a[52:55], v[28:31]
    ds_read_b128 a[228:231], v63 offset:9216
    v_cvt_pk_bf16_f32 v67, v18, v19
    v_mfma_f32_16x16x32_bf16 v[28:31], a[224:227], a[48:51], v[28:31]
    v_exp_f32 v21, v21
    v_smfmac_f32_16x16x64_bf16 v[32:35], v[12:15], v[96:103], v57
    s_waitcnt lgkmcnt(8)
    v_cvt_pk_bf16_f32 v74, v20, v21
    v_mfma_f32_16x16x32_bf16 v[160:163], a[240:243], v[96:99], v[160:163]
    s_waitcnt lgkmcnt(6)
    ds_read_b128 a[224:227], v62 offset:8192
    v_mul_f32 v138, v138, v48
    v_mfma_f32_16x16x32_bf16 v[160:163], a[244:247], v[100:103], v[160:163]
    v_exp_f32 v22, v22
    v_mfma_f32_16x16x32_bf16 v[168:171], a[244:247], v[116:119], v[168:171]
    ds_read_b128 a[232:235], v62 offset:10240
    v_mul_f32 v139, v139, v48
    v_mfma_f32_16x16x32_bf16 v[168:171], a[240:243], v[112:115], v[168:171]
    v_exp_f32 v23, v23
    v_mfma_f32_16x16x32_bf16 v[164:167], a[240:243], v[104:107], v[164:167]
    v_cvt_pk_bf16_f32 v75, v22, v23
    v_mul_f32 v152, v152, v48
    v_mfma_f32_16x16x32_bf16 v[164:167], a[244:247], v[108:111], v[164:167]
    v_exp_f32 v24, v24
    v_mfma_f32_16x16x32_bf16 v[172:175], a[244:247], v[124:127], v[172:175]
    v_exp_f32 v25, v25
    v_mfma_f32_16x16x32_bf16 v[172:175], a[240:243], v[120:123], v[172:175]
    s_waitcnt lgkmcnt(6)
    v_exp_f32 v26, v26
    v_mfma_f32_16x16x32_bf16 v[188:191], a[248:251], v[120:123], v[188:191]
    s_waitcnt lgkmcnt(4)
    v_exp_f32 v27, v27
    v_mfma_f32_16x16x32_bf16 v[188:191], a[252:255], v[124:127], v[188:191]
    v_cvt_pk_bf16_f32 v82, v24, v25
    v_cvt_pk_bf16_f32 v83, v26, v27
    v_mfma_f32_16x16x32_bf16 v[180:183], a[252:255], v[108:111], v[180:183]
    v_exp_f32 v28, v28
    v_mfma_f32_16x16x32_bf16 v[180:183], a[248:251], v[104:107], v[180:183]
    v_exp_f32 v29, v29
    v_mfma_f32_16x16x32_bf16 v[184:187], a[248:251], v[112:115], v[184:187]
    v_exp_f32 v30, v30
    v_mfma_f32_16x16x32_bf16 v[184:187], a[252:255], v[116:119], v[184:187]
    v_exp_f32 v31, v31
    v_mfma_f32_16x16x32_bf16 v[176:179], a[252:255], v[100:103], v[176:179]
    ds_read_b64_tr_b16 a[240:241], v1 offset:33296
    ds_read_b64_tr_b16 a[242:243], v1 offset:33808
    v_mfma_f32_16x16x32_bf16 v[176:179], a[248:251], v[96:99], v[176:179]
    s_waitcnt lgkmcnt(3)
    v_cvt_pk_bf16_f32 v90, v28, v29
    v_cvt_pk_bf16_f32 v91, v30, v31
    v_mfma_f32_16x16x32_bf16 v[16:19], a[224:227], a[0:3], -4.0
    ds_read_b64_tr_b16 a[244:245], v1 offset:34320
    ds_read_b64_tr_b16 a[246:247], v1 offset:34832
    v_mfma_f32_16x16x32_bf16 v[16:19], a[228:231], a[4:7], v[16:19]
    s_waitcnt lgkmcnt(4)
    v_mul_f32 v153, v153, v48
    v_mul_f32 v154, v154, v48
    v_mfma_f32_16x16x32_bf16 v[16:19], a[232:235], a[8:11], v[16:19]
    ds_read_b64_tr_b16 a[248:249], v1 offset:33304
    ds_read_b64_tr_b16 a[250:251], v1 offset:33816
    v_mfma_f32_16x16x32_bf16 v[16:19], a[236:239], a[12:15], v[16:19]
    v_mul_f32 v155, v155, v48
    v_cvt_pk_bf16_f32 v155, v154, v155
    v_mfma_f32_16x16x32_bf16 v[20:23], a[236:239], a[28:31], -4.0
    ds_read_b64_tr_b16 a[252:253], v1 offset:34328
    ds_read_b64_tr_b16 a[254:255], v1 offset:34840
    v_mfma_f32_16x16x32_bf16 v[20:23], a[232:235], a[24:27], v[20:23]
    v_cvt_pk_bf16_f32 v154, v152, v153
    v_cvt_pk_bf16_f32 v152, v136, v137
    v_mfma_f32_16x16x32_bf16 v[20:23], a[228:231], a[20:23], v[20:23]
    v_cvt_pk_bf16_f32 v153, v138, v139
    v_mul_f32 v168, v168, v48
    v_mfma_f32_16x16x32_bf16 v[20:23], a[224:227], a[16:19], v[20:23]
    v_exp_f32 v16, v16
    v_mfma_f32_16x16x32_bf16 v[24:27], a[224:227], a[32:35], -4.0
    v_exp_f32 v17, v17
    v_mfma_f32_16x16x32_bf16 v[24:27], a[228:231], a[36:39], v[24:27]
    v_exp_f32 v18, v18
    v_mfma_f32_16x16x32_bf16 v[24:27], a[232:235], a[40:43], v[24:27]
    v_exp_f32 v19, v19
    v_mfma_f32_16x16x32_bf16 v[24:27], a[236:239], a[44:47], v[24:27]
    v_cvt_pk_bf16_f32 v68, v16, v17
    v_cvt_pk_bf16_f32 v69, v18, v19
    v_mfma_f32_16x16x32_bf16 v[28:31], a[236:239], a[60:63], -4.0
    v_exp_f32 v20, v20
    v_mfma_f32_16x16x32_bf16 v[28:31], a[232:235], a[56:59], v[28:31]
    ds_read_b128 a[232:235], v62 offset:14336
    v_mul_f32 v169, v169, v48
    v_mfma_f32_16x16x32_bf16 v[28:31], a[228:231], a[52:55], v[28:31]
    v_exp_f32 v21, v21
    v_mfma_f32_16x16x32_bf16 v[28:31], a[224:227], a[48:51], v[28:31]
    ds_read_b128 a[224:227], v62 offset:12288
    v_cvt_pk_bf16_f32 v76, v20, v21
    v_smfmac_f32_16x16x64_bf16 v[36:39], v[12:15], v[104:111], v57
    s_waitcnt lgkmcnt(8)
    v_mul_f32 v170, v170, v48
    v_mfma_f32_16x16x32_bf16 v[196:199], a[240:243], v[104:107], v[196:199]
    s_waitcnt lgkmcnt(6)
    ds_read_b128 a[228:231], v63 offset:13312
    v_mul_f32 v171, v171, v48
    v_mfma_f32_16x16x32_bf16 v[196:199], a[244:247], v[108:111], v[196:199]
    v_exp_f32 v22, v22
    v_mfma_f32_16x16x32_bf16 v[200:203], a[244:247], v[116:119], v[200:203]
    ds_read_b128 a[236:239], v63 offset:15360
    v_mul_f32 v184, v184, v48
    v_mfma_f32_16x16x32_bf16 v[200:203], a[240:243], v[112:115], v[200:203]
    v_exp_f32 v23, v23
    v_mfma_f32_16x16x32_bf16 v[192:195], a[240:243], v[96:99], v[192:195]
    v_cvt_pk_bf16_f32 v77, v22, v23
    v_mul_f32 v185, v185, v48
    v_mfma_f32_16x16x32_bf16 v[192:195], a[244:247], v[100:103], v[192:195]
    v_exp_f32 v24, v24
    v_mfma_f32_16x16x32_bf16 v[204:207], a[244:247], v[124:127], v[204:207]
    v_exp_f32 v25, v25
    v_mfma_f32_16x16x32_bf16 v[204:207], a[240:243], v[120:123], v[204:207]
    s_waitcnt lgkmcnt(6)
    v_exp_f32 v26, v26
    v_mfma_f32_16x16x32_bf16 v[220:223], a[248:251], v[120:123], v[220:223]
    s_waitcnt lgkmcnt(4)
    v_exp_f32 v27, v27
    v_mfma_f32_16x16x32_bf16 v[220:223], a[252:255], v[124:127], v[220:223]
    v_cvt_pk_bf16_f32 v84, v24, v25
    v_cvt_pk_bf16_f32 v85, v26, v27
    v_mfma_f32_16x16x32_bf16 v[208:211], a[252:255], v[100:103], v[208:211]
    v_exp_f32 v28, v28
    v_mfma_f32_16x16x32_bf16 v[208:211], a[248:251], v[96:99], v[208:211]
    v_exp_f32 v29, v29
    v_mfma_f32_16x16x32_bf16 v[216:219], a[248:251], v[112:115], v[216:219]
    v_exp_f32 v30, v30
    v_mfma_f32_16x16x32_bf16 v[216:219], a[252:255], v[116:119], v[216:219]
    v_exp_f32 v31, v31
    v_mfma_f32_16x16x32_bf16 v[212:215], a[252:255], v[108:111], v[212:215]
    ds_read_b64_tr_b16 a[240:241], v1 offset:33360
    ds_read_b64_tr_b16 a[242:243], v1 offset:33872
    v_mfma_f32_16x16x32_bf16 v[212:215], a[248:251], v[104:107], v[212:215]
    s_waitcnt lgkmcnt(4)
    v_cvt_pk_bf16_f32 v92, v28, v29
    v_cvt_pk_bf16_f32 v93, v30, v31
    v_mfma_f32_16x16x32_bf16 v[16:19], a[224:227], a[0:3], -4.0
    s_waitcnt lgkmcnt(3)
    ds_read_b64_tr_b16 a[244:245], v1 offset:34384
    ds_read_b64_tr_b16 a[246:247], v1 offset:34896
    v_mfma_f32_16x16x32_bf16 v[16:19], a[228:231], a[4:7], v[16:19]
    v_mul_f32 v186, v186, v48
    v_mul_f32 v187, v187, v48
    v_mfma_f32_16x16x32_bf16 v[16:19], a[232:235], a[8:11], v[16:19]
    s_waitcnt lgkmcnt(4)
    ds_read_b64_tr_b16 a[248:249], v1 offset:33368
    ds_read_b64_tr_b16 a[250:251], v1 offset:33880
    v_mfma_f32_16x16x32_bf16 v[16:19], a[236:239], a[12:15], v[16:19]
    v_cvt_pk_bf16_f32 v187, v186, v187
    v_cvt_pk_bf16_f32 v186, v184, v185
    v_mfma_f32_16x16x32_bf16 v[20:23], a[236:239], a[28:31], -4.0
    ds_read_b64_tr_b16 a[252:253], v1 offset:34392
    ds_read_b64_tr_b16 a[254:255], v1 offset:34904
    v_mfma_f32_16x16x32_bf16 v[20:23], a[232:235], a[24:27], v[20:23]
    v_cvt_pk_bf16_f32 v184, v168, v169
    v_cvt_pk_bf16_f32 v185, v170, v171
    v_mfma_f32_16x16x32_bf16 v[20:23], a[228:231], a[20:23], v[20:23]
    v_cndmask_b32_dpp v170, v154, v186, vcc row_ror:8 row_mask:0xf bank_mask:0xf
    v_mov_b32_dpp v154, v186 row_ror:8 row_mask:0xf bank_mask:0xc
    v_mfma_f32_16x16x32_bf16 v[20:23], a[224:227], a[16:19], v[20:23]
    v_exp_f32 v16, v16
    v_mfma_f32_16x16x32_bf16 v[24:27], a[224:227], a[32:35], -4.0
    v_exp_f32 v17, v17
    v_mfma_f32_16x16x32_bf16 v[24:27], a[228:231], a[36:39], v[24:27]
    v_exp_f32 v18, v18
    v_mfma_f32_16x16x32_bf16 v[24:27], a[232:235], a[40:43], v[24:27]
    v_exp_f32 v19, v19
    v_mfma_f32_16x16x32_bf16 v[24:27], a[236:239], a[44:47], v[24:27]
    v_exp_f32 v20, v20
    v_mfma_f32_16x16x32_bf16 v[28:31], a[236:239], a[60:63], -4.0
    ds_read_b128 a[236:239], v63 offset:19456
    v_cvt_pk_bf16_f32 v70, v16, v17
    v_mfma_f32_16x16x32_bf16 v[28:31], a[232:235], a[56:59], v[28:31]
    v_exp_f32 v21, v21
    v_mfma_f32_16x16x32_bf16 v[28:31], a[228:231], a[52:55], v[28:31]
    ds_read_b128 a[228:231], v63 offset:17408
    v_cvt_pk_bf16_f32 v71, v18, v19
    v_mfma_f32_16x16x32_bf16 v[28:31], a[224:227], a[48:51], v[28:31]
    v_exp_f32 v22, v22
    v_smfmac_f32_16x16x64_bf16 v[44:47], v[12:15], v[120:127], v57
    s_waitcnt lgkmcnt(8)
    v_cvt_pk_bf16_f32 v78, v20, v21
    v_mfma_f32_16x16x32_bf16 v[236:239], a[240:243], v[120:123], v[236:239]
    s_waitcnt lgkmcnt(6)
    ds_read_b128 a[224:227], v62 offset:16384
    v_cndmask_b32_dpp v168, v152, v184, vcc row_ror:8 row_mask:0xf bank_mask:0xf
    v_mfma_f32_16x16x32_bf16 v[236:239], a[244:247], v[124:127], v[236:239]
    v_exp_f32 v23, v23
    v_mfma_f32_16x16x32_bf16 v[232:235], a[244:247], v[116:119], v[232:235]
    ds_read_b128 a[232:235], v62 offset:18432
    v_cvt_pk_bf16_f32 v79, v22, v23
    v_mfma_f32_16x16x32_bf16 v[232:235], a[240:243], v[112:115], v[232:235]
    v_exp_f32 v24, v24
    v_mfma_f32_16x16x32_bf16 v[224:227], a[240:243], v[96:99], v[224:227]
    v_exp_f32 v25, v25
    v_mfma_f32_16x16x32_bf16 v[224:227], a[244:247], v[100:103], v[224:227]
    v_exp_f32 v26, v26
    v_mfma_f32_16x16x32_bf16 v[228:231], a[244:247], v[108:111], v[228:231]
    s_waitcnt lgkmcnt(4)
    v_exp_f32 v27, v27
    v_mfma_f32_16x16x32_bf16 v[228:231], a[240:243], v[104:107], v[228:231]
    s_barrier
    buffer_load_dwordx4 v0, s[20:23], s37 offen offset:1024 lds
    v_mfma_f32_16x16x32_bf16 v[244:247], a[248:251], v[104:107], v[244:247]
    v_cvt_pk_bf16_f32 v86, v24, v25
    v_cvt_pk_bf16_f32 v87, v26, v27
    v_mfma_f32_16x16x32_bf16 v[244:247], a[252:255], v[108:111], v[244:247]
    v_exp_f32 v28, v28
    v_mfma_f32_16x16x32_bf16 v[240:243], a[252:255], v[100:103], v[240:243]
    v_exp_f32 v29, v29
    v_mfma_f32_16x16x32_bf16 v[240:243], a[248:251], v[96:99], v[240:243]
    v_exp_f32 v30, v30
    v_mfma_f32_16x16x32_bf16 v[248:251], a[248:251], v[112:115], v[248:251]
    buffer_load_dwordx4 v0, s[28:31], s37 offen offset:3080 lds
    v_mfma_f32_16x16x32_bf16 v[248:251], a[252:255], v[116:119], v[248:251]
    s_mov_b32 m0, s99
    v_exp_f32 v31, v31
    v_mfma_f32_16x16x32_bf16 v[252:255], a[252:255], v[124:127], v[252:255]
    v_cvt_pk_bf16_f32 v94, v28, v29
    v_cvt_pk_bf16_f32 v95, v30, v31
    v_mfma_f32_16x16x32_bf16 v[252:255], a[248:251], v[120:123], v[252:255]
    s_waitcnt lgkmcnt(1)
    v_mov_b32_dpp v152, v184 row_ror:8 row_mask:0xf bank_mask:0xc
    v_cndmask_b32_dpp v169, v153, v185, vcc row_ror:8 row_mask:0xf bank_mask:0xf
    v_mfma_f32_16x16x32_bf16 v[16:19], a[224:227], a[0:3], -4.0
    v_mov_b32_dpp v153, v185 row_ror:8 row_mask:0xf bank_mask:0xc
    v_cndmask_b32_dpp v171, v155, v187, vcc row_ror:8 row_mask:0xf bank_mask:0xf
    v_mfma_f32_16x16x32_bf16 v[16:19], a[228:231], a[4:7], v[16:19]
    s_waitcnt lgkmcnt(0)
    buffer_store_dwordx4 v[168:171], v2, s[24:27], s43 offen offset:2048 sc1
    v_mfma_f32_16x16x32_bf16 v[16:19], a[232:235], a[8:11], v[16:19]
    v_mov_b32_dpp v155, v187 row_ror:8 row_mask:0xf bank_mask:0xc
    v_max3_u32 v58, v58, v40, v48
    v_mfma_f32_16x16x32_bf16 v[16:19], a[236:239], a[12:15], v[16:19]
    v_mov_b32 v40, 0
    v_mov_b32 v41, 0
    v_mfma_f32_16x16x32_bf16 v[20:23], a[236:239], a[28:31], -4.0
    v_mul_f32 v200, v200, v48
    v_mul_f32 v201, v201, v48
    v_mfma_f32_16x16x32_bf16 v[20:23], a[232:235], a[24:27], v[20:23]
    v_mul_f32 v202, v202, v48
    v_mul_f32 v203, v203, v48
    v_mfma_f32_16x16x32_bf16 v[20:23], a[228:231], a[20:23], v[20:23]
    buffer_load_dwordx4 v0, s[20:23], s38 offen offset:0 lds
    v_mfma_f32_16x16x32_bf16 v[20:23], a[224:227], a[16:19], v[20:23]
    v_exp_f32 v16, v16
    v_mfma_f32_16x16x32_bf16 v[24:27], a[224:227], a[32:35], -4.0
    v_exp_f32 v17, v17
    v_mfma_f32_16x16x32_bf16 v[24:27], a[228:231], a[36:39], v[24:27]
    v_exp_f32 v18, v18
    v_mfma_f32_16x16x32_bf16 v[24:27], a[232:235], a[40:43], v[24:27]
    v_exp_f32 v19, v19
    v_mfma_f32_16x16x32_bf16 v[24:27], a[236:239], a[44:47], v[24:27]
    buffer_load_dwordx4 v0, s[20:23], s38 offen offset:1024 lds
    v_mfma_f32_16x16x32_bf16 v[28:31], a[236:239], a[60:63], -4.0
    ds_read_b128 a[236:239], v63 offset:23552
    v_cvt_pk_bf16_f32 v96, v16, v17
    v_mfma_f32_16x16x32_bf16 v[28:31], a[232:235], a[56:59], v[28:31]
    v_exp_f32 v20, v20
    v_mfma_f32_16x16x32_bf16 v[28:31], a[228:231], a[52:55], v[28:31]
    ds_read_b128 a[228:231], v63 offset:21504
    v_cvt_pk_bf16_f32 v97, v18, v19
    v_mfma_f32_16x16x32_bf16 v[28:31], a[224:227], a[48:51], v[28:31]
    v_exp_f32 v21, v21
    v_smfmac_f32_16x16x64_bf16 v[32:35], v[12:15], v[64:71], v57
    v_cvt_pk_bf16_f32 v104, v20, v21
    v_mfma_f32_16x16x32_bf16 v[128:131], a[128:131], v[64:67], v[128:131]
    buffer_store_dwordx4 v[152:155], v2, s[24:27], s43 offen offset:0 sc1
    v_mfma_f32_16x16x32_bf16 v[128:131], a[132:135], v[68:71], v[128:131]
    ds_read_b128 a[224:227], v62 offset:20480
    v_mul_f32 v216, v216, v48
    v_mfma_f32_16x16x32_bf16 v[132:135], a[132:135], v[76:79], v[132:135]
    v_exp_f32 v22, v22
    v_mfma_f32_16x16x32_bf16 v[132:135], a[128:131], v[72:75], v[132:135]
    ds_read_b128 a[232:235], v62 offset:22528
    v_mul_f32 v217, v217, v48
    v_mfma_f32_16x16x32_bf16 v[136:139], a[128:131], v[80:83], 0
    v_exp_f32 v23, v23
    v_mfma_f32_16x16x32_bf16 v[136:139], a[132:135], v[84:87], v[136:139]
    buffer_load_dwordx4 v0, s[28:31], s38 offen offset:2056 lds
    v_mfma_f32_16x16x32_bf16 v[140:143], a[132:135], v[92:95], v[140:143]
    v_cvt_pk_bf16_f32 v105, v22, v23
    v_mul_f32 v218, v218, v48
    v_mfma_f32_16x16x32_bf16 v[140:143], a[128:131], v[88:91], v[140:143]
    v_exp_f32 v24, v24
    v_mfma_f32_16x16x32_bf16 v[156:159], a[136:139], v[88:91], v[156:159]
    v_exp_f32 v25, v25
    v_mfma_f32_16x16x32_bf16 v[156:159], a[140:143], v[92:95], v[156:159]
    v_exp_f32 v26, v26
    v_mfma_f32_16x16x32_bf16 v[152:155], a[140:143], v[84:87], 0
    buffer_load_dwordx4 v0, s[28:31], s38 offen offset:3080 lds
    v_mfma_f32_16x16x32_bf16 v[152:155], a[136:139], v[80:83], v[152:155]
    v_exp_f32 v27, v27
    v_mfma_f32_16x16x32_bf16 v[148:151], a[136:139], v[72:75], v[148:151]
    v_cvt_pk_bf16_f32 v112, v24, v25
    v_cvt_pk_bf16_f32 v113, v26, v27
    v_mfma_f32_16x16x32_bf16 v[148:151], a[140:143], v[76:79], v[148:151]
    v_exp_f32 v28, v28
    v_mfma_f32_16x16x32_bf16 v[144:147], a[140:143], v[68:71], v[144:147]
    v_exp_f32 v29, v29
    v_mfma_f32_16x16x32_bf16 v[144:147], a[136:139], v[64:67], v[144:147]
    s_waitcnt lgkmcnt(1)
    v_exp_f32 v30, v30
    v_mfma_f32_16x16x32_bf16 v[16:19], a[224:227], a[0:3], -4.0
    v_exp_f32 v31, v31
    v_mfma_f32_16x16x32_bf16 v[16:19], a[228:231], a[4:7], v[16:19]
    s_waitcnt lgkmcnt(0)
    v_cvt_pk_bf16_f32 v120, v28, v29
    v_cvt_pk_bf16_f32 v121, v30, v31
    v_mfma_f32_16x16x32_bf16 v[16:19], a[232:235], a[8:11], v[16:19]
    v_mul_f32 v219, v219, v48
    v_cvt_pk_bf16_f32 v219, v218, v219
    v_mfma_f32_16x16x32_bf16 v[16:19], a[236:239], a[12:15], v[16:19]
    v_cvt_pk_bf16_f32 v218, v216, v217
    v_cvt_pk_bf16_f32 v216, v200, v201
    v_mfma_f32_16x16x32_bf16 v[20:23], a[236:239], a[28:31], -4.0
    v_cvt_pk_bf16_f32 v217, v202, v203
    v_mul_f32 v232, v232, v48
    v_mfma_f32_16x16x32_bf16 v[20:23], a[232:235], a[24:27], v[20:23]
    v_mul_f32 v233, v233, v48
    v_mul_f32 v234, v234, v48
    v_mfma_f32_16x16x32_bf16 v[20:23], a[228:231], a[20:23], v[20:23]
    v_mul_f32 v235, v235, v48
    v_mul_f32 v248, v248, v48
    v_mfma_f32_16x16x32_bf16 v[20:23], a[224:227], a[16:19], v[20:23]
    v_exp_f32 v16, v16
    v_mfma_f32_16x16x32_bf16 v[24:27], a[224:227], a[32:35], -4.0
    v_exp_f32 v17, v17
    v_mfma_f32_16x16x32_bf16 v[24:27], a[228:231], a[36:39], v[24:27]
    v_exp_f32 v18, v18
    v_mfma_f32_16x16x32_bf16 v[24:27], a[232:235], a[40:43], v[24:27]
L_hop7:
    s_cbranch_execz L_hback
    v_exp_f32 v19, v19
    v_mfma_f32_16x16x32_bf16 v[24:27], a[236:239], a[44:47], v[24:27]
    v_cvt_pk_bf16_f32 v98, v16, v17
    v_cvt_pk_bf16_f32 v99, v18, v19
    v_mfma_f32_16x16x32_bf16 v[28:31], a[236:239], a[60:63], -4.0
    v_exp_f32 v20, v20
    v_mfma_f32_16x16x32_bf16 v[28:31], a[232:235], a[56:59], v[28:31]
    s_mov_b32 m0, s76
    ds_read_b128 a[232:235], v62 offset:26624
    v_mul_f32 v249, v249, v48
    v_mfma_f32_16x16x32_bf16 v[28:31], a[228:231], a[52:55], v[28:31]
    v_exp_f32 v21, v21
    v_mfma_f32_16x16x32_bf16 v[28:31], a[224:227], a[48:51], v[28:31]
    ds_read_b128 a[224:227], v62 offset:24576
    v_cvt_pk_bf16_f32 v106, v20, v21
    v_smfmac_f32_16x16x64_bf16 v[36:39], v[12:15], v[72:79], v57
    v_mul_f32 v250, v250, v48
    v_mfma_f32_16x16x32_bf16 v[164:167], a[144:147], v[72:75], v[164:167]
    ds_read_b128 a[228:231], v63 offset:25600
    v_mul_f32 v251, v251, v48
    v_mfma_f32_16x16x32_bf16 v[164:167], a[148:151], v[76:79], v[164:167]
    v_exp_f32 v22, v22
    v_mfma_f32_16x16x32_bf16 v[160:163], a[148:151], v[68:71], v[160:163]
    ds_read_b128 a[236:239], v63 offset:27648
    v_cvt_pk_bf16_f32 v251, v250, v251
    v_mfma_f32_16x16x32_bf16 v[160:163], a[144:147], v[64:67], v[160:163]
    v_exp_f32 v23, v23
    v_mfma_f32_16x16x32_bf16 v[168:171], a[144:147], v[80:83], 0
    v_cvt_pk_bf16_f32 v107, v22, v23
    v_cvt_pk_bf16_f32 v250, v248, v249
    v_mfma_f32_16x16x32_bf16 v[168:171], a[148:151], v[84:87], v[168:171]
    v_exp_f32 v24, v24
    v_mfma_f32_16x16x32_bf16 v[172:175], a[148:151], v[92:95], v[172:175]
    v_exp_f32 v25, v25
    v_mfma_f32_16x16x32_bf16 v[172:175], a[144:147], v[88:91], v[172:175]
    v_exp_f32 v26, v26
    v_mfma_f32_16x16x32_bf16 v[188:191], a[152:155], v[88:91], v[188:191]
    v_exp_f32 v27, v27
    v_mfma_f32_16x16x32_bf16 v[188:191], a[156:159], v[92:95], v[188:191]
    v_cvt_pk_bf16_f32 v114, v24, v25
    v_cvt_pk_bf16_f32 v115, v26, v27
    v_mfma_f32_16x16x32_bf16 v[184:187], a[156:159], v[84:87], 0
    v_exp_f32 v28, v28
    v_mfma_f32_16x16x32_bf16 v[184:187], a[152:155], v[80:83], v[184:187]
    v_exp_f32 v29, v29
    v_mfma_f32_16x16x32_bf16 v[176:179], a[152:155], v[64:67], v[176:179]
    v_exp_f32 v30, v30
    v_mfma_f32_16x16x32_bf16 v[176:179], a[156:159], v[68:71], v[176:179]
    v_exp_f32 v31, v31
    v_mfma_f32_16x16x32_bf16 v[180:183], a[156:159], v[76:79], v[180:183]
    v_cvt_pk_bf16_f32 v122, v28, v29
    v_cvt_pk_bf16_f32 v123, v30, v31
    v_mfma_f32_16x16x32_bf16 v[180:183], a[152:155], v[72:75], v[180:183]
    s_waitcnt lgkmcnt(2)
    v_cvt_pk_bf16_f32 v248, v232, v233
    v_cvt_pk_bf16_f32 v249, v234, v235
    v_mfma_f32_16x16x32_bf16 v[16:19], a[224:227], a[0:3], -4.0
    s_waitcnt lgkmcnt(1)
    v_cndmask_b32_dpp v234, v218, v250, vcc row_ror:8 row_mask:0xf bank_mask:0xf
    v_mov_b32_dpp v218, v250 row_ror:8 row_mask:0xf bank_mask:0xc
    v_mfma_f32_16x16x32_bf16 v[16:19], a[228:231], a[4:7], v[16:19]
    v_cndmask_b32_dpp v232, v216, v248, vcc row_ror:8 row_mask:0xf bank_mask:0xf
    v_mov_b32_dpp v216, v248 row_ror:8 row_mask:0xf bank_mask:0xc
    v_mfma_f32_16x16x32_bf16 v[16:19], a[232:235], a[8:11], v[16:19]
    s_waitcnt lgkmcnt(0)
    v_cndmask_b32_dpp v233, v217, v249, vcc row_ror:8 row_mask:0xf bank_mask:0xf
    v_mov_b32_dpp v217, v249 row_ror:8 row_mask:0xf bank_mask:0xc
    v_mfma_f32_16x16x32_bf16 v[16:19], a[236:239], a[12:15], v[16:19]
    v_cndmask_b32_dpp v235, v219, v251, vcc row_ror:8 row_mask:0xf bank_mask:0xf
    v_mov_b32_dpp v219, v251 row_ror:8 row_mask:0xf bank_mask:0xc
    v_mfma_f32_16x16x32_bf16 v[20:23], a[236:239], a[28:31], -4.0
    buffer_store_dwordx4 v[216:219], v2, s[24:27], s43 offen offset:128 sc1
    v_mfma_f32_16x16x32_bf16 v[20:23], a[232:235], a[24:27], v[20:23]
    v_mfma_f32_16x16x32_bf16 v[20:23], a[228:231], a[20:23], v[20:23]
    v_mfma_f32_16x16x32_bf16 v[20:23], a[224:227], a[16:19], v[20:23]
    s_nop 0
    v_exp_f32 v16, v16
    v_mfma_f32_16x16x32_bf16 v[24:27], a[224:227], a[32:35], -4.0
    v_exp_f32 v17, v17
    v_mfma_f32_16x16x32_bf16 v[24:27], a[228:231], a[36:39], v[24:27]
    v_exp_f32 v18, v18
    v_mfma_f32_16x16x32_bf16 v[24:27], a[232:235], a[40:43], v[24:27]
    v_exp_f32 v19, v19
    v_mfma_f32_16x16x32_bf16 v[24:27], a[236:239], a[44:47], v[24:27]
    v_cvt_pk_bf16_f32 v100, v16, v17
    v_cvt_pk_bf16_f32 v101, v18, v19
    v_mfma_f32_16x16x32_bf16 v[28:31], a[236:239], a[60:63], -4.0
    v_exp_f32 v20, v20
    v_mfma_f32_16x16x32_bf16 v[28:31], a[232:235], a[56:59], v[28:31]
    v_exp_f32 v21, v21
    v_mfma_f32_16x16x32_bf16 v[28:31], a[228:231], a[52:55], v[28:31]
    ds_read_b128 a[228:231], v63 offset:29696
    v_cvt_pk_bf16_f32 v108, v20, v21
    v_mfma_f32_16x16x32_bf16 v[28:31], a[224:227], a[48:51], v[28:31]
    v_exp_f32 v22, v22
    v_smfmac_f32_16x16x64_bf16 v[40:43], v[12:15], v[80:87], v57
    v_mfma_f32_16x16x32_bf16 v[200:203], a[160:163], v[80:83], 0
    v_exp_f32 v23, v23
    v_mfma_f32_16x16x32_bf16 v[200:203], a[164:167], v[84:87], v[200:203]
    ds_read_b128 a[224:227], v62 offset:28672
    v_cvt_pk_bf16_f32 v109, v22, v23
    v_mfma_f32_16x16x32_bf16 v[192:195], a[164:167], v[68:71], v[192:195]
    v_exp_f32 v24, v24
    v_mfma_f32_16x16x32_bf16 v[192:195], a[160:163], v[64:67], v[192:195]
    buffer_store_dwordx4 v[232:235], v2, s[24:27], s43 offen offset:2176 sc1
    v_mfma_f32_16x16x32_bf16 v[196:199], a[160:163], v[72:75], v[196:199]
    v_exp_f32 v25, v25
    v_mfma_f32_16x16x32_bf16 v[196:199], a[164:167], v[76:79], v[196:199]
    s_add_u32 s43, s43, 4096
    ds_read_b128 a[232:235], v62 offset:30720
    v_cvt_pk_bf16_f32 v116, v24, v25
    v_mfma_f32_16x16x32_bf16 v[204:207], a[164:167], v[92:95], v[204:207]
    v_exp_f32 v26, v26
    v_mfma_f32_16x16x32_bf16 v[204:207], a[160:163], v[88:91], v[204:207]
    v_exp_f32 v27, v27
    v_mfma_f32_16x16x32_bf16 v[220:223], a[168:171], v[88:91], v[220:223]
    ds_read_b128 a[236:239], v63 offset:31744
    v_cvt_pk_bf16_f32 v117, v26, v27
    v_mfma_f32_16x16x32_bf16 v[220:223], a[172:175], v[92:95], v[220:223]
    v_exp_f32 v28, v28
    v_mfma_f32_16x16x32_bf16 v[212:215], a[172:175], v[76:79], v[212:215]
    v_exp_f32 v29, v29
    v_mfma_f32_16x16x32_bf16 v[212:215], a[168:171], v[72:75], v[212:215]
    v_exp_f32 v30, v30
    v_mfma_f32_16x16x32_bf16 v[208:211], a[168:171], v[64:67], v[208:211]
    v_exp_f32 v31, v31
    v_mfma_f32_16x16x32_bf16 v[208:211], a[172:175], v[68:71], v[208:211]
    v_cvt_pk_bf16_f32 v124, v28, v29
    v_cvt_pk_bf16_f32 v125, v30, v31
    v_mfma_f32_16x16x32_bf16 v[216:219], a[172:175], v[84:87], 0
    v_mfma_f32_16x16x32_bf16 v[216:219], a[168:171], v[80:83], v[216:219]
    s_waitcnt lgkmcnt(2)
    v_mfma_f32_16x16x32_bf16 v[16:19], a[224:227], a[48:51], -4.0
    s_waitcnt vmcnt(10)
    ds_read_b128 a[48:51], v3 offset:0
    v_mfma_f32_16x16x32_bf16 v[16:19], a[228:231], a[52:55], v[16:19]
    s_waitcnt lgkmcnt(2)
    v_mfma_f32_16x16x32_bf16 v[16:19], a[232:235], a[56:59], v[16:19]
    s_waitcnt lgkmcnt(1)
    ds_read_b128 a[52:55], v3 offset:64
    v_mfma_f32_16x16x32_bf16 v[16:19], a[236:239], a[60:63], v[16:19]
    v_mfma_f32_16x16x32_bf16 v[20:23], a[236:239], a[12:15], -4.0
    ds_read_b128 a[56:59], v3 offset:128
    v_mfma_f32_16x16x32_bf16 v[20:23], a[232:235], a[8:11], v[20:23]
    v_mfma_f32_16x16x32_bf16 v[20:23], a[228:231], a[4:7], v[20:23]
    s_nop 0
    ds_read_b128 a[60:63], v3 offset:192
    v_mfma_f32_16x16x32_bf16 v[20:23], a[224:227], a[0:3], v[20:23]
    s_nop 0
    v_exp_f32 v16, v16
    v_mfma_f32_16x16x32_bf16 v[24:27], a[224:227], a[16:19], -4.0
    v_exp_f32 v17, v17
    v_mfma_f32_16x16x32_bf16 v[24:27], a[228:231], a[20:23], v[24:27]
    v_exp_f32 v18, v18
    v_mfma_f32_16x16x32_bf16 v[24:27], a[232:235], a[24:27], v[24:27]
    v_exp_f32 v19, v19
    v_mfma_f32_16x16x32_bf16 v[24:27], a[236:239], a[28:31], v[24:27]
    v_cvt_pk_bf16_f32 v126, v16, v17
    v_cvt_pk_bf16_f32 v127, v18, v19
    v_mfma_f32_16x16x32_bf16 v[28:31], a[236:239], a[44:47], -4.0
    v_exp_f32 v20, v20
    v_mfma_f32_16x16x32_bf16 v[28:31], a[232:235], a[40:43], v[28:31]
    s_waitcnt lgkmcnt(0)
    buffer_load_dwordx4 v0, s[12:15], s42 offen offset:0 nt lds
    v_mfma_f32_16x16x32_bf16 v[28:31], a[228:231], a[36:39], v[28:31]
    v_exp_f32 v21, v21
    v_mfma_f32_16x16x32_bf16 v[28:31], a[224:227], a[32:35], v[28:31]
    s_mov_b32 m0, s77
    ds_read_b128 a[224:227], v62 offset:32768
    v_cvt_pk_bf16_f32 v102, v20, v21
    v_smfmac_f32_16x16x64_bf16 v[44:47], v[12:15], v[88:95], v57
    v_mfma_f32_16x16x32_bf16 v[236:239], a[176:179], v[88:91], v[236:239]
    v_exp_f32 v22, v22
    v_mfma_f32_16x16x32_bf16 v[236:239], a[180:183], v[92:95], v[236:239]
    buffer_load_dwordx4 v0, s[12:15], s42 offen offset:1024 nt lds
    v_mfma_f32_16x16x32_bf16 v[224:227], a[180:183], v[68:71], v[224:227]
    v_exp_f32 v23, v23
    v_mfma_f32_16x16x32_bf16 v[224:227], a[176:179], v[64:67], v[224:227]
    s_mov_b32 m0, s78
    ds_read_b128 a[228:231], v63 offset:33792
    v_cvt_pk_bf16_f32 v103, v22, v23
    v_mfma_f32_16x16x32_bf16 v[228:231], a[176:179], v[72:75], v[228:231]
    v_exp_f32 v24, v24
    v_mfma_f32_16x16x32_bf16 v[228:231], a[180:183], v[76:79], v[228:231]
    v_exp_f32 v25, v25
    v_mfma_f32_16x16x32_bf16 v[232:235], a[180:183], v[84:87], 0
    s_waitcnt vmcnt(10)
    buffer_load_dwordx4 v0, s[12:15], s42 offen offset:2048 nt lds
    v_mfma_f32_16x16x32_bf16 v[232:235], a[176:179], v[80:83], v[232:235]
    s_barrier
    ds_read_b128 a[232:235], v62 offset:34816
    v_cvt_pk_bf16_f32 v110, v24, v25
    v_mfma_f32_16x16x32_bf16 v[248:251], a[184:187], v[80:83], 0
    v_exp_f32 v26, v26
    v_mfma_f32_16x16x32_bf16 v[248:251], a[188:191], v[84:87], v[248:251]
    v_exp_f32 v27, v27
    v_mfma_f32_16x16x32_bf16 v[244:247], a[188:191], v[76:79], v[244:247]
    s_mov_b32 m0, s79
    ds_read_b128 a[236:239], v63 offset:35840
    v_cvt_pk_bf16_f32 v111, v26, v27
    v_mfma_f32_16x16x32_bf16 v[244:247], a[184:187], v[72:75], v[244:247]
    v_exp_f32 v28, v28
    v_mfma_f32_16x16x32_bf16 v[240:243], a[184:187], v[64:67], v[240:243]
    buffer_load_dwordx4 v0, s[12:15], s42 offen offset:3072 nt lds
    v_mfma_f32_16x16x32_bf16 v[240:243], a[188:191], v[68:71], v[240:243]
    v_exp_f32 v29, v29
    v_mfma_f32_16x16x32_bf16 v[252:255], a[188:191], v[92:95], v[252:255]
    v_exp_f32 v30, v30
    v_mfma_f32_16x16x32_bf16 v[252:255], a[184:187], v[88:91], v[252:255]
    s_waitcnt lgkmcnt(3)
    v_exp_f32 v31, v31
    v_mfma_f32_16x16x32_bf16 v[16:19], a[224:227], a[0:3], -4.0
    s_waitcnt lgkmcnt(2)
    v_cvt_pk_bf16_f32 v118, v28, v29
    v_cvt_pk_bf16_f32 v119, v30, v31
    v_mfma_f32_16x16x32_bf16 v[16:19], a[228:231], a[4:7], v[16:19]
    s_waitcnt lgkmcnt(1)
    ds_read_b64_tr_b16 a[244:245], v1 offset:34192
    ds_read_b64_tr_b16 a[246:247], v1 offset:34704
    v_mfma_f32_16x16x32_bf16 v[16:19], a[232:235], a[8:11], v[16:19]
    s_waitcnt lgkmcnt(2)
    v_mfma_f32_16x16x32_bf16 v[16:19], a[236:239], a[12:15], v[16:19]
    s_add_u32 s42, s42, 4096
    ds_read_b64_tr_b16 a[252:253], v1 offset:34200
    ds_read_b64_tr_b16 a[254:255], v1 offset:34712
    v_mfma_f32_16x16x32_bf16 v[20:23], a[236:239], a[28:31], -4.0
    v_mfma_f32_16x16x32_bf16 v[20:23], a[232:235], a[24:27], v[20:23]
    v_mfma_f32_16x16x32_bf16 v[20:23], a[228:231], a[20:23], v[20:23]
    v_mfma_f32_16x16x32_bf16 v[20:23], a[224:227], a[16:19], v[20:23]
    s_nop 0
    v_exp_f32 v16, v16
    v_mfma_f32_16x16x32_bf16 v[24:27], a[224:227], a[32:35], -4.0
    v_exp_f32 v17, v17
    v_mfma_f32_16x16x32_bf16 v[24:27], a[228:231], a[36:39], v[24:27]
    v_exp_f32 v18, v18
    v_mfma_f32_16x16x32_bf16 v[24:27], a[232:235], a[40:43], v[24:27]
    v_exp_f32 v19, v19
    v_mfma_f32_16x16x32_bf16 v[24:27], a[236:239], a[44:47], v[24:27]
    v_cvt_pk_bf16_f32 v64, v16, v17
    v_cvt_pk_bf16_f32 v65, v18, v19
    v_mfma_f32_16x16x32_bf16 v[28:31], a[236:239], a[60:63], -4.0
    v_exp_f32 v20, v20
    v_mfma_f32_16x16x32_bf16 v[28:31], a[232:235], a[56:59], v[28:31]
    v_exp_f32 v21, v21
    v_mfma_f32_16x16x32_bf16 v[28:31], a[228:231], a[52:55], v[28:31]
    s_mov_b32 m0, s98
    ds_read_b128 a[228:231], v63 offset:37888
    v_cvt_pk_bf16_f32 v72, v20, v21
    v_mfma_f32_16x16x32_bf16 v[28:31], a[224:227], a[48:51], v[28:31]
    v_exp_f32 v22, v22
    v_smfmac_f32_16x16x64_bf16 v[44:47], v[12:15], v[120:127], v57
    v_mfma_f32_16x16x32_bf16 v[140:143], a[192:195], v[120:123], v[140:143]
    s_waitcnt lgkmcnt(3)
    v_exp_f32 v23, v23
    v_mfma_f32_16x16x32_bf16 v[140:143], a[244:247], v[124:127], v[140:143]
    ds_read_b128 a[224:227], v62 offset:36864
    v_cvt_pk_bf16_f32 v73, v22, v23
    v_mfma_f32_16x16x32_bf16 v[128:131], a[244:247], v[100:103], v[128:131]
    v_exp_f32 v24, v24
    v_mfma_f32_16x16x32_bf16 v[128:131], a[192:195], v[96:99], v[128:131]
    v_exp_f32 v25, v25
    v_mfma_f32_16x16x32_bf16 v[132:135], a[192:195], v[104:107], v[132:135]
    ds_read_b128 a[232:235], v62 offset:38912
    v_cvt_pk_bf16_f32 v80, v24, v25
    v_mfma_f32_16x16x32_bf16 v[132:135], a[244:247], v[108:111], v[132:135]
    v_exp_f32 v26, v26
    v_mfma_f32_16x16x32_bf16 v[136:139], a[244:247], v[116:119], v[136:139]
    ds_read_b128 a[236:239], v63 offset:39936
    v_add_f32 v44, v44, v45
    v_mfma_f32_16x16x32_bf16 v[136:139], a[192:195], v[112:115], v[136:139]
    v_exp_f32 v27, v27
    v_mfma_f32_16x16x32_bf16 v[152:155], a[196:199], v[112:115], v[152:155]
    s_waitcnt lgkmcnt(4)
    ds_read_b64_tr_b16 a[244:245], v1 offset:34256
    v_cvt_pk_bf16_f32 v81, v26, v27
    v_mfma_f32_16x16x32_bf16 v[152:155], a[252:255], v[116:119], v[152:155]
    v_exp_f32 v28, v28
    v_mfma_f32_16x16x32_bf16 v[148:151], a[252:255], v[108:111], v[148:151]
    v_exp_f32 v29, v29
    v_mfma_f32_16x16x32_bf16 v[148:151], a[196:199], v[104:107], v[148:151]
    v_exp_f32 v30, v30
    v_mfma_f32_16x16x32_bf16 v[144:147], a[196:199], v[96:99], v[144:147]
    v_exp_f32 v31, v31
    v_mfma_f32_16x16x32_bf16 v[144:147], a[252:255], v[100:103], v[144:147]
    v_cvt_pk_bf16_f32 v88, v28, v29
    v_cvt_pk_bf16_f32 v89, v30, v31
    v_mfma_f32_16x16x32_bf16 v[156:159], a[252:255], v[124:127], v[156:159]
    v_rcp_f32 v50, v44
    v_mfma_f32_16x16x32_bf16 v[156:159], a[196:199], v[120:123], v[156:159]
    s_waitcnt lgkmcnt(3)
    ds_read_b64_tr_b16 a[246:247], v1 offset:34768
    ds_read_b64_tr_b16 a[252:253], v1 offset:34264
    v_mfma_f32_16x16x32_bf16 v[16:19], a[224:227], a[0:3], -4.0
    v_mul_f32 v140, v140, v50
    v_mul_f32 v141, v141, v50
    v_mfma_f32_16x16x32_bf16 v[16:19], a[228:231], a[4:7], v[16:19]
    s_waitcnt lgkmcnt(4)
    ds_read_b64_tr_b16 a[254:255], v1 offset:34776
    v_mul_f32 v142, v142, v50
    v_mfma_f32_16x16x32_bf16 v[16:19], a[232:235], a[8:11], v[16:19]
    s_waitcnt lgkmcnt(4)
    v_mul_f32 v143, v143, v50
    v_max3_u32 v58, v58, v44, v50
    v_mfma_f32_16x16x32_bf16 v[16:19], a[236:239], a[12:15], v[16:19]
    v_mul_f32 v156, v156, v50
    v_mul_f32 v157, v157, v50
    v_mfma_f32_16x16x32_bf16 v[20:23], a[236:239], a[28:31], -4.0
    v_mul_f32 v158, v158, v50
    v_mul_f32 v159, v159, v50
    v_mfma_f32_16x16x32_bf16 v[20:23], a[232:235], a[24:27], v[20:23]
    v_cvt_pk_bf16_f32 v159, v158, v159
    v_cvt_pk_bf16_f32 v158, v156, v157
    v_mfma_f32_16x16x32_bf16 v[20:23], a[228:231], a[20:23], v[20:23]
    v_cvt_pk_bf16_f32 v156, v140, v141
    v_cvt_pk_bf16_f32 v157, v142, v143
    v_mfma_f32_16x16x32_bf16 v[20:23], a[224:227], a[16:19], v[20:23]
    v_exp_f32 v16, v16
    v_mfma_f32_16x16x32_bf16 v[24:27], a[224:227], a[32:35], -4.0
    v_exp_f32 v17, v17
    v_mfma_f32_16x16x32_bf16 v[24:27], a[228:231], a[36:39], v[24:27]
    v_exp_f32 v18, v18
    v_mfma_f32_16x16x32_bf16 v[24:27], a[232:235], a[40:43], v[24:27]
    v_exp_f32 v19, v19
    v_mfma_f32_16x16x32_bf16 v[24:27], a[236:239], a[44:47], v[24:27]
    v_cvt_pk_bf16_f32 v66, v16, v17
    v_cvt_pk_bf16_f32 v67, v18, v19
    v_mfma_f32_16x16x32_bf16 v[28:31], a[236:239], a[60:63], -4.0
    v_exp_f32 v20, v20
    v_mfma_f32_16x16x32_bf16 v[28:31], a[232:235], a[56:59], v[28:31]
    ds_read_b128 a[232:235], v62 offset:43008
    v_mov_b32 v44, 0
    v_mfma_f32_16x16x32_bf16 v[28:31], a[228:231], a[52:55], v[28:31]
    v_exp_f32 v21, v21
    v_mfma_f32_16x16x32_bf16 v[28:31], a[224:227], a[48:51], v[28:31]
    ds_read_b128 a[224:227], v62 offset:40960
    v_cvt_pk_bf16_f32 v74, v20, v21
    v_smfmac_f32_16x16x64_bf16 v[32:35], v[12:15], v[96:103], v57
    v_mov_b32 v45, 0
    v_mfma_f32_16x16x32_bf16 v[160:163], a[200:203], v[96:99], v[160:163]
    s_waitcnt lgkmcnt(4)
    v_exp_f32 v22, v22
    v_mfma_f32_16x16x32_bf16 v[160:163], a[244:247], v[100:103], v[160:163]
    v_exp_f32 v23, v23
    v_mfma_f32_16x16x32_bf16 v[172:175], a[244:247], v[124:127], v[172:175]
    ds_read_b128 a[228:231], v63 offset:41984
    v_cvt_pk_bf16_f32 v75, v22, v23
    v_mfma_f32_16x16x32_bf16 v[172:175], a[200:203], v[120:123], v[172:175]
    v_exp_f32 v24, v24
    v_mfma_f32_16x16x32_bf16 v[164:167], a[200:203], v[104:107], v[164:167]
    v_exp_f32 v25, v25
    v_mfma_f32_16x16x32_bf16 v[164:167], a[244:247], v[108:111], v[164:167]
    ds_read_b128 a[236:239], v63 offset:44032
    v_cvt_pk_bf16_f32 v82, v24, v25
    v_mfma_f32_16x16x32_bf16 v[168:171], a[244:247], v[116:119], v[168:171]
    v_exp_f32 v26, v26
    v_mfma_f32_16x16x32_bf16 v[168:171], a[200:203], v[112:115], v[168:171]
    v_exp_f32 v27, v27
    v_mfma_f32_16x16x32_bf16 v[184:187], a[204:207], v[112:115], v[184:187]
    s_waitcnt lgkmcnt(4)
    ds_read_b64_tr_b16 a[244:245], v1 offset:34320
    v_cvt_pk_bf16_f32 v83, v26, v27
    v_mfma_f32_16x16x32_bf16 v[184:187], a[252:255], v[116:119], v[184:187]
    v_exp_f32 v28, v28
    v_mfma_f32_16x16x32_bf16 v[180:183], a[252:255], v[108:111], v[180:183]
    v_exp_f32 v29, v29
    v_mfma_f32_16x16x32_bf16 v[180:183], a[204:207], v[104:107], v[180:183]
    v_exp_f32 v30, v30
    v_mfma_f32_16x16x32_bf16 v[188:191], a[204:207], v[120:123], v[188:191]
    v_exp_f32 v31, v31
    v_mfma_f32_16x16x32_bf16 v[188:191], a[252:255], v[124:127], v[188:191]
    v_cvt_pk_bf16_f32 v90, v28, v29
    v_cvt_pk_bf16_f32 v91, v30, v31
    v_mfma_f32_16x16x32_bf16 v[176:179], a[252:255], v[100:103], v[176:179]
    ds_read_b64_tr_b16 a[246:247], v1 offset:34832
    ds_read_b64_tr_b16 a[252:253], v1 offset:34328
    v_mfma_f32_16x16x32_bf16 v[176:179], a[204:207], v[96:99], v[176:179]
    s_waitcnt lgkmcnt(5)
    v_mul_f32 v172, v172, v50
    v_mul_f32 v173, v173, v50
    v_mfma_f32_16x16x32_bf16 v[16:19], a[224:227], a[0:3], -4.0
    s_waitcnt lgkmcnt(4)
    ds_read_b64_tr_b16 a[254:255], v1 offset:34840
    v_mul_f32 v174, v174, v50
    v_mfma_f32_16x16x32_bf16 v[16:19], a[228:231], a[4:7], v[16:19]
    v_mul_f32 v175, v175, v50
    v_mul_f32 v188, v188, v50
    v_mfma_f32_16x16x32_bf16 v[16:19], a[232:235], a[8:11], v[16:19]
    s_waitcnt lgkmcnt(4)
    v_mul_f32 v189, v189, v50
    v_mul_f32 v190, v190, v50
    v_mfma_f32_16x16x32_bf16 v[16:19], a[236:239], a[12:15], v[16:19]
    v_mul_f32 v191, v191, v50
    v_cvt_pk_bf16_f32 v191, v190, v191
    v_mfma_f32_16x16x32_bf16 v[20:23], a[236:239], a[28:31], -4.0
    v_cvt_pk_bf16_f32 v190, v188, v189
    v_cvt_pk_bf16_f32 v188, v172, v173
    v_mfma_f32_16x16x32_bf16 v[20:23], a[232:235], a[24:27], v[20:23]
    v_cvt_pk_bf16_f32 v189, v174, v175
    v_cndmask_b32_dpp v175, v159, v191, vcc row_ror:8 row_mask:0xf bank_mask:0xf
    v_mfma_f32_16x16x32_bf16 v[20:23], a[228:231], a[20:23], v[20:23]
    v_cndmask_b32_dpp v172, v156, v188, vcc row_ror:8 row_mask:0xf bank_mask:0xf
    v_mov_b32_dpp v156, v188 row_ror:8 row_mask:0xf bank_mask:0xc
    v_mfma_f32_16x16x32_bf16 v[20:23], a[224:227], a[16:19], v[20:23]
    v_exp_f32 v16, v16
    v_mfma_f32_16x16x32_bf16 v[24:27], a[224:227], a[32:35], -4.0
    v_exp_f32 v17, v17
    v_mfma_f32_16x16x32_bf16 v[24:27], a[228:231], a[36:39], v[24:27]
    v_exp_f32 v18, v18
    v_mfma_f32_16x16x32_bf16 v[24:27], a[232:235], a[40:43], v[24:27]
    v_exp_f32 v19, v19
    v_mfma_f32_16x16x32_bf16 v[24:27], a[236:239], a[44:47], v[24:27]
    v_cvt_pk_bf16_f32 v68, v16, v17
    v_cvt_pk_bf16_f32 v69, v18, v19
    v_mfma_f32_16x16x32_bf16 v[28:31], a[236:239], a[60:63], -4.0
    v_exp_f32 v20, v20
    v_mfma_f32_16x16x32_bf16 v[28:31], a[232:235], a[56:59], v[28:31]
    ds_read_b128 a[232:235], v62 offset:47104
    v_cndmask_b32_dpp v173, v157, v189, vcc row_ror:8 row_mask:0xf bank_mask:0xf
    v_mfma_f32_16x16x32_bf16 v[28:31], a[228:231], a[52:55], v[28:31]
    v_exp_f32 v21, v21
    v_mfma_f32_16x16x32_bf16 v[28:31], a[224:227], a[48:51], v[28:31]
    ds_read_b128 a[224:227], v62 offset:45056
    v_cvt_pk_bf16_f32 v76, v20, v21
    v_smfmac_f32_16x16x64_bf16 v[36:39], v[12:15], v[104:111], v57
    v_mov_b32_dpp v157, v189 row_ror:8 row_mask:0xf bank_mask:0xc
    v_mfma_f32_16x16x32_bf16 v[196:199], a[208:211], v[104:107], v[196:199]
    s_waitcnt lgkmcnt(4)
    v_exp_f32 v22, v22
    v_mfma_f32_16x16x32_bf16 v[196:199], a[244:247], v[108:111], v[196:199]
    ds_read_b128 a[228:231], v63 offset:46080
    v_cndmask_b32_dpp v174, v158, v190, vcc row_ror:8 row_mask:0xf bank_mask:0xf
    v_mfma_f32_16x16x32_bf16 v[204:207], a[244:247], v[124:127], v[204:207]
    v_exp_f32 v23, v23
    v_mfma_f32_16x16x32_bf16 v[204:207], a[208:211], v[120:123], v[204:207]
    buffer_store_dwordx4 v[172:175], v2, s[24:27], s43 offen offset:2048 sc1
    v_mfma_f32_16x16x32_bf16 v[192:195], a[208:211], v[96:99], v[192:195]
    ds_read_b128 a[236:239], v63 offset:48128
    v_cvt_pk_bf16_f32 v77, v22, v23
    v_mfma_f32_16x16x32_bf16 v[192:195], a[244:247], v[100:103], v[192:195]
    v_exp_f32 v24, v24
    v_mfma_f32_16x16x32_bf16 v[200:203], a[244:247], v[116:119], v[200:203]
    v_exp_f32 v25, v25
    v_mfma_f32_16x16x32_bf16 v[200:203], a[208:211], v[112:115], v[200:203]
    v_exp_f32 v26, v26
    v_mfma_f32_16x16x32_bf16 v[216:219], a[212:215], v[112:115], v[216:219]
    s_waitcnt lgkmcnt(4)
    v_exp_f32 v27, v27
    v_mfma_f32_16x16x32_bf16 v[216:219], a[252:255], v[116:119], v[216:219]
    v_cvt_pk_bf16_f32 v84, v24, v25
    v_cvt_pk_bf16_f32 v85, v26, v27
    v_mfma_f32_16x16x32_bf16 v[208:211], a[252:255], v[100:103], v[208:211]
    v_exp_f32 v28, v28
    v_mfma_f32_16x16x32_bf16 v[208:211], a[212:215], v[96:99], v[208:211]
    v_exp_f32 v29, v29
    v_mfma_f32_16x16x32_bf16 v[220:223], a[212:215], v[120:123], v[220:223]
    v_exp_f32 v30, v30
    v_mfma_f32_16x16x32_bf16 v[220:223], a[252:255], v[124:127], v[220:223]
    v_exp_f32 v31, v31
    v_mfma_f32_16x16x32_bf16 v[212:215], a[252:255], v[108:111], v[212:215]
    v_cvt_pk_bf16_f32 v92, v28, v29
    v_cvt_pk_bf16_f32 v93, v30, v31
    v_mfma_f32_16x16x32_bf16 v[212:215], a[212:215], v[104:107], v[212:215]
    s_waitcnt lgkmcnt(2)
    ds_read_b64_tr_b16 a[244:245], v1 offset:34384
    ds_read_b64_tr_b16 a[246:247], v1 offset:34896
    v_mfma_f32_16x16x32_bf16 v[16:19], a[224:227], a[0:3], -4.0
    s_waitcnt lgkmcnt(3)
    v_mov_b32_dpp v158, v190 row_ror:8 row_mask:0xf bank_mask:0xc
    v_mov_b32_dpp v159, v191 row_ror:8 row_mask:0xf bank_mask:0xc
    v_mfma_f32_16x16x32_bf16 v[16:19], a[228:231], a[4:7], v[16:19]
    ds_read_b64_tr_b16 a[252:253], v1 offset:34392
    ds_read_b64_tr_b16 a[254:255], v1 offset:34904
    v_mfma_f32_16x16x32_bf16 v[16:19], a[232:235], a[8:11], v[16:19]
    s_waitcnt lgkmcnt(4)
    v_mul_f32 v204, v204, v50
    v_mul_f32 v205, v205, v50
    v_mfma_f32_16x16x32_bf16 v[16:19], a[236:239], a[12:15], v[16:19]
    buffer_store_dwordx4 v[156:159], v2, s[24:27], s43 offen offset:0 sc1
    v_mfma_f32_16x16x32_bf16 v[20:23], a[236:239], a[28:31], -4.0
    v_mul_f32 v206, v206, v50
    v_mul_f32 v207, v207, v50
    v_mfma_f32_16x16x32_bf16 v[20:23], a[232:235], a[24:27], v[20:23]
    v_mul_f32 v220, v220, v50
    v_mul_f32 v221, v221, v50
    v_mfma_f32_16x16x32_bf16 v[20:23], a[228:231], a[20:23], v[20:23]
    v_mul_f32 v222, v222, v50
    v_mul_f32 v223, v223, v50
    v_mfma_f32_16x16x32_bf16 v[20:23], a[224:227], a[16:19], v[20:23]
    v_exp_f32 v16, v16
    v_mfma_f32_16x16x32_bf16 v[24:27], a[224:227], a[32:35], -4.0
    v_exp_f32 v17, v17
    v_mfma_f32_16x16x32_bf16 v[24:27], a[228:231], a[36:39], v[24:27]
    v_exp_f32 v18, v18
    v_mfma_f32_16x16x32_bf16 v[24:27], a[232:235], a[40:43], v[24:27]
    v_exp_f32 v19, v19
    v_mfma_f32_16x16x32_bf16 v[24:27], a[236:239], a[44:47], v[24:27]
    v_cvt_pk_bf16_f32 v70, v16, v17
    v_cvt_pk_bf16_f32 v71, v18, v19
    v_mfma_f32_16x16x32_bf16 v[28:31], a[236:239], a[60:63], -4.0
    v_exp_f32 v20, v20
    v_mfma_f32_16x16x32_bf16 v[28:31], a[232:235], a[56:59], v[28:31]
    ds_read_b128 a[232:235], v62 offset:51200
    v_cvt_pk_bf16_f32 v223, v222, v223
    v_mfma_f32_16x16x32_bf16 v[28:31], a[228:231], a[52:55], v[28:31]
    v_exp_f32 v21, v21
    v_mfma_f32_16x16x32_bf16 v[28:31], a[224:227], a[48:51], v[28:31]
    ds_read_b128 a[224:227], v62 offset:49152
    v_cvt_pk_bf16_f32 v78, v20, v21
    v_smfmac_f32_16x16x64_bf16 v[40:43], v[12:15], v[112:119], v57
    v_cvt_pk_bf16_f32 v222, v220, v221
    v_mfma_f32_16x16x32_bf16 v[232:235], a[216:219], v[112:115], v[232:235]
    s_waitcnt lgkmcnt(4)
    v_exp_f32 v22, v22
    v_mfma_f32_16x16x32_bf16 v[232:235], a[244:247], v[116:119], v[232:235]
    ds_read_b128 a[228:231], v63 offset:50176
    v_cvt_pk_bf16_f32 v220, v204, v205
    v_mfma_f32_16x16x32_bf16 v[236:239], a[244:247], v[124:127], v[236:239]
    v_exp_f32 v23, v23
    v_mfma_f32_16x16x32_bf16 v[236:239], a[216:219], v[120:123], v[236:239]
    ds_read_b128 a[236:239], v63 offset:52224
    v_cvt_pk_bf16_f32 v79, v22, v23
    v_mfma_f32_16x16x32_bf16 v[224:227], a[216:219], v[96:99], v[224:227]
    v_exp_f32 v24, v24
    v_mfma_f32_16x16x32_bf16 v[224:227], a[244:247], v[100:103], v[224:227]
    v_exp_f32 v25, v25
    v_mfma_f32_16x16x32_bf16 v[228:231], a[244:247], v[108:111], v[228:231]
    s_waitcnt vmcnt(8) lgkmcnt(4)
    v_exp_f32 v26, v26
    v_mfma_f32_16x16x32_bf16 v[228:231], a[216:219], v[104:107], v[228:231]
    s_barrier
    buffer_load_dwordx4 v0, s[20:23], s39 offen offset:0 lds
    v_mfma_f32_16x16x32_bf16 v[244:247], a[220:223], v[104:107], v[244:247]
    v_exp_f32 v27, v27
    v_mfma_f32_16x16x32_bf16 v[244:247], a[252:255], v[108:111], v[244:247]
    v_cvt_pk_bf16_f32 v86, v24, v25
    v_cvt_pk_bf16_f32 v87, v26, v27
    v_mfma_f32_16x16x32_bf16 v[240:243], a[252:255], v[100:103], v[240:243]
    v_exp_f32 v28, v28
    v_mfma_f32_16x16x32_bf16 v[240:243], a[220:223], v[96:99], v[240:243]
    v_exp_f32 v29, v29
    v_mfma_f32_16x16x32_bf16 v[252:255], a[220:223], v[120:123], v[252:255]
    buffer_load_dwordx4 v0, s[20:23], s39 offen offset:1024 lds
    v_mfma_f32_16x16x32_bf16 v[252:255], a[252:255], v[124:127], v[252:255]
    v_exp_f32 v30, v30
    v_mfma_f32_16x16x32_bf16 v[248:251], a[252:255], v[116:119], v[248:251]
    v_exp_f32 v31, v31
    v_mfma_f32_16x16x32_bf16 v[248:251], a[220:223], v[112:115], v[248:251]
    s_waitcnt lgkmcnt(2)
    ds_read_b64_tr_b16 a[240:241], v1 offset:49752
    ds_read_b64_tr_b16 a[242:243], v1 offset:50264
    v_mfma_f32_16x16x32_bf16 v[16:19], a[224:227], a[0:3], -4.0
    s_waitcnt lgkmcnt(3)
    v_cvt_pk_bf16_f32 v94, v28, v29
    v_cvt_pk_bf16_f32 v95, v30, v31
    v_mfma_f32_16x16x32_bf16 v[16:19], a[228:231], a[4:7], v[16:19]
    buffer_load_dwordx4 v0, s[28:31], s39 offen offset:2056 lds
    v_mfma_f32_16x16x32_bf16 v[16:19], a[232:235], a[8:11], v[16:19]
    s_waitcnt lgkmcnt(2)
    ds_read_b64_tr_b16 a[244:245], v1 offset:50776
    ds_read_b64_tr_b16 a[246:247], v1 offset:51288
    v_mfma_f32_16x16x32_bf16 v[16:19], a[236:239], a[12:15], v[16:19]
    v_cvt_pk_bf16_f32 v221, v206, v207
    v_mul_f32 v236, v236, v50
    v_mfma_f32_16x16x32_bf16 v[20:23], a[236:239], a[28:31], -4.0
    ds_read_b64_tr_b16 a[248:249], v1 offset:49760
    ds_read_b64_tr_b16 a[250:251], v1 offset:50272
    v_mfma_f32_16x16x32_bf16 v[20:23], a[232:235], a[24:27], v[20:23]
    v_mul_f32 v237, v237, v50
    v_mul_f32 v238, v238, v50
    v_mfma_f32_16x16x32_bf16 v[20:23], a[228:231], a[20:23], v[20:23]
    buffer_load_dwordx4 v0, s[28:31], s39 offen offset:3080 lds
    v_mfma_f32_16x16x32_bf16 v[20:23], a[224:227], a[16:19], v[20:23]
    v_exp_f32 v16, v16
    v_mfma_f32_16x16x32_bf16 v[24:27], a[224:227], a[32:35], -4.0
    v_exp_f32 v17, v17
    v_mfma_f32_16x16x32_bf16 v[24:27], a[228:231], a[36:39], v[24:27]
    s_mov_b32 m0, s99
    ds_read_b64_tr_b16 a[252:253], v1 offset:50784
    ds_read_b64_tr_b16 a[254:255], v1 offset:51296
    v_mfma_f32_16x16x32_bf16 v[24:27], a[232:235], a[40:43], v[24:27]
    v_exp_f32 v18, v18
    v_mfma_f32_16x16x32_bf16 v[24:27], a[236:239], a[44:47], v[24:27]
    v_exp_f32 v19, v19
    v_mfma_f32_16x16x32_bf16 v[28:31], a[236:239], a[60:63], -4.0
    ds_read_b128 a[236:239], v63 offset:56320
    v_cvt_pk_bf16_f32 v96, v16, v17
    v_mfma_f32_16x16x32_bf16 v[28:31], a[232:235], a[56:59], v[28:31]
    v_exp_f32 v20, v20
    v_mfma_f32_16x16x32_bf16 v[28:31], a[228:231], a[52:55], v[28:31]
    ds_read_b128 a[228:231], v63 offset:54272
    v_cvt_pk_bf16_f32 v97, v18, v19
    v_mfma_f32_16x16x32_bf16 v[28:31], a[224:227], a[48:51], v[28:31]
    v_exp_f32 v21, v21
    v_smfmac_f32_16x16x64_bf16 v[32:35], v[12:15], v[64:71], v57
    s_waitcnt lgkmcnt(8)
    v_cvt_pk_bf16_f32 v104, v20, v21
    v_mfma_f32_16x16x32_bf16 v[128:131], a[240:243], v[64:67], v[128:131]
    s_waitcnt lgkmcnt(6)
    ds_read_b128 a[224:227], v62 offset:53248
    v_mul_f32 v239, v239, v50
    v_mfma_f32_16x16x32_bf16 v[128:131], a[244:247], v[68:71], v[128:131]
    v_exp_f32 v22, v22
    v_mfma_f32_16x16x32_bf16 v[132:135], a[244:247], v[76:79], v[132:135]
    ds_read_b128 a[232:235], v62 offset:55296
    v_mul_f32 v252, v252, v50
    v_mfma_f32_16x16x32_bf16 v[132:135], a[240:243], v[72:75], v[132:135]
    v_exp_f32 v23, v23
    v_mfma_f32_16x16x32_bf16 v[136:139], a[240:243], v[80:83], v[136:139]
    v_cvt_pk_bf16_f32 v105, v22, v23
    v_mul_f32 v253, v253, v50
    v_mfma_f32_16x16x32_bf16 v[136:139], a[244:247], v[84:87], v[136:139]
L_hop8:
    s_cbranch_execz L_hback
    v_exp_f32 v24, v24
    v_mfma_f32_16x16x32_bf16 v[140:143], a[244:247], v[92:95], 0
    v_exp_f32 v25, v25
    v_mfma_f32_16x16x32_bf16 v[140:143], a[240:243], v[88:91], v[140:143]
    s_waitcnt lgkmcnt(6)
    v_exp_f32 v26, v26
    v_mfma_f32_16x16x32_bf16 v[156:159], a[248:251], v[88:91], 0
    s_waitcnt lgkmcnt(4)
    v_exp_f32 v27, v27
    v_mfma_f32_16x16x32_bf16 v[156:159], a[252:255], v[92:95], v[156:159]
    v_cvt_pk_bf16_f32 v112, v24, v25
    v_cvt_pk_bf16_f32 v113, v26, v27
    v_mfma_f32_16x16x32_bf16 v[152:155], a[252:255], v[84:87], v[152:155]
    v_exp_f32 v28, v28
    v_mfma_f32_16x16x32_bf16 v[152:155], a[248:251], v[80:83], v[152:155]
    v_exp_f32 v29, v29
    v_mfma_f32_16x16x32_bf16 v[148:151], a[248:251], v[72:75], v[148:151]
    v_exp_f32 v30, v30
    v_mfma_f32_16x16x32_bf16 v[148:151], a[252:255], v[76:79], v[148:151]
    v_exp_f32 v31, v31
    v_mfma_f32_16x16x32_bf16 v[144:147], a[252:255], v[68:71], v[144:147]
    ds_read_b64_tr_b16 a[240:241], v1 offset:49816
    ds_read_b64_tr_b16 a[242:243], v1 offset:50328
    v_mfma_f32_16x16x32_bf16 v[144:147], a[248:251], v[64:67], v[144:147]
    s_waitcnt lgkmcnt(3)
    v_cvt_pk_bf16_f32 v120, v28, v29
    v_cvt_pk_bf16_f32 v121, v30, v31
    v_mfma_f32_16x16x32_bf16 v[16:19], a[224:227], a[0:3], -4.0
    ds_read_b64_tr_b16 a[244:245], v1 offset:50840
    ds_read_b64_tr_b16 a[246:247], v1 offset:51352
    v_mfma_f32_16x16x32_bf16 v[16:19], a[228:231], a[4:7], v[16:19]
    s_waitcnt lgkmcnt(4)
    v_mul_f32 v254, v254, v50
    v_mul_f32 v255, v255, v50
    v_mfma_f32_16x16x32_bf16 v[16:19], a[232:235], a[8:11], v[16:19]
    ds_read_b64_tr_b16 a[248:249], v1 offset:49824
    ds_read_b64_tr_b16 a[250:251], v1 offset:50336
    v_mfma_f32_16x16x32_bf16 v[16:19], a[236:239], a[12:15], v[16:19]
    v_cvt_pk_bf16_f32 v255, v254, v255
    v_cvt_pk_bf16_f32 v254, v252, v253
    v_mfma_f32_16x16x32_bf16 v[20:23], a[236:239], a[28:31], -4.0
    ds_read_b64_tr_b16 a[252:253], v1 offset:50848
    ds_read_b64_tr_b16 a[254:255], v1 offset:51360
    v_mfma_f32_16x16x32_bf16 v[20:23], a[232:235], a[24:27], v[20:23]
    v_cvt_pk_bf16_f32 v252, v236, v237
    v_cvt_pk_bf16_f32 v253, v238, v239
    v_mfma_f32_16x16x32_bf16 v[20:23], a[228:231], a[20:23], v[20:23]
    v_cndmask_b32_dpp v238, v222, v254, vcc row_ror:8 row_mask:0xf bank_mask:0xf
    v_mov_b32_dpp v222, v254 row_ror:8 row_mask:0xf bank_mask:0xc
    v_mfma_f32_16x16x32_bf16 v[20:23], a[224:227], a[16:19], v[20:23]
    v_exp_f32 v16, v16
    v_mfma_f32_16x16x32_bf16 v[24:27], a[224:227], a[32:35], -4.0
    v_exp_f32 v17, v17
    v_mfma_f32_16x16x32_bf16 v[24:27], a[228:231], a[36:39], v[24:27]
    v_exp_f32 v18, v18
    v_mfma_f32_16x16x32_bf16 v[24:27], a[232:235], a[40:43], v[24:27]
    v_exp_f32 v19, v19
    v_mfma_f32_16x16x32_bf16 v[24:27], a[236:239], a[44:47], v[24:27]
    v_exp_f32 v20, v20
    v_mfma_f32_16x16x32_bf16 v[28:31], a[236:239], a[60:63], -4.0
    ds_read_b128 a[236:239], v63 offset:60416
    v_cvt_pk_bf16_f32 v98, v16, v17
    v_mfma_f32_16x16x32_bf16 v[28:31], a[232:235], a[56:59], v[28:31]
    v_exp_f32 v21, v21
    v_mfma_f32_16x16x32_bf16 v[28:31], a[228:231], a[52:55], v[28:31]
    ds_read_b128 a[228:231], v63 offset:58368
    v_cvt_pk_bf16_f32 v99, v18, v19
    v_mfma_f32_16x16x32_bf16 v[28:31], a[224:227], a[48:51], v[28:31]
    v_exp_f32 v22, v22
    v_smfmac_f32_16x16x64_bf16 v[36:39], v[12:15], v[72:79], v57
    s_waitcnt lgkmcnt(8)
    v_cvt_pk_bf16_f32 v106, v20, v21
    v_mfma_f32_16x16x32_bf16 v[164:167], a[240:243], v[72:75], v[164:167]
    s_waitcnt lgkmcnt(6)
    ds_read_b128 a[224:227], v62 offset:57344
    v_cndmask_b32_dpp v236, v220, v252, vcc row_ror:8 row_mask:0xf bank_mask:0xf
    v_mfma_f32_16x16x32_bf16 v[164:167], a[244:247], v[76:79], v[164:167]
    v_exp_f32 v23, v23
    v_mfma_f32_16x16x32_bf16 v[160:163], a[244:247], v[68:71], v[160:163]
    ds_read_b128 a[232:235], v62 offset:59392
    v_cvt_pk_bf16_f32 v107, v22, v23
    v_mfma_f32_16x16x32_bf16 v[160:163], a[240:243], v[64:67], v[160:163]
    v_exp_f32 v24, v24
    v_mfma_f32_16x16x32_bf16 v[168:171], a[240:243], v[80:83], v[168:171]
    v_exp_f32 v25, v25
    v_mfma_f32_16x16x32_bf16 v[168:171], a[244:247], v[84:87], v[168:171]
    v_exp_f32 v26, v26
    v_mfma_f32_16x16x32_bf16 v[172:175], a[244:247], v[92:95], 0
    v_exp_f32 v27, v27
    v_mfma_f32_16x16x32_bf16 v[172:175], a[240:243], v[88:91], v[172:175]
    s_waitcnt lgkmcnt(6)
    v_cvt_pk_bf16_f32 v114, v24, v25
    v_cvt_pk_bf16_f32 v115, v26, v27
    v_mfma_f32_16x16x32_bf16 v[188:191], a[248:251], v[88:91], 0
    s_waitcnt lgkmcnt(4)
    v_exp_f32 v28, v28
    v_mfma_f32_16x16x32_bf16 v[188:191], a[252:255], v[92:95], v[188:191]
    v_exp_f32 v29, v29
    v_mfma_f32_16x16x32_bf16 v[184:187], a[252:255], v[84:87], v[184:187]
    v_exp_f32 v30, v30
    v_mfma_f32_16x16x32_bf16 v[184:187], a[248:251], v[80:83], v[184:187]
    v_exp_f32 v31, v31
    v_mfma_f32_16x16x32_bf16 v[176:179], a[248:251], v[64:67], v[176:179]
    ds_read_b64_tr_b16 a[240:241], v1 offset:49880
    ds_read_b64_tr_b16 a[242:243], v1 offset:50392
    v_mfma_f32_16x16x32_bf16 v[176:179], a[252:255], v[68:71], v[176:179]
    v_cvt_pk_bf16_f32 v122, v28, v29
    v_cvt_pk_bf16_f32 v123, v30, v31
    v_mfma_f32_16x16x32_bf16 v[180:183], a[252:255], v[76:79], v[180:183]
    ds_read_b64_tr_b16 a[244:245], v1 offset:50904
    ds_read_b64_tr_b16 a[246:247], v1 offset:51416
    v_mfma_f32_16x16x32_bf16 v[180:183], a[248:251], v[72:75], v[180:183]
    s_waitcnt lgkmcnt(5)
    v_mov_b32_dpp v220, v252 row_ror:8 row_mask:0xf bank_mask:0xc
    v_cndmask_b32_dpp v237, v221, v253, vcc row_ror:8 row_mask:0xf bank_mask:0xf
    v_mfma_f32_16x16x32_bf16 v[16:19], a[224:227], a[0:3], -4.0
    ds_read_b64_tr_b16 a[248:249], v1 offset:49888
    ds_read_b64_tr_b16 a[250:251], v1 offset:50400
    v_mfma_f32_16x16x32_bf16 v[16:19], a[228:231], a[4:7], v[16:19]
    s_waitcnt lgkmcnt(6)
    v_mov_b32_dpp v221, v253 row_ror:8 row_mask:0xf bank_mask:0xc
    v_cndmask_b32_dpp v239, v223, v255, vcc row_ror:8 row_mask:0xf bank_mask:0xf
    v_mfma_f32_16x16x32_bf16 v[16:19], a[232:235], a[8:11], v[16:19]
    buffer_store_dwordx4 v[236:239], v2, s[24:27], s43 offen offset:2176 sc1
    v_mfma_f32_16x16x32_bf16 v[16:19], a[236:239], a[12:15], v[16:19]
    ds_read_b64_tr_b16 a[252:253], v1 offset:50912
    ds_read_b64_tr_b16 a[254:255], v1 offset:51424
    v_mfma_f32_16x16x32_bf16 v[20:23], a[236:239], a[28:31], -4.0
    v_mov_b32_dpp v223, v255 row_ror:8 row_mask:0xf bank_mask:0xc
    v_mfma_f32_16x16x32_bf16 v[20:23], a[232:235], a[24:27], v[20:23]
    v_mfma_f32_16x16x32_bf16 v[20:23], a[228:231], a[20:23], v[20:23]
    v_mfma_f32_16x16x32_bf16 v[20:23], a[224:227], a[16:19], v[20:23]
    s_nop 0
    v_exp_f32 v16, v16
    v_mfma_f32_16x16x32_bf16 v[24:27], a[224:227], a[32:35], -4.0
    v_exp_f32 v17, v17
    v_mfma_f32_16x16x32_bf16 v[24:27], a[228:231], a[36:39], v[24:27]
    v_exp_f32 v18, v18
    v_mfma_f32_16x16x32_bf16 v[24:27], a[232:235], a[40:43], v[24:27]
    v_exp_f32 v19, v19
    v_mfma_f32_16x16x32_bf16 v[24:27], a[236:239], a[44:47], v[24:27]
    v_cvt_pk_bf16_f32 v100, v16, v17
    v_cvt_pk_bf16_f32 v101, v18, v19
    v_mfma_f32_16x16x32_bf16 v[28:31], a[236:239], a[60:63], -4.0
    v_exp_f32 v20, v20
    v_mfma_f32_16x16x32_bf16 v[28:31], a[232:235], a[56:59], v[28:31]
    v_exp_f32 v21, v21
    v_mfma_f32_16x16x32_bf16 v[28:31], a[228:231], a[52:55], v[28:31]
    ds_read_b128 a[228:231], v63 offset:62464
    v_cvt_pk_bf16_f32 v108, v20, v21
    v_mfma_f32_16x16x32_bf16 v[28:31], a[224:227], a[48:51], v[28:31]
    v_exp_f32 v22, v22
    v_smfmac_f32_16x16x64_bf16 v[40:43], v[12:15], v[80:87], v57
    s_waitcnt lgkmcnt(7)
    v_mfma_f32_16x16x32_bf16 v[200:203], a[240:243], v[80:83], v[200:203]
    s_waitcnt lgkmcnt(5)
    v_exp_f32 v23, v23
    v_mfma_f32_16x16x32_bf16 v[200:203], a[244:247], v[84:87], v[200:203]
    buffer_store_dwordx4 v[220:223], v2, s[24:27], s43 offen offset:128 sc1
    v_mfma_f32_16x16x32_bf16 v[192:195], a[244:247], v[68:71], v[192:195]
    s_add_u32 s43, s43, 4096
    ds_read_b128 a[224:227], v62 offset:61440
    v_cvt_pk_bf16_f32 v109, v22, v23
    v_mfma_f32_16x16x32_bf16 v[192:195], a[240:243], v[64:67], v[192:195]
    v_exp_f32 v24, v24
    v_mfma_f32_16x16x32_bf16 v[196:199], a[240:243], v[72:75], v[196:199]
    v_exp_f32 v25, v25
    v_mfma_f32_16x16x32_bf16 v[196:199], a[244:247], v[76:79], v[196:199]
    ds_read_b128 a[232:235], v62 offset:63488
    v_cvt_pk_bf16_f32 v116, v24, v25
    v_mfma_f32_16x16x32_bf16 v[204:207], a[244:247], v[92:95], 0
    v_exp_f32 v26, v26
    v_mfma_f32_16x16x32_bf16 v[204:207], a[240:243], v[88:91], v[204:207]
    s_waitcnt lgkmcnt(5)
    v_exp_f32 v27, v27
    v_mfma_f32_16x16x32_bf16 v[220:223], a[248:251], v[88:91], 0
    s_waitcnt lgkmcnt(3)
    ds_read_b128 a[236:239], v63 offset:64512
    v_cvt_pk_bf16_f32 v117, v26, v27
    v_mfma_f32_16x16x32_bf16 v[220:223], a[252:255], v[92:95], v[220:223]
    v_exp_f32 v28, v28
    v_mfma_f32_16x16x32_bf16 v[212:215], a[252:255], v[76:79], v[212:215]
    v_exp_f32 v29, v29
    v_mfma_f32_16x16x32_bf16 v[212:215], a[248:251], v[72:75], v[212:215]
    v_exp_f32 v30, v30
    v_mfma_f32_16x16x32_bf16 v[208:211], a[248:251], v[64:67], v[208:211]
    v_exp_f32 v31, v31
    v_mfma_f32_16x16x32_bf16 v[208:211], a[252:255], v[68:71], v[208:211]
    ds_read_b64_tr_b16 a[240:241], v1 offset:49944
    ds_read_b64_tr_b16 a[242:243], v1 offset:50456
    v_mfma_f32_16x16x32_bf16 v[216:219], a[252:255], v[84:87], v[216:219]
    v_cvt_pk_bf16_f32 v124, v28, v29
    v_cvt_pk_bf16_f32 v125, v30, v31
    v_mfma_f32_16x16x32_bf16 v[216:219], a[248:251], v[80:83], v[216:219]
    s_waitcnt lgkmcnt(4)
    ds_read_b64_tr_b16 a[244:245], v1 offset:50968
    ds_read_b64_tr_b16 a[246:247], v1 offset:51480
    v_mfma_f32_16x16x32_bf16 v[16:19], a[224:227], a[0:3], -4.0
    v_mfma_f32_16x16x32_bf16 v[16:19], a[228:231], a[4:7], v[16:19]
    s_waitcnt vmcnt(8) lgkmcnt(5)
    ds_read_b128 a[0:3], v3 offset:0
    v_mfma_f32_16x16x32_bf16 v[16:19], a[232:235], a[8:11], v[16:19]
    s_waitcnt lgkmcnt(5)
    v_mfma_f32_16x16x32_bf16 v[16:19], a[236:239], a[12:15], v[16:19]
    ds_read_b128 a[4:7], v3 offset:64
    v_mfma_f32_16x16x32_bf16 v[20:23], a[236:239], a[28:31], -4.0
    v_mfma_f32_16x16x32_bf16 v[20:23], a[232:235], a[24:27], v[20:23]
    ds_read_b128 a[8:11], v3 offset:128
    v_mfma_f32_16x16x32_bf16 v[20:23], a[228:231], a[20:23], v[20:23]
    s_nop 0
    v_mfma_f32_16x16x32_bf16 v[20:23], a[224:227], a[16:19], v[20:23]
    s_nop 0
    v_exp_f32 v16, v16
    v_mfma_f32_16x16x32_bf16 v[24:27], a[224:227], a[32:35], -4.0
    v_exp_f32 v17, v17
    v_mfma_f32_16x16x32_bf16 v[24:27], a[228:231], a[36:39], v[24:27]
    ds_read_b128 a[12:15], v3 offset:192
    v_cvt_pk_bf16_f32 v102, v16, v17
    v_mfma_f32_16x16x32_bf16 v[24:27], a[232:235], a[40:43], v[24:27]
    v_exp_f32 v18, v18
    v_mfma_f32_16x16x32_bf16 v[24:27], a[236:239], a[44:47], v[24:27]
    ds_read_b64_tr_b16 a[248:249], v1 offset:49952
    ds_read_b64_tr_b16 a[250:251], v1 offset:50464
    v_mfma_f32_16x16x32_bf16 v[28:31], a[236:239], a[60:63], -4.0
    v_exp_f32 v19, v19
    v_mfma_f32_16x16x32_bf16 v[28:31], a[232:235], a[56:59], v[28:31]
    ds_read_b64_tr_b16 a[252:253], v1 offset:50976
    ds_read_b64_tr_b16 a[254:255], v1 offset:51488
    v_mfma_f32_16x16x32_bf16 v[28:31], a[228:231], a[52:55], v[28:31]
    v_exp_f32 v20, v20
    v_mfma_f32_16x16x32_bf16 v[28:31], a[224:227], a[48:51], v[28:31]
    ds_read_b128 a[232:235], v60 offset:17632
    v_cvt_pk_bf16_f32 v103, v18, v19
    v_smfmac_f32_16x16x64_bf16 v[44:47], v[12:15], v[88:95], v57
    s_waitcnt lgkmcnt(11)
    v_mfma_f32_16x16x32_bf16 v[236:239], a[240:243], v[88:91], 0
    s_waitcnt lgkmcnt(9)
    v_exp_f32 v21, v21
    v_mfma_f32_16x16x32_bf16 v[236:239], a[244:247], v[92:95], v[236:239]
    v_exp_f32 v22, v22
    v_mfma_f32_16x16x32_bf16 v[224:227], a[244:247], v[68:71], v[224:227]
    v_exp_f32 v23, v23
    v_mfma_f32_16x16x32_bf16 v[224:227], a[240:243], v[64:67], v[224:227]
    v_cvt_pk_bf16_f32 v110, v20, v21
    v_cvt_pk_bf16_f32 v111, v22, v23
    v_mfma_f32_16x16x32_bf16 v[228:231], a[240:243], v[72:75], v[228:231]
    v_exp_f32 v24, v24
    v_mfma_f32_16x16x32_bf16 v[228:231], a[244:247], v[76:79], v[228:231]
    v_exp_f32 v25, v25
    v_mfma_f32_16x16x32_bf16 v[232:235], a[244:247], v[84:87], v[232:235]
    s_waitcnt vmcnt(2) lgkmcnt(1)
    v_exp_f32 v26, v26
    v_mfma_f32_16x16x32_bf16 v[232:235], a[240:243], v[80:83], v[232:235]
    s_barrier
    buffer_load_dwordx4 v0, s[20:23], s32 offen offset:0 lds
    v_mfma_f32_16x16x32_bf16 v[248:251], a[248:251], v[80:83], v[248:251]
    v_exp_f32 v27, v27
    v_mfma_f32_16x16x32_bf16 v[248:251], a[252:255], v[84:87], v[248:251]
    v_cvt_pk_bf16_f32 v118, v24, v25
    v_cvt_pk_bf16_f32 v119, v26, v27
    v_mfma_f32_16x16x32_bf16 v[244:247], a[252:255], v[76:79], v[244:247]
    v_exp_f32 v28, v28
    v_mfma_f32_16x16x32_bf16 v[244:247], a[248:251], v[72:75], v[244:247]
    v_exp_f32 v29, v29
    v_mfma_f32_16x16x32_bf16 v[240:243], a[248:251], v[64:67], v[240:243]
    buffer_load_dwordx4 v0, s[20:23], s32 offen offset:1024 lds
    v_mfma_f32_16x16x32_bf16 v[240:243], a[252:255], v[68:71], v[240:243]
    v_exp_f32 v30, v30
    v_mfma_f32_16x16x32_bf16 v[252:255], a[252:255], v[92:95], 0
    s_sub_u32 s44, s44, 1
    v_exp_f32 v31, v31
    v_mfma_f32_16x16x32_bf16 v[252:255], a[248:251], v[88:91], v[252:255]
    ds_read_b64_tr_b16 a[240:241], v1 offset:33168
    ds_read_b64_tr_b16 a[242:243], v1 offset:33680
    s_cbranch_scc0 L_loop
    v_mfma_f32_16x16x32_bf16 v[16:19], a[64:67], a[16:19], -4.0
    v_cvt_pk_bf16_f32 v126, v28, v29
    v_cvt_pk_bf16_f32 v127, v30, v31
    v_mfma_f32_16x16x32_bf16 v[16:19], a[68:71], a[20:23], v[16:19]
    buffer_load_dwordx4 v0, s[28:31], s32 offen offset:2056 lds
    v_mfma_f32_16x16x32_bf16 v[16:19], a[72:75], a[24:27], v[16:19]
    ds_read_b64_tr_b16 a[244:245], v1 offset:34192
    ds_read_b64_tr_b16 a[246:247], v1 offset:34704
    v_mfma_f32_16x16x32_bf16 v[16:19], a[76:79], a[28:31], v[16:19]
    v_mfma_f32_16x16x32_bf16 v[20:23], a[76:79], a[44:47], -4.0
    ds_read_b64_tr_b16 a[248:249], v1 offset:33176
    ds_read_b64_tr_b16 a[250:251], v1 offset:33688
    v_mfma_f32_16x16x32_bf16 v[20:23], a[72:75], a[40:43], v[20:23]
    v_mfma_f32_16x16x32_bf16 v[20:23], a[68:71], a[36:39], v[20:23]
    buffer_load_dwordx4 v0, s[28:31], s32 offen offset:3080 lds
    v_mfma_f32_16x16x32_bf16 v[20:23], a[64:67], a[32:35], v[20:23]
    s_mov_b32 m0, s98
    ds_read_b64_tr_b16 a[252:253], v1 offset:34200
    ds_read_b64_tr_b16 a[254:255], v1 offset:34712
    v_mfma_f32_16x16x32_bf16 v[24:27], a[64:67], a[48:51], -4.0
    v_exp_f32 v16, v16
    v_mfma_f32_16x16x32_bf16 v[24:27], a[68:71], a[52:55], v[24:27]
    v_exp_f32 v17, v17
    v_mfma_f32_16x16x32_bf16 v[24:27], a[72:75], a[56:59], v[24:27]
    v_exp_f32 v18, v18
    v_mfma_f32_16x16x32_bf16 v[24:27], a[76:79], a[60:63], v[24:27]
    v_exp_f32 v19, v19
    v_smfmac_f32_16x16x64_bf16 v[32:35], v[12:15], v[96:103], v57
    s_waitcnt lgkmcnt(6)
    v_cvt_pk_bf16_f32 v72, v16, v17
    v_mfma_f32_16x16x32_bf16 v[128:131], a[240:243], v[96:99], v[128:131]
    s_waitcnt lgkmcnt(4)
    ds_read_b128 a[236:239], v61 offset:18656
    v_cvt_pk_bf16_f32 v73, v18, v19
    v_mfma_f32_16x16x32_bf16 v[128:131], a[244:247], v[100:103], v[128:131]
    v_exp_f32 v20, v20
    v_mfma_f32_16x16x32_bf16 v[132:135], a[244:247], v[108:111], v[132:135]
    v_exp_f32 v21, v21
    v_mfma_f32_16x16x32_bf16 v[132:135], a[240:243], v[104:107], v[132:135]
    v_exp_f32 v22, v22
    v_mfma_f32_16x16x32_bf16 v[136:139], a[240:243], v[112:115], v[136:139]
    v_exp_f32 v23, v23
    v_mfma_f32_16x16x32_bf16 v[136:139], a[244:247], v[116:119], v[136:139]
    v_cvt_pk_bf16_f32 v80, v20, v21
    v_cvt_pk_bf16_f32 v81, v22, v23
    v_mfma_f32_16x16x32_bf16 v[140:143], a[244:247], v[124:127], v[140:143]
    v_exp_f32 v24, v24
    v_mfma_f32_16x16x32_bf16 v[140:143], a[240:243], v[120:123], v[140:143]
    s_waitcnt lgkmcnt(3)
    ds_read_b64_tr_b16 a[240:241], v1 offset:33232
    ds_read_b64_tr_b16 a[242:243], v1 offset:33744
    v_mfma_f32_16x16x32_bf16 v[156:159], a[248:251], v[120:123], v[156:159]
    s_waitcnt lgkmcnt(3)
    v_exp_f32 v25, v25
    v_mfma_f32_16x16x32_bf16 v[156:159], a[252:255], v[124:127], v[156:159]
    ds_read_b64_tr_b16 a[244:245], v1 offset:34256
    ds_read_b64_tr_b16 a[246:247], v1 offset:34768
    v_mfma_f32_16x16x32_bf16 v[152:155], a[252:255], v[116:119], v[152:155]
    v_exp_f32 v26, v26
    v_mfma_f32_16x16x32_bf16 v[152:155], a[248:251], v[112:115], v[152:155]
    v_exp_f32 v27, v27
    v_mfma_f32_16x16x32_bf16 v[148:151], a[248:251], v[104:107], v[148:151]
    v_cvt_pk_bf16_f32 v88, v24, v25
    v_cvt_pk_bf16_f32 v89, v26, v27
    v_mfma_f32_16x16x32_bf16 v[148:151], a[252:255], v[108:111], v[148:151]
    ds_read_b128 a[224:227], v60 offset:19680
    v_add_f32 v32, v32, v33
    v_mfma_f32_16x16x32_bf16 v[144:147], a[252:255], v[100:103], v[144:147]
    v_rcp_f32 v48, v32
    v_mfma_f32_16x16x32_bf16 v[144:147], a[248:251], v[96:99], v[144:147]
    ds_read_b64_tr_b16 a[248:249], v1 offset:33240
    ds_read_b64_tr_b16 a[250:251], v1 offset:33752
    v_mfma_f32_16x16x32_bf16 v[28:31], a[80:83], a[16:19], -4.0
    v_mul_f32 v128, v128, v48
    v_mul_f32 v129, v129, v48
    v_mfma_f32_16x16x32_bf16 v[28:31], a[84:87], a[20:23], v[28:31]
    ds_read_b64_tr_b16 a[252:253], v1 offset:34264
    ds_read_b64_tr_b16 a[254:255], v1 offset:34776
    v_mfma_f32_16x16x32_bf16 v[28:31], a[88:91], a[24:27], v[28:31]
    v_mul_f32 v130, v130, v48
    v_mul_f32 v131, v131, v48
    v_mfma_f32_16x16x32_bf16 v[28:31], a[92:95], a[28:31], v[28:31]
    ds_read_b128 a[228:231], v61 offset:20704
    v_mul_f32 v144, v144, v48
    v_mfma_f32_16x16x32_bf16 v[16:19], a[92:95], a[44:47], -4.0
    v_mul_f32 v145, v145, v48
    v_mul_f32 v146, v146, v48
    v_mfma_f32_16x16x32_bf16 v[16:19], a[88:91], a[40:43], v[16:19]
    v_mul_f32 v147, v147, v48
    v_cvt_pk_bf16_f32 v147, v146, v147
    v_mfma_f32_16x16x32_bf16 v[16:19], a[84:87], a[36:39], v[16:19]
    v_cvt_pk_bf16_f32 v146, v144, v145
    v_cvt_pk_bf16_f32 v144, v128, v129
    v_mfma_f32_16x16x32_bf16 v[16:19], a[80:83], a[32:35], v[16:19]
    v_exp_f32 v28, v28
    v_mfma_f32_16x16x32_bf16 v[20:23], a[80:83], a[48:51], -4.0
    v_exp_f32 v29, v29
    v_mfma_f32_16x16x32_bf16 v[20:23], a[84:87], a[52:55], v[20:23]
    v_exp_f32 v30, v30
    v_mfma_f32_16x16x32_bf16 v[20:23], a[88:91], a[56:59], v[20:23]
    v_exp_f32 v31, v31
    v_mfma_f32_16x16x32_bf16 v[20:23], a[92:95], a[60:63], v[20:23]
    v_cvt_pk_bf16_f32 v74, v28, v29
    v_cvt_pk_bf16_f32 v75, v30, v31
    v_smfmac_f32_16x16x64_bf16 v[36:39], v[12:15], v[104:111], v57
    s_waitcnt lgkmcnt(8)
    v_cvt_pk_bf16_f32 v145, v130, v131
    v_mfma_f32_16x16x32_bf16 v[164:167], a[240:243], v[104:107], v[164:167]
    s_waitcnt lgkmcnt(6)
    v_exp_f32 v16, v16
    v_mfma_f32_16x16x32_bf16 v[164:167], a[244:247], v[108:111], v[164:167]
    v_exp_f32 v17, v17
    v_mfma_f32_16x16x32_bf16 v[160:163], a[244:247], v[100:103], v[160:163]
    v_exp_f32 v18, v18
    v_mfma_f32_16x16x32_bf16 v[160:163], a[240:243], v[96:99], v[160:163]
    v_exp_f32 v19, v19
    v_mfma_f32_16x16x32_bf16 v[168:171], a[240:243], v[112:115], v[168:171]
    v_cvt_pk_bf16_f32 v82, v16, v17
    v_cvt_pk_bf16_f32 v83, v18, v19
    v_mfma_f32_16x16x32_bf16 v[168:171], a[244:247], v[116:119], v[168:171]
    v_exp_f32 v20, v20
    v_mfma_f32_16x16x32_bf16 v[172:175], a[244:247], v[124:127], v[172:175]
    ds_read_b64_tr_b16 a[244:245], v1 offset:34320
    ds_read_b64_tr_b16 a[246:247], v1 offset:34832
    v_mfma_f32_16x16x32_bf16 v[172:175], a[240:243], v[120:123], v[172:175]
    s_waitcnt lgkmcnt(5)
    v_exp_f32 v21, v21
    v_mfma_f32_16x16x32_bf16 v[188:191], a[248:251], v[120:123], v[188:191]
    s_waitcnt lgkmcnt(3)
    ds_read_b64_tr_b16 a[240:241], v1 offset:33296
    ds_read_b64_tr_b16 a[242:243], v1 offset:33808
    v_mfma_f32_16x16x32_bf16 v[188:191], a[252:255], v[124:127], v[188:191]
    v_exp_f32 v22, v22
    v_mfma_f32_16x16x32_bf16 v[184:187], a[252:255], v[116:119], v[184:187]
    v_exp_f32 v23, v23
    v_mfma_f32_16x16x32_bf16 v[184:187], a[248:251], v[112:115], v[184:187]
    v_cvt_pk_bf16_f32 v90, v20, v21
    v_cvt_pk_bf16_f32 v91, v22, v23
    v_mfma_f32_16x16x32_bf16 v[176:179], a[248:251], v[96:99], v[176:179]
    v_mul_f32 v160, v160, v48
    v_mul_f32 v161, v161, v48
    v_mfma_f32_16x16x32_bf16 v[176:179], a[252:255], v[100:103], v[176:179]
    v_mul_f32 v162, v162, v48
    v_mul_f32 v163, v163, v48
    v_mfma_f32_16x16x32_bf16 v[180:183], a[252:255], v[108:111], v[180:183]
    ds_read_b64_tr_b16 a[252:253], v1 offset:34328
    ds_read_b64_tr_b16 a[254:255], v1 offset:34840
    v_mfma_f32_16x16x32_bf16 v[180:183], a[248:251], v[104:107], v[180:183]
    v_max3_u32 v58, v58, v32, v48
    v_mfma_f32_16x16x32_bf16 v[24:27], a[96:99], a[16:19], -4.0
    ds_read_b64_tr_b16 a[248:249], v1 offset:33304
    ds_read_b64_tr_b16 a[250:251], v1 offset:33816
    v_mfma_f32_16x16x32_bf16 v[24:27], a[100:103], a[20:23], v[24:27]
    v_mul_f32 v176, v176, v48
    v_mul_f32 v177, v177, v48
    v_mfma_f32_16x16x32_bf16 v[24:27], a[104:107], a[24:27], v[24:27]
    v_mul_f32 v178, v178, v48
    v_mul_f32 v179, v179, v48
    v_mfma_f32_16x16x32_bf16 v[24:27], a[108:111], a[28:31], v[24:27]
    v_cvt_pk_bf16_f32 v179, v178, v179
    v_cvt_pk_bf16_f32 v178, v176, v177
    v_mfma_f32_16x16x32_bf16 v[28:31], a[108:111], a[44:47], -4.0
    v_cvt_pk_bf16_f32 v176, v160, v161
    v_cvt_pk_bf16_f32 v177, v162, v163
    v_mfma_f32_16x16x32_bf16 v[28:31], a[104:107], a[40:43], v[28:31]
    v_cndmask_b32_dpp v162, v146, v178, vcc row_ror:8 row_mask:0xf bank_mask:0xf
    v_mov_b32_dpp v146, v178 row_ror:8 row_mask:0xf bank_mask:0xc
    v_mfma_f32_16x16x32_bf16 v[28:31], a[100:103], a[36:39], v[28:31]
    v_cndmask_b32_dpp v160, v144, v176, vcc row_ror:8 row_mask:0xf bank_mask:0xf
    v_mov_b32_dpp v144, v176 row_ror:8 row_mask:0xf bank_mask:0xc
    v_mfma_f32_16x16x32_bf16 v[28:31], a[96:99], a[32:35], v[28:31]
    v_exp_f32 v24, v24
    v_mfma_f32_16x16x32_bf16 v[16:19], a[96:99], a[48:51], -4.0
    v_exp_f32 v25, v25
    v_mfma_f32_16x16x32_bf16 v[16:19], a[100:103], a[52:55], v[16:19]
    v_exp_f32 v26, v26
    v_mfma_f32_16x16x32_bf16 v[16:19], a[104:107], a[56:59], v[16:19]
    v_exp_f32 v27, v27
    v_mfma_f32_16x16x32_bf16 v[16:19], a[108:111], a[60:63], v[16:19]
    v_cvt_pk_bf16_f32 v76, v24, v25
    v_cvt_pk_bf16_f32 v77, v26, v27
    v_smfmac_f32_16x16x64_bf16 v[40:43], v[12:15], v[112:119], v57
    s_waitcnt lgkmcnt(4)
    v_cndmask_b32_dpp v161, v145, v177, vcc row_ror:8 row_mask:0xf bank_mask:0xf
    v_mfma_f32_16x16x32_bf16 v[200:203], a[240:243], v[112:115], v[200:203]
    v_exp_f32 v28, v28
    v_mfma_f32_16x16x32_bf16 v[200:203], a[244:247], v[116:119], v[200:203]
    v_exp_f32 v29, v29
    v_mfma_f32_16x16x32_bf16 v[192:195], a[244:247], v[100:103], v[192:195]
    v_exp_f32 v30, v30
    v_mfma_f32_16x16x32_bf16 v[192:195], a[240:243], v[96:99], v[192:195]
    v_exp_f32 v31, v31
    v_mfma_f32_16x16x32_bf16 v[196:199], a[240:243], v[104:107], v[196:199]
    v_cvt_pk_bf16_f32 v84, v28, v29
    v_cvt_pk_bf16_f32 v85, v30, v31
    v_mfma_f32_16x16x32_bf16 v[196:199], a[244:247], v[108:111], v[196:199]
    v_exp_f32 v16, v16
    v_mfma_f32_16x16x32_bf16 v[204:207], a[244:247], v[124:127], v[204:207]
    ds_read_b64_tr_b16 a[244:245], v1 offset:34384
    ds_read_b64_tr_b16 a[246:247], v1 offset:34896
    v_mfma_f32_16x16x32_bf16 v[204:207], a[240:243], v[120:123], v[204:207]
    s_waitcnt lgkmcnt(2)
    v_exp_f32 v17, v17
    v_mfma_f32_16x16x32_bf16 v[220:223], a[248:251], v[120:123], v[220:223]
    ds_read_b64_tr_b16 a[240:241], v1 offset:33360
    ds_read_b64_tr_b16 a[242:243], v1 offset:33872
    v_mfma_f32_16x16x32_bf16 v[220:223], a[252:255], v[124:127], v[220:223]
    v_exp_f32 v18, v18
    v_mfma_f32_16x16x32_bf16 v[212:215], a[252:255], v[108:111], v[212:215]
    v_exp_f32 v19, v19
    v_mfma_f32_16x16x32_bf16 v[212:215], a[248:251], v[104:107], v[212:215]
    v_cvt_pk_bf16_f32 v92, v16, v17
    v_cvt_pk_bf16_f32 v93, v18, v19
    v_mfma_f32_16x16x32_bf16 v[208:211], a[248:251], v[96:99], v[208:211]
    v_mov_b32_dpp v145, v177 row_ror:8 row_mask:0xf bank_mask:0xc
    v_cndmask_b32_dpp v163, v147, v179, vcc row_ror:8 row_mask:0xf bank_mask:0xf
    v_mfma_f32_16x16x32_bf16 v[208:211], a[252:255], v[100:103], v[208:211]
    buffer_store_dwordx4 v[160:163], v2, s[24:27], s43 offen offset:2048 sc1
    v_mfma_f32_16x16x32_bf16 v[216:219], a[252:255], v[116:119], v[216:219]
    ds_read_b64_tr_b16 a[252:253], v1 offset:34392
    ds_read_b64_tr_b16 a[254:255], v1 offset:34904
    v_mfma_f32_16x16x32_bf16 v[216:219], a[248:251], v[112:115], v[216:219]
    v_mov_b32_dpp v147, v179 row_ror:8 row_mask:0xf bank_mask:0xc
    v_mul_f32 v192, v192, v48
    v_mfma_f32_16x16x32_bf16 v[20:23], a[112:115], a[16:19], -4.0
    ds_read_b64_tr_b16 a[248:249], v1 offset:33368
    ds_read_b64_tr_b16 a[250:251], v1 offset:33880
    v_mfma_f32_16x16x32_bf16 v[20:23], a[116:119], a[20:23], v[20:23]
    v_mul_f32 v193, v193, v48
    v_mul_f32 v194, v194, v48
    v_mfma_f32_16x16x32_bf16 v[20:23], a[120:123], a[24:27], v[20:23]
    v_mul_f32 v195, v195, v48
    v_mul_f32 v208, v208, v48
    v_mfma_f32_16x16x32_bf16 v[20:23], a[124:127], a[28:31], v[20:23]
    v_mul_f32 v209, v209, v48
    v_mul_f32 v210, v210, v48
    v_mfma_f32_16x16x32_bf16 v[24:27], a[124:127], a[44:47], -4.0
    v_mul_f32 v211, v211, v48
    v_cvt_pk_bf16_f32 v211, v210, v211
    v_mfma_f32_16x16x32_bf16 v[24:27], a[120:123], a[40:43], v[24:27]
    v_cvt_pk_bf16_f32 v210, v208, v209
    v_cvt_pk_bf16_f32 v208, v192, v193
    v_mfma_f32_16x16x32_bf16 v[24:27], a[116:119], a[36:39], v[24:27]
    ds_read_b128 a[64:67], v60 offset:31968
    v_cvt_pk_bf16_f32 v209, v194, v195
    v_mfma_f32_16x16x32_bf16 v[24:27], a[112:115], a[32:35], v[24:27]
    v_exp_f32 v20, v20
    v_mfma_f32_16x16x32_bf16 v[28:31], a[112:115], a[48:51], -4.0
    v_exp_f32 v21, v21
    v_mfma_f32_16x16x32_bf16 v[28:31], a[116:119], a[52:55], v[28:31]
    v_exp_f32 v22, v22
    v_mfma_f32_16x16x32_bf16 v[28:31], a[120:123], a[56:59], v[28:31]
    v_exp_f32 v23, v23
    v_mfma_f32_16x16x32_bf16 v[28:31], a[124:127], a[60:63], v[28:31]
    v_cvt_pk_bf16_f32 v78, v20, v21
    v_cvt_pk_bf16_f32 v79, v22, v23
    v_smfmac_f32_16x16x64_bf16 v[44:47], v[12:15], v[120:127], v57
    s_waitcnt lgkmcnt(5)
    v_mfma_f32_16x16x32_bf16 v[236:239], a[240:243], v[120:123], v[236:239]
    buffer_store_dwordx4 v[144:147], v2, s[24:27], s43 offen offset:0 sc1
    v_mfma_f32_16x16x32_bf16 v[236:239], a[244:247], v[124:127], v[236:239]
    v_exp_f32 v24, v24
    v_mfma_f32_16x16x32_bf16 v[224:227], a[244:247], v[100:103], v[224:227]
    v_exp_f32 v25, v25
    v_mfma_f32_16x16x32_bf16 v[224:227], a[240:243], v[96:99], v[224:227]
    v_exp_f32 v26, v26
    v_mfma_f32_16x16x32_bf16 v[228:231], a[240:243], v[104:107], v[228:231]
    v_exp_f32 v27, v27
    v_mfma_f32_16x16x32_bf16 v[228:231], a[244:247], v[108:111], v[228:231]
    v_cvt_pk_bf16_f32 v86, v24, v25
    v_cvt_pk_bf16_f32 v87, v26, v27
    v_mfma_f32_16x16x32_bf16 v[232:235], a[244:247], v[116:119], v[232:235]
    v_exp_f32 v28, v28
    v_mfma_f32_16x16x32_bf16 v[232:235], a[240:243], v[112:115], v[232:235]
    s_waitcnt lgkmcnt(1)
    v_exp_f32 v29, v29
    v_mfma_f32_16x16x32_bf16 v[248:251], a[248:251], v[112:115], v[248:251]
    s_waitcnt vmcnt(2)
    v_exp_f32 v30, v30
    v_mfma_f32_16x16x32_bf16 v[248:251], a[252:255], v[116:119], v[248:251]
    s_barrier
    buffer_load_dwordx4 v0, s[20:23], s33 offen offset:0 lds
    v_mfma_f32_16x16x32_bf16 v[244:247], a[252:255], v[108:111], v[244:247]
    ds_read_b64_tr_b16 a[240:241], v1 offset:49752
    ds_read_b64_tr_b16 a[242:243], v1 offset:50264
    v_mfma_f32_16x16x32_bf16 v[244:247], a[248:251], v[104:107], v[244:247]
    v_exp_f32 v31, v31
    v_mfma_f32_16x16x32_bf16 v[240:243], a[248:251], v[96:99], v[240:243]
    ds_read_b64_tr_b16 a[244:245], v1 offset:50776
    ds_read_b64_tr_b16 a[246:247], v1 offset:51288
    v_mfma_f32_16x16x32_bf16 v[240:243], a[252:255], v[100:103], v[240:243]
    v_cvt_pk_bf16_f32 v94, v28, v29
    v_cvt_pk_bf16_f32 v95, v30, v31
    v_mfma_f32_16x16x32_bf16 v[252:255], a[252:255], v[124:127], v[252:255]
    buffer_load_dwordx4 v0, s[20:23], s33 offen offset:1024 lds
    v_mfma_f32_16x16x32_bf16 v[252:255], a[248:251], v[120:123], v[252:255]
    ds_read_b64_tr_b16 a[252:253], v1 offset:50784
    ds_read_b64_tr_b16 a[254:255], v1 offset:51296
    v_mfma_f32_16x16x32_bf16 v[16:19], v[52:55], a[16:19], -4.0
    v_mul_f32 v224, v224, v48
    v_mul_f32 v225, v225, v48
    v_mfma_f32_16x16x32_bf16 v[16:19], v[8:11], a[20:23], v[16:19]
    ds_read_b64_tr_b16 a[248:249], v1 offset:49760
    ds_read_b64_tr_b16 a[250:251], v1 offset:50272
    v_mfma_f32_16x16x32_bf16 v[16:19], a[232:235], a[24:27], v[16:19]
    v_mul_f32 v226, v226, v48
    v_mul_f32 v227, v227, v48
    v_mfma_f32_16x16x32_bf16 v[16:19], a[236:239], a[28:31], v[16:19]
    buffer_load_dwordx4 v0, s[28:31], s33 offen offset:2056 lds
    v_mfma_f32_16x16x32_bf16 v[20:23], a[236:239], a[44:47], -4.0
    v_mul_f32 v240, v240, v48
    v_mul_f32 v241, v241, v48
    v_mfma_f32_16x16x32_bf16 v[20:23], a[232:235], a[40:43], v[20:23]
    v_mul_f32 v242, v242, v48
    v_mul_f32 v243, v243, v48
    v_mfma_f32_16x16x32_bf16 v[20:23], v[8:11], a[36:39], v[20:23]
    v_cvt_pk_bf16_f32 v243, v242, v243
    v_cvt_pk_bf16_f32 v242, v240, v241
    v_mfma_f32_16x16x32_bf16 v[20:23], v[52:55], a[32:35], v[20:23]
    v_exp_f32 v16, v16
    v_mfma_f32_16x16x32_bf16 v[24:27], v[52:55], a[48:51], -4.0
    buffer_load_dwordx4 v0, s[28:31], s33 offen offset:3080 lds
    v_mfma_f32_16x16x32_bf16 v[24:27], v[8:11], a[52:55], v[24:27]
    v_exp_f32 v17, v17
    v_mfma_f32_16x16x32_bf16 v[24:27], a[232:235], a[56:59], v[24:27]
    s_mov_b32 m0, s96
    ds_read_b128 a[232:235], v60 offset:21728
    v_cvt_pk_bf16_f32 v104, v16, v17
    v_mfma_f32_16x16x32_bf16 v[24:27], a[236:239], a[60:63], v[24:27]
L_hop9:
    s_cbranch_execz L_hback
    v_exp_f32 v18, v18
    v_smfmac_f32_16x16x64_bf16 v[36:39], v[12:15], v[72:79], v57
    s_waitcnt lgkmcnt(7)
    v_cvt_pk_bf16_f32 v240, v224, v225
    v_mfma_f32_16x16x32_bf16 v[132:135], a[240:243], v[72:75], v[132:135]
    s_waitcnt lgkmcnt(5)
    buffer_load_dwordx4 v0, s[20:23], s34 offen offset:0 lds
    v_mfma_f32_16x16x32_bf16 v[132:135], a[244:247], v[76:79], v[132:135]
    ds_read_b128 a[236:239], v61 offset:22752
    v_cvt_pk_bf16_f32 v241, v226, v227
    v_mfma_f32_16x16x32_bf16 v[136:139], a[244:247], v[84:87], v[136:139]
    v_exp_f32 v19, v19
    v_mfma_f32_16x16x32_bf16 v[136:139], a[240:243], v[80:83], v[136:139]
    v_cvt_pk_bf16_f32 v105, v18, v19
    v_cndmask_b32_dpp v224, v208, v240, vcc row_ror:8 row_mask:0xf bank_mask:0xf
    v_mfma_f32_16x16x32_bf16 v[140:143], a[240:243], v[88:91], v[140:143]
    v_exp_f32 v20, v20
    v_mfma_f32_16x16x32_bf16 v[140:143], a[244:247], v[92:95], v[140:143]
    s_waitcnt lgkmcnt(4)
    buffer_load_dwordx4 v0, s[20:23], s34 offen offset:1024 lds
    v_mfma_f32_16x16x32_bf16 v[156:159], a[252:255], v[92:95], v[156:159]
    s_waitcnt lgkmcnt(2)
    v_exp_f32 v21, v21
    v_mfma_f32_16x16x32_bf16 v[156:159], a[248:251], v[88:91], v[156:159]
    v_exp_f32 v22, v22
    v_mfma_f32_16x16x32_bf16 v[152:155], a[248:251], v[80:83], v[152:155]
    v_exp_f32 v23, v23
    v_mfma_f32_16x16x32_bf16 v[152:155], a[252:255], v[84:87], v[152:155]
    ds_read_b64_tr_b16 a[240:241], v1 offset:49816
    ds_read_b64_tr_b16 a[242:243], v1 offset:50328
    v_mfma_f32_16x16x32_bf16 v[148:151], a[252:255], v[76:79], v[148:151]
    v_exp_f32 v24, v24
    v_mfma_f32_16x16x32_bf16 v[148:151], a[248:251], v[72:75], v[148:151]
    buffer_load_dwordx4 v0, s[28:31], s34 offen offset:2056 lds
    v_mfma_f32_16x16x32_bf16 v[28:31], a[224:227], a[16:19], -4.0
    v_cvt_pk_bf16_f32 v112, v20, v21
    v_cvt_pk_bf16_f32 v113, v22, v23
    v_mfma_f32_16x16x32_bf16 v[28:31], a[228:231], a[20:23], v[28:31]
    s_waitcnt lgkmcnt(3)
    v_exp_f32 v25, v25
    v_mfma_f32_16x16x32_bf16 v[28:31], a[232:235], a[24:27], v[28:31]
    s_waitcnt lgkmcnt(2)
    ds_read_b64_tr_b16 a[244:245], v1 offset:50840
    ds_read_b64_tr_b16 a[246:247], v1 offset:51352
    v_mfma_f32_16x16x32_bf16 v[28:31], a[236:239], a[28:31], v[28:31]
    v_exp_f32 v26, v26
    v_mfma_f32_16x16x32_bf16 v[16:19], a[236:239], a[44:47], -4.0
    buffer_load_dwordx4 v0, s[28:31], s34 offen offset:3080 lds
    v_mfma_f32_16x16x32_bf16 v[16:19], a[232:235], a[40:43], v[16:19]
    s_mov_b32 m0, s97
    ds_read_b64_tr_b16 a[252:253], v1 offset:50848
    ds_read_b64_tr_b16 a[254:255], v1 offset:51360
    v_mfma_f32_16x16x32_bf16 v[16:19], a[228:231], a[36:39], v[16:19]
    v_exp_f32 v27, v27
    v_mfma_f32_16x16x32_bf16 v[16:19], a[224:227], a[32:35], v[16:19]
    ds_read_b64_tr_b16 a[248:249], v1 offset:49824
    ds_read_b64_tr_b16 a[250:251], v1 offset:50336
    v_mfma_f32_16x16x32_bf16 v[20:23], a[224:227], a[48:51], -4.0
    v_exp_f32 v28, v28
    v_mfma_f32_16x16x32_bf16 v[20:23], a[228:231], a[52:55], v[20:23]
    buffer_load_dwordx4 v0, s[20:23], s35 offen offset:0 lds
    v_mfma_f32_16x16x32_bf16 v[20:23], a[232:235], a[56:59], v[20:23]
    ds_read_b128 a[224:227], v60 offset:23776
    v_cvt_pk_bf16_f32 v120, v24, v25
    v_mfma_f32_16x16x32_bf16 v[20:23], a[236:239], a[60:63], v[20:23]
    v_exp_f32 v29, v29
    v_smfmac_f32_16x16x64_bf16 v[40:43], v[12:15], v[80:87], v57
    s_waitcnt lgkmcnt(7)
    v_cvt_pk_bf16_f32 v121, v26, v27
    v_mfma_f32_16x16x32_bf16 v[168:171], a[240:243], v[80:83], v[168:171]
    s_waitcnt lgkmcnt(5)
    ds_read_b128 a[228:231], v61 offset:24800
    v_cvt_pk_bf16_f32 v106, v28, v29
    v_mfma_f32_16x16x32_bf16 v[168:171], a[244:247], v[84:87], v[168:171]
    v_exp_f32 v30, v30
    v_mfma_f32_16x16x32_bf16 v[164:167], a[244:247], v[76:79], v[164:167]
    buffer_load_dwordx4 v0, s[20:23], s35 offen offset:1024 lds
    v_mfma_f32_16x16x32_bf16 v[164:167], a[240:243], v[72:75], v[164:167]
    ds_read_b128 a[232:235], v60 offset:25824
    v_mov_b32_dpp v208, v240 row_ror:8 row_mask:0xf bank_mask:0xc
    v_mfma_f32_16x16x32_bf16 v[172:175], a[240:243], v[88:91], v[172:175]
    v_exp_f32 v31, v31
    v_mfma_f32_16x16x32_bf16 v[172:175], a[244:247], v[92:95], v[172:175]
    s_waitcnt lgkmcnt(5)
    ds_read_b128 a[236:239], v61 offset:26848
    v_cvt_pk_bf16_f32 v107, v30, v31
    v_mfma_f32_16x16x32_bf16 v[188:191], a[252:255], v[92:95], v[188:191]
    s_waitcnt lgkmcnt(4)
    v_exp_f32 v16, v16
    v_mfma_f32_16x16x32_bf16 v[188:191], a[248:251], v[88:91], v[188:191]
    buffer_load_dwordx4 v0, s[28:31], s35 offen offset:2056 lds
    v_mfma_f32_16x16x32_bf16 v[180:183], a[248:251], v[72:75], v[180:183]
    v_exp_f32 v17, v17
    v_mfma_f32_16x16x32_bf16 v[180:183], a[252:255], v[76:79], v[180:183]
    v_exp_f32 v18, v18
    v_mfma_f32_16x16x32_bf16 v[184:187], a[252:255], v[84:87], v[184:187]
    v_exp_f32 v19, v19
    v_mfma_f32_16x16x32_bf16 v[184:187], a[248:251], v[80:83], v[184:187]
    s_waitcnt lgkmcnt(3)
    ds_read_b64_tr_b16 a[240:241], v1 offset:49880
    ds_read_b64_tr_b16 a[242:243], v1 offset:50392
    v_mfma_f32_16x16x32_bf16 v[24:27], a[224:227], a[16:19], -4.0
    s_waitcnt lgkmcnt(4)
    v_exp_f32 v20, v20
    v_mfma_f32_16x16x32_bf16 v[24:27], a[228:231], a[20:23], v[24:27]
    s_waitcnt lgkmcnt(3)
    buffer_load_dwordx4 v0, s[28:31], s35 offen offset:3080 lds
    v_mfma_f32_16x16x32_bf16 v[24:27], a[232:235], a[24:27], v[24:27]
    s_waitcnt lgkmcnt(2)
    v_cvt_pk_bf16_f32 v114, v16, v17
    v_cvt_pk_bf16_f32 v115, v18, v19
    v_mfma_f32_16x16x32_bf16 v[24:27], a[236:239], a[28:31], v[24:27]
    v_exp_f32 v21, v21
    v_mfma_f32_16x16x32_bf16 v[28:31], a[236:239], a[44:47], -4.0
    s_mov_b32 m0, s99
    ds_read_b64_tr_b16 a[244:245], v1 offset:50904
    ds_read_b64_tr_b16 a[246:247], v1 offset:51416
    v_mfma_f32_16x16x32_bf16 v[28:31], a[232:235], a[40:43], v[28:31]
    v_exp_f32 v22, v22
    v_mfma_f32_16x16x32_bf16 v[28:31], a[228:231], a[36:39], v[28:31]
    ds_read_b64_tr_b16 a[252:253], v1 offset:50912
    ds_read_b64_tr_b16 a[254:255], v1 offset:51424
    v_mfma_f32_16x16x32_bf16 v[28:31], a[224:227], a[32:35], v[28:31]
    v_exp_f32 v23, v23
    v_mfma_f32_16x16x32_bf16 v[16:19], a[224:227], a[48:51], -4.0
    ds_read_b64_tr_b16 a[248:249], v1 offset:49888
    ds_read_b64_tr_b16 a[250:251], v1 offset:50400
    v_mfma_f32_16x16x32_bf16 v[16:19], a[228:231], a[52:55], v[16:19]
    v_exp_f32 v24, v24
    v_mfma_f32_16x16x32_bf16 v[16:19], a[232:235], a[56:59], v[16:19]
    ds_read_b128 a[224:227], v60 offset:27872
    v_cvt_pk_bf16_f32 v122, v20, v21
    v_mfma_f32_16x16x32_bf16 v[16:19], a[236:239], a[60:63], v[16:19]
    v_exp_f32 v25, v25
    v_smfmac_f32_16x16x64_bf16 v[44:47], v[12:15], v[88:95], v57
    s_waitcnt lgkmcnt(7)
    v_cvt_pk_bf16_f32 v123, v22, v23
    v_mfma_f32_16x16x32_bf16 v[204:207], a[240:243], v[88:91], v[204:207]
    s_waitcnt lgkmcnt(5)
    ds_read_b128 a[228:231], v61 offset:28896
    v_cvt_pk_bf16_f32 v108, v24, v25
    v_mfma_f32_16x16x32_bf16 v[204:207], a[244:247], v[92:95], v[204:207]
    v_exp_f32 v26, v26
    v_mfma_f32_16x16x32_bf16 v[196:199], a[244:247], v[76:79], v[196:199]
    ds_read_b128 a[232:235], v60 offset:29920
    v_cndmask_b32_dpp v225, v209, v241, vcc row_ror:8 row_mask:0xf bank_mask:0xf
    v_mfma_f32_16x16x32_bf16 v[196:199], a[240:243], v[72:75], v[196:199]
    v_exp_f32 v27, v27
    v_mfma_f32_16x16x32_bf16 v[200:203], a[240:243], v[80:83], v[200:203]
    ds_read_b128 a[236:239], v61 offset:30944
    v_cvt_pk_bf16_f32 v109, v26, v27
    v_mfma_f32_16x16x32_bf16 v[200:203], a[244:247], v[84:87], v[200:203]
    s_waitcnt lgkmcnt(6)
    v_exp_f32 v28, v28
    v_mfma_f32_16x16x32_bf16 v[216:219], a[252:255], v[84:87], v[216:219]
    s_waitcnt lgkmcnt(4)
    ds_read_b64_tr_b16 a[240:241], v1 offset:49944
    ds_read_b64_tr_b16 a[242:243], v1 offset:50456
    v_mfma_f32_16x16x32_bf16 v[216:219], a[248:251], v[80:83], v[216:219]
    v_exp_f32 v29, v29
    v_mfma_f32_16x16x32_bf16 v[212:215], a[248:251], v[72:75], v[212:215]
    v_exp_f32 v30, v30
    v_mfma_f32_16x16x32_bf16 v[212:215], a[252:255], v[76:79], v[212:215]
    v_exp_f32 v31, v31
    v_mfma_f32_16x16x32_bf16 v[220:223], a[252:255], v[92:95], v[220:223]
    ds_read_b64_tr_b16 a[244:245], v1 offset:50968
    ds_read_b64_tr_b16 a[246:247], v1 offset:51480
    v_mfma_f32_16x16x32_bf16 v[220:223], a[248:251], v[88:91], v[220:223]
    s_waitcnt lgkmcnt(7)
    v_exp_f32 v16, v16
    v_mfma_f32_16x16x32_bf16 v[20:23], a[224:227], a[16:19], -4.0
    s_waitcnt lgkmcnt(6)
    v_cvt_pk_bf16_f32 v116, v28, v29
    v_cvt_pk_bf16_f32 v117, v30, v31
    v_mfma_f32_16x16x32_bf16 v[20:23], a[228:231], a[20:23], v[20:23]
    s_waitcnt lgkmcnt(5)
    v_exp_f32 v17, v17
    v_mfma_f32_16x16x32_bf16 v[20:23], a[232:235], a[24:27], v[20:23]
    s_waitcnt lgkmcnt(4)
    v_mov_b32_dpp v209, v241 row_ror:8 row_mask:0xf bank_mask:0xc
    v_cndmask_b32_dpp v226, v210, v242, vcc row_ror:8 row_mask:0xf bank_mask:0xf
    v_mfma_f32_16x16x32_bf16 v[20:23], a[236:239], a[28:31], v[20:23]
    v_exp_f32 v18, v18
    v_mfma_f32_16x16x32_bf16 v[24:27], a[236:239], a[44:47], -4.0
    v_mov_b32_dpp v210, v242 row_ror:8 row_mask:0xf bank_mask:0xc
    v_cndmask_b32_dpp v227, v211, v243, vcc row_ror:8 row_mask:0xf bank_mask:0xf
    v_mfma_f32_16x16x32_bf16 v[24:27], a[232:235], a[40:43], v[24:27]
    v_exp_f32 v19, v19
    v_mfma_f32_16x16x32_bf16 v[24:27], a[228:231], a[36:39], v[24:27]
    buffer_store_dwordx4 v[224:227], v2, s[24:27], s43 offen offset:2176 sc1
    v_mfma_f32_16x16x32_bf16 v[24:27], a[224:227], a[32:35], v[24:27]
    ds_read_b64_tr_b16 a[248:249], v1 offset:49952
    v_mov_b32_dpp v211, v243 row_ror:8 row_mask:0xf bank_mask:0xc
    v_mfma_f32_16x16x32_bf16 v[28:31], a[224:227], a[48:51], -4.0
    v_exp_f32 v20, v20
    v_mfma_f32_16x16x32_bf16 v[28:31], a[228:231], a[52:55], v[28:31]
    ds_read_b64_tr_b16 a[250:251], v1 offset:50464
    ds_read_b64_tr_b16 a[252:253], v1 offset:50976
    v_mfma_f32_16x16x32_bf16 v[28:31], a[232:235], a[56:59], v[28:31]
    buffer_store_dwordx4 v[208:211], v2, s[24:27], s43 offen offset:128 sc1
    ds_read_b64_tr_b16 a[254:255], v1 offset:51488
    v_mfma_f32_16x16x32_bf16 v[28:31], a[236:239], a[60:63], v[28:31]
    s_waitcnt lgkmcnt(6)
    v_cvt_pk_bf16_f32 v124, v16, v17
    v_cvt_pk_bf16_f32 v125, v18, v19
    v_mfma_f32_16x16x32_bf16 v[228:231], a[240:243], v[72:75], v[228:231]
    s_waitcnt lgkmcnt(4)
    v_exp_f32 v21, v21
    v_mfma_f32_16x16x32_bf16 v[228:231], a[244:247], v[76:79], v[228:231]
    s_add_u32 s43, s43, 4096
    ds_read_b128 a[68:71], v61 offset:32992
    v_cvt_pk_bf16_f32 v110, v20, v21
    v_mfma_f32_16x16x32_bf16 v[232:235], a[244:247], v[84:87], v[232:235]
    v_exp_f32 v22, v22
    v_mfma_f32_16x16x32_bf16 v[232:235], a[240:243], v[80:83], v[232:235]
    v_exp_f32 v23, v23
    v_mfma_f32_16x16x32_bf16 v[236:239], a[240:243], v[88:91], v[236:239]
    s_waitcnt vmcnt(6) lgkmcnt(1)
    ds_read_b128 a[72:75], v60 offset:34016
    v_cvt_pk_bf16_f32 v111, v22, v23
    v_mfma_f32_16x16x32_bf16 v[236:239], a[244:247], v[92:95], v[236:239]
    s_barrier
    v_exp_f32 v24, v24
    v_mfma_f32_16x16x32_bf16 v[252:255], a[252:255], v[92:95], v[252:255]
    buffer_load_dwordx4 v0, s[20:23], s37 offen offset:1024 lds
    v_mfma_f32_16x16x32_bf16 v[252:255], a[248:251], v[88:91], v[252:255]
    v_exp_f32 v25, v25
    v_mfma_f32_16x16x32_bf16 v[248:251], a[248:251], v[80:83], v[248:251]
    ds_read_b128 a[76:79], v61 offset:35040
    v_cvt_pk_bf16_f32 v118, v24, v25
    v_mfma_f32_16x16x32_bf16 v[248:251], a[252:255], v[84:87], v[248:251]
    v_exp_f32 v26, v26
    v_mfma_f32_16x16x32_bf16 v[244:247], a[252:255], v[76:79], v[244:247]
    ds_read_b64_tr_b16 a[240:241], v1 offset:33168
    ds_read_b64_tr_b16 a[242:243], v1 offset:33680
    v_mfma_f32_16x16x32_bf16 v[244:247], a[248:251], v[72:75], v[244:247]
    v_exp_f32 v27, v27
    v_mfma_f32_16x16x32_bf16 v[16:19], a[64:67], a[32:35], -4.0
    s_waitcnt lgkmcnt(4)
    buffer_load_dwordx4 v0, s[28:31], s37 offen offset:3080 lds
    v_mfma_f32_16x16x32_bf16 v[16:19], a[68:71], a[36:39], v[16:19]
    s_waitcnt lgkmcnt(3)
    ds_read_b64_tr_b16 a[244:245], v1 offset:34192
    ds_read_b64_tr_b16 a[246:247], v1 offset:34704
    v_mfma_f32_16x16x32_bf16 v[16:19], a[72:75], a[40:43], v[16:19]
    s_waitcnt lgkmcnt(4)
    v_exp_f32 v28, v28
    v_mfma_f32_16x16x32_bf16 v[16:19], a[76:79], a[44:47], v[16:19]
    ds_read_b64_tr_b16 a[252:253], v1 offset:34200
    ds_read_b64_tr_b16 a[254:255], v1 offset:34712
    v_mfma_f32_16x16x32_bf16 v[20:23], a[76:79], a[60:63], -4.0
    v_exp_f32 v29, v29
    v_mfma_f32_16x16x32_bf16 v[20:23], a[72:75], a[56:59], v[20:23]
    ds_read_b64_tr_b16 a[248:249], v1 offset:33176
    v_cvt_pk_bf16_f32 v119, v26, v27
    v_mfma_f32_16x16x32_bf16 v[20:23], a[68:71], a[52:55], v[20:23]
    v_exp_f32 v30, v30
    v_mfma_f32_16x16x32_bf16 v[20:23], a[64:67], a[48:51], v[20:23]
    ds_read_b64_tr_b16 a[250:251], v1 offset:33688
    v_cvt_pk_bf16_f32 v126, v28, v29
    v_smfmac_f32_16x16x64_bf16 v[36:39], v[12:15], v[104:111], v57
    s_waitcnt lgkmcnt(6)
    v_mfma_f32_16x16x32_bf16 v[132:135], a[240:243], v[104:107], v[132:135]
    s_waitcnt lgkmcnt(4)
    v_exp_f32 v31, v31
    v_mfma_f32_16x16x32_bf16 v[132:135], a[244:247], v[108:111], v[132:135]
    ds_read_b128 a[80:83], v60 offset:36064
    v_cvt_pk_bf16_f32 v127, v30, v31
    v_mfma_f32_16x16x32_bf16 v[136:139], a[244:247], v[116:119], v[136:139]
    v_exp_f32 v16, v16
    v_mfma_f32_16x16x32_bf16 v[136:139], a[240:243], v[112:115], v[136:139]
    v_exp_f32 v17, v17
    v_mfma_f32_16x16x32_bf16 v[140:143], a[240:243], v[120:123], v[140:143]
    ds_read_b128 a[84:87], v61 offset:37088
    v_cvt_pk_bf16_f32 v80, v16, v17
    v_mfma_f32_16x16x32_bf16 v[140:143], a[244:247], v[124:127], v[140:143]
    s_waitcnt lgkmcnt(4)
    v_exp_f32 v18, v18
    v_mfma_f32_16x16x32_bf16 v[156:159], a[252:255], v[124:127], v[156:159]
    s_waitcnt lgkmcnt(2)
    ds_read_b128 a[88:91], v60 offset:38112
    v_add_f32 v36, v36, v37
    v_mfma_f32_16x16x32_bf16 v[156:159], a[248:251], v[120:123], v[156:159]
    v_exp_f32 v19, v19
    v_mfma_f32_16x16x32_bf16 v[152:155], a[248:251], v[112:115], v[152:155]
    ds_read_b128 a[92:95], v61 offset:39136
    v_cvt_pk_bf16_f32 v81, v18, v19
    v_mfma_f32_16x16x32_bf16 v[152:155], a[252:255], v[116:119], v[152:155]
    ds_read_b64_tr_b16 a[0:1], v1 offset:33232
    ds_read_b64_tr_b16 a[2:3], v1 offset:33744
    v_mfma_f32_16x16x32_bf16 v[148:151], a[252:255], v[108:111], v[148:151]
    ds_read_b64_tr_b16 a[4:5], v1 offset:34256
    ds_read_b64_tr_b16 a[6:7], v1 offset:34768
    v_mfma_f32_16x16x32_bf16 v[148:151], a[248:251], v[104:107], v[148:151]
    s_waitcnt lgkmcnt(7)
    ds_read_b64_tr_b16 a[12:13], v1 offset:34264
    ds_read_b64_tr_b16 a[14:15], v1 offset:34776
    v_mfma_f32_16x16x32_bf16 v[24:27], a[80:83], a[32:35], -4.0
    s_waitcnt lgkmcnt(8)
    ds_read_b64_tr_b16 a[8:9], v1 offset:33240
    ds_read_b64_tr_b16 a[10:11], v1 offset:33752
    v_mfma_f32_16x16x32_bf16 v[24:27], a[84:87], a[36:39], v[24:27]
    s_waitcnt lgkmcnt(9)
    v_exp_f32 v20, v20
    v_mfma_f32_16x16x32_bf16 v[24:27], a[88:91], a[40:43], v[24:27]
    s_waitcnt lgkmcnt(8)
    ds_read_b128 a[96:99], v60 offset:40160
    v_exp_f32 v21, v21
    v_mfma_f32_16x16x32_bf16 v[24:27], a[92:95], a[44:47], v[24:27]
    ds_read_b128 a[100:103], v61 offset:41184
    v_cvt_pk_bf16_f32 v88, v20, v21
    v_mfma_f32_16x16x32_bf16 v[28:31], a[92:95], a[60:63], -4.0
    v_exp_f32 v22, v22
    v_mfma_f32_16x16x32_bf16 v[28:31], a[88:91], a[56:59], v[28:31]
    v_exp_f32 v23, v23
    v_mfma_f32_16x16x32_bf16 v[28:31], a[84:87], a[52:55], v[28:31]
    ds_read_b128 a[104:107], v60 offset:42208
    v_cvt_pk_bf16_f32 v89, v22, v23
    v_mfma_f32_16x16x32_bf16 v[28:31], a[80:83], a[48:51], v[28:31]
    v_exp_f32 v24, v24
    v_smfmac_f32_16x16x64_bf16 v[40:43], v[12:15], v[112:119], v57
    s_waitcnt lgkmcnt(9)
    ds_read_b64_tr_b16 a[240:241], v1 offset:33296
    v_mfma_f32_16x16x32_bf16 v[168:171], a[0:3], v[112:115], v[168:171]
    s_waitcnt lgkmcnt(8)
    ds_read_b128 a[108:111], v61 offset:43232
    v_exp_f32 v25, v25
    v_mfma_f32_16x16x32_bf16 v[168:171], a[4:7], v[116:119], v[168:171]
    ds_read_b64_tr_b16 a[242:243], v1 offset:33808
    ds_read_b64_tr_b16 a[244:245], v1 offset:34320
    v_mfma_f32_16x16x32_bf16 v[164:167], a[4:7], v[108:111], v[164:167]
    ds_read_b64_tr_b16 a[246:247], v1 offset:34832
    ds_read_b64_tr_b16 a[252:253], v1 offset:34328
    v_mfma_f32_16x16x32_bf16 v[164:167], a[0:3], v[104:107], v[164:167]
    ds_read_b64_tr_b16 a[254:255], v1 offset:34840
    ds_read_b64_tr_b16 a[248:249], v1 offset:33304
    v_mfma_f32_16x16x32_bf16 v[172:175], a[0:3], v[120:123], v[172:175]
    ds_read_b64_tr_b16 a[250:251], v1 offset:33816
    v_exp_f32 v26, v26
    v_mfma_f32_16x16x32_bf16 v[172:175], a[4:7], v[124:127], v[172:175]
    s_waitcnt lgkmcnt(14)
    ds_read_b128 a[112:115], v60 offset:44256
    v_cvt_pk_bf16_f32 v82, v24, v25
    v_mfma_f32_16x16x32_bf16 v[188:191], a[12:15], v[124:127], v[188:191]
    s_waitcnt lgkmcnt(13)
    v_exp_f32 v27, v27
    v_mfma_f32_16x16x32_bf16 v[188:191], a[8:11], v[120:123], v[188:191]
    ds_read_b128 a[116:119], v61 offset:45280
    v_exp_f32 v28, v28
    v_mfma_f32_16x16x32_bf16 v[180:183], a[8:11], v[104:107], v[180:183]
    ds_read_b128 a[120:123], v60 offset:46304
    v_cvt_pk_bf16_f32 v83, v26, v27
    v_mfma_f32_16x16x32_bf16 v[180:183], a[12:15], v[108:111], v[180:183]
    v_exp_f32 v29, v29
    v_mfma_f32_16x16x32_bf16 v[184:187], a[12:15], v[116:119], v[184:187]
    ds_read_b128 a[124:127], v61 offset:47328
    v_exp_f32 v30, v30
    v_mfma_f32_16x16x32_bf16 v[184:187], a[8:11], v[112:115], v[184:187]
    s_waitcnt lgkmcnt(14)
    ds_read_b64_tr_b16 a[0:1], v1 offset:33360
    ds_read_b64_tr_b16 a[2:3], v1 offset:33872
    v_mfma_f32_16x16x32_bf16 v[16:19], a[96:99], a[32:35], -4.0
    s_waitcnt lgkmcnt(14)
    v_exp_f32 v31, v31
    v_mfma_f32_16x16x32_bf16 v[16:19], a[100:103], a[36:39], v[16:19]
    s_waitcnt lgkmcnt(14)
    ds_read_b64_tr_b16 a[4:5], v1 offset:34384
    ds_read_b64_tr_b16 a[6:7], v1 offset:34896
    v_cvt_pk_bf16_f32 v90, v28, v29
    v_mfma_f32_16x16x32_bf16 v[16:19], a[104:107], a[40:43], v[16:19]
    s_waitcnt lgkmcnt(14)
    ds_read_b64_tr_b16 a[12:13], v1 offset:34392
    v_cvt_pk_bf16_f32 v91, v30, v31
    v_mfma_f32_16x16x32_bf16 v[16:19], a[108:111], a[44:47], v[16:19]
    ds_read_b64_tr_b16 a[14:15], v1 offset:34904
    ds_read_b64_tr_b16 a[8:9], v1 offset:33368
    v_mfma_f32_16x16x32_bf16 v[20:23], a[108:111], a[60:63], -4.0
    ds_read_b64_tr_b16 a[10:11], v1 offset:33880
    v_rcp_f32 v50, v36
    v_mfma_f32_16x16x32_bf16 v[20:23], a[104:107], a[56:59], v[20:23]
    ds_read_b128 a[64:67], v60 offset:48352
    v_mul_f32 v132, v132, v50
    v_mfma_f32_16x16x32_bf16 v[20:23], a[100:103], a[52:55], v[20:23]
    ds_read_b128 a[68:71], v61 offset:49376
    v_mul_f32 v133, v133, v50
    v_mfma_f32_16x16x32_bf16 v[20:23], a[96:99], a[48:51], v[20:23]
    ds_read_b128 a[72:75], v60 offset:50400
    v_exp_f32 v16, v16
    v_smfmac_f32_16x16x64_bf16 v[44:47], v[12:15], v[120:127], v57
    s_waitcnt lgkmcnt(14)
    v_mul_f32 v134, v134, v50
    v_mfma_f32_16x16x32_bf16 v[204:207], a[240:243], v[120:123], v[204:207]
    s_waitcnt lgkmcnt(14)
    ds_read_b128 a[76:79], v61 offset:51424
    v_mul_f32 v135, v135, v50
    v_mfma_f32_16x16x32_bf16 v[204:207], a[244:247], v[124:127], v[204:207]
    ds_read_b128 a[80:83], v60 offset:52448
    v_exp_f32 v17, v17
    v_mfma_f32_16x16x32_bf16 v[196:199], a[244:247], v[108:111], v[196:199]
    v_exp_f32 v18, v18
    v_mfma_f32_16x16x32_bf16 v[196:199], a[240:243], v[104:107], v[196:199]
    v_exp_f32 v19, v19
    v_cvt_pk_bf16_f32 v84, v16, v17
    v_mfma_f32_16x16x32_bf16 v[200:203], a[240:243], v[112:115], v[200:203]
    ds_read_b64_tr_b16 a[240:241], v1 offset:0
    v_cvt_pk_bf16_f32 v85, v18, v19
    v_mfma_f32_16x16x32_bf16 v[200:203], a[244:247], v[116:119], v[200:203]
    s_waitcnt lgkmcnt(14)
    v_exp_f32 v20, v20
    v_mfma_f32_16x16x32_bf16 v[216:219], a[252:255], v[116:119], v[216:219]
    s_waitcnt lgkmcnt(14)
    ds_read_b64_tr_b16 a[242:243], v1 offset:512
    v_exp_f32 v21, v21
    v_mfma_f32_16x16x32_bf16 v[216:219], a[248:251], v[112:115], v[216:219]
    v_exp_f32 v22, v22
    v_mfma_f32_16x16x32_bf16 v[212:215], a[248:251], v[104:107], v[212:215]
    v_exp_f32 v23, v23
    v_mfma_f32_16x16x32_bf16 v[212:215], a[252:255], v[108:111], v[212:215]
    ds_read_b64_tr_b16 a[244:245], v1 offset:1024
    v_cvt_pk_bf16_f32 v92, v20, v21
    v_cvt_pk_bf16_f32 v93, v22, v23
    v_mfma_f32_16x16x32_bf16 v[220:223], a[252:255], v[124:127], v[220:223]
    ds_read_b64_tr_b16 a[246:247], v1 offset:1536
    ds_read_b64_tr_b16 a[252:253], v1 offset:1032
    v_mfma_f32_16x16x32_bf16 v[220:223], a[248:251], v[120:123], v[220:223]
    s_waitcnt lgkmcnt(14)
    ds_read_b64_tr_b16 a[248:249], v1 offset:8
    ds_read_b64_tr_b16 a[250:251], v1 offset:520
    v_mfma_f32_16x16x32_bf16 v[24:27], a[112:115], a[32:35], -4.0
    s_waitcnt lgkmcnt(14)
    ds_read_b64_tr_b16 a[254:255], v1 offset:1544
    v_mul_f32 v148, v148, v50
    v_mul_f32 v149, v149, v50
    v_mfma_f32_16x16x32_bf16 v[24:27], a[116:119], a[36:39], v[24:27]
    s_waitcnt lgkmcnt(14)
    ds_read_b128 a[84:87], v61 offset:53472
    v_mul_f32 v150, v150, v50
    v_mfma_f32_16x16x32_bf16 v[24:27], a[120:123], a[40:43], v[24:27]
    s_waitcnt lgkmcnt(14)
    ds_read_b128 a[88:91], v60 offset:54496
    v_mul_f32 v151, v151, v50
    v_mfma_f32_16x16x32_bf16 v[24:27], a[124:127], a[44:47], v[24:27]
    ds_read_b128 a[92:95], v61 offset:55520
    v_cvt_pk_bf16_f32 v151, v150, v151
    v_cvt_pk_bf16_f32 v150, v148, v149
    v_mfma_f32_16x16x32_bf16 v[28:31], a[124:127], a[60:63], -4.0
    v_cvt_pk_bf16_f32 v148, v132, v133
    v_cvt_pk_bf16_f32 v149, v134, v135
    v_mfma_f32_16x16x32_bf16 v[28:31], a[120:123], a[56:59], v[28:31]
    v_mul_f32 v164, v164, v50
    v_mul_f32 v165, v165, v50
    v_mfma_f32_16x16x32_bf16 v[28:31], a[116:119], a[52:55], v[28:31]
    v_mul_f32 v166, v166, v50
    v_mul_f32 v167, v167, v50
    v_mul_f32 v180, v180, v50
    v_mfma_f32_16x16x32_bf16 v[28:31], a[112:115], a[48:51], v[28:31]
    s_waitcnt lgkmcnt(14)
    v_exp_f32 v24, v24
    v_mfma_f32_16x16x32_bf16 v[228:231], a[0:3], v[104:107], v[228:231]
    s_waitcnt lgkmcnt(14)
    v_exp_f32 v25, v25
    v_mfma_f32_16x16x32_bf16 v[228:231], a[4:7], v[108:111], v[228:231]
    v_exp_f32 v26, v26
    v_cvt_pk_bf16_f32 v86, v24, v25
    v_mfma_f32_16x16x32_bf16 v[232:235], a[4:7], v[116:119], v[232:235]
    v_exp_f32 v27, v27
    v_mfma_f32_16x16x32_bf16 v[232:235], a[0:3], v[112:115], v[232:235]
    v_cvt_pk_bf16_f32 v87, v26, v27
    v_mul_f32 v181, v181, v50
    v_mfma_f32_16x16x32_bf16 v[236:239], a[0:3], v[120:123], v[236:239]
    ds_read_b64_tr_b16 a[0:1], v1 offset:64
    v_exp_f32 v28, v28
    v_mfma_f32_16x16x32_bf16 v[236:239], a[4:7], v[124:127], v[236:239]
    s_waitcnt lgkmcnt(14)
    v_exp_f32 v29, v29
    v_mfma_f32_16x16x32_bf16 v[252:255], a[12:15], v[124:127], v[252:255]
    s_waitcnt lgkmcnt(14)
    v_exp_f32 v30, v30
    v_mfma_f32_16x16x32_bf16 v[252:255], a[8:11], v[120:123], v[252:255]
    v_exp_f32 v31, v31
    v_cvt_pk_bf16_f32 v94, v28, v29
    v_mfma_f32_16x16x32_bf16 v[248:251], a[8:11], v[112:115], v[248:251]
    ds_read_b64_tr_b16 a[2:3], v1 offset:576
    v_cvt_pk_bf16_f32 v95, v30, v31
    v_mfma_f32_16x16x32_bf16 v[248:251], a[12:15], v[116:119], v[248:251]
    ds_read_b64_tr_b16 a[4:5], v1 offset:1088
    ds_read_b64_tr_b16 a[6:7], v1 offset:1600
    v_mfma_f32_16x16x32_bf16 v[244:247], a[12:15], v[108:111], v[244:247]
    v_mul_f32 v182, v182, v50
    v_mul_f32 v183, v183, v50
    v_cvt_pk_bf16_f32 v183, v182, v183
    v_mfma_f32_16x16x32_bf16 v[244:247], a[8:11], v[104:107], v[244:247]
    s_waitcnt lgkmcnt(14)
    v_cvt_pk_bf16_f32 v182, v180, v181
    v_cvt_pk_bf16_f32 v180, v164, v165
    v_mfma_f32_16x16x32_bf16 v[16:19], a[64:67], a[32:35], -4.0
    s_waitcnt lgkmcnt(14)
    v_cvt_pk_bf16_f32 v181, v166, v167
    v_cndmask_b32_dpp v167, v151, v183, vcc row_ror:8 row_mask:0xf bank_mask:0xf
    v_mov_b32_dpp v151, v183 row_ror:8 row_mask:0xf bank_mask:0xc
    v_mfma_f32_16x16x32_bf16 v[16:19], a[68:71], a[36:39], v[16:19]
    s_waitcnt lgkmcnt(14)
    v_cndmask_b32_dpp v164, v148, v180, vcc row_ror:8 row_mask:0xf bank_mask:0xf
    v_mov_b32_dpp v148, v180 row_ror:8 row_mask:0xf bank_mask:0xc
    v_mfma_f32_16x16x32_bf16 v[16:19], a[72:75], a[40:43], v[16:19]
    s_waitcnt lgkmcnt(14)
    v_cndmask_b32_dpp v165, v149, v181, vcc row_ror:8 row_mask:0xf bank_mask:0xf
    v_mov_b32_dpp v149, v181 row_ror:8 row_mask:0xf bank_mask:0xc
    v_mfma_f32_16x16x32_bf16 v[16:19], a[76:79], a[44:47], v[16:19]
    ds_read_b64_tr_b16 a[8:9], v1 offset:72
    v_cndmask_b32_dpp v166, v150, v182, vcc row_ror:8 row_mask:0xf bank_mask:0xf
    v_mov_b32_dpp v150, v182 row_ror:8 row_mask:0xf bank_mask:0xc
    v_mfma_f32_16x16x32_bf16 v[20:23], a[76:79], a[60:63], -4.0
    buffer_store_dwordx4 v[148:151], v2, s[24:27], s43 offen offset:0 sc1
    v_mfma_f32_16x16x32_bf16 v[20:23], a[72:75], a[56:59], v[20:23]
    ds_read_b64_tr_b16 a[10:11], v1 offset:584
    ds_read_b64_tr_b16 a[12:13], v1 offset:1096
    v_mfma_f32_16x16x32_bf16 v[20:23], a[68:71], a[52:55], v[20:23]
    ds_read_b64_tr_b16 a[14:15], v1 offset:1608
    ds_read_b64_tr_b16 a[16:17], v1 offset:128
    v_mul_f32 v196, v196, v50
    v_mfma_f32_16x16x32_bf16 v[20:23], a[64:67], a[48:51], v[20:23]
    ds_read_b128 a[96:99], v60 offset:56544
    v_mul_f32 v197, v197, v50
    v_smfmac_f32_16x16x64_bf16 v[40:43], v[12:15], v[80:87], v57
    s_waitcnt lgkmcnt(14)
    ds_read_b64_tr_b16 a[18:19], v1 offset:640
    v_mfma_f32_16x16x32_bf16 v[136:139], a[240:243], v[80:83], v[136:139]
    s_waitcnt lgkmcnt(14)
    ds_read_b128 a[100:103], v61 offset:57568
    v_exp_f32 v16, v16
    v_mfma_f32_16x16x32_bf16 v[136:139], a[244:247], v[84:87], v[136:139]
    ds_read_b128 a[104:107], v60 offset:58592
    v_mul_f32 v198, v198, v50
    v_mfma_f32_16x16x32_bf16 v[140:143], a[244:247], v[92:95], v[140:143]
    ds_read_b128 a[108:111], v61 offset:59616
    v_mul_f32 v199, v199, v50
    v_mfma_f32_16x16x32_bf16 v[140:143], a[240:243], v[88:91], v[140:143]
    s_waitcnt lgkmcnt(14)
    ds_read_b64_tr_b16 a[20:21], v1 offset:1152
    v_exp_f32 v17, v17
    v_mfma_f32_16x16x32_bf16 v[156:159], a[248:251], v[88:91], v[156:159]
    s_waitcnt lgkmcnt(14)
    v_exp_f32 v18, v18
    v_mfma_f32_16x16x32_bf16 v[156:159], a[252:255], v[92:95], v[156:159]
    v_exp_f32 v19, v19
    v_mfma_f32_16x16x32_bf16 v[152:155], a[252:255], v[84:87], v[152:155]
    ds_read_b64_tr_b16 a[22:23], v1 offset:1664
    v_cvt_pk_bf16_f32 v112, v16, v17
    v_cvt_pk_bf16_f32 v113, v18, v19
    v_mfma_f32_16x16x32_bf16 v[152:155], a[248:251], v[80:83], v[152:155]
    v_exp_f32 v20, v20
    v_mfma_f32_16x16x32_bf16 v[24:27], a[80:83], a[32:35], -4.0
    s_waitcnt lgkmcnt(14)
    ds_read_b64_tr_b16 a[24:25], v1 offset:136
    v_exp_f32 v21, v21
    v_mfma_f32_16x16x32_bf16 v[24:27], a[84:87], a[36:39], v[24:27]
    s_waitcnt lgkmcnt(14)
    buffer_store_dwordx4 v[164:167], v2, s[24:27], s43 offen offset:2048 sc1
    v_mfma_f32_16x16x32_bf16 v[24:27], a[88:91], a[40:43], v[24:27]
    s_waitcnt lgkmcnt(14)
    v_exp_f32 v22, v22
    v_mfma_f32_16x16x32_bf16 v[24:27], a[92:95], a[44:47], v[24:27]
    v_exp_f32 v23, v23
    v_cvt_pk_bf16_f32 v120, v20, v21
    v_mfma_f32_16x16x32_bf16 v[28:31], a[92:95], a[60:63], -4.0
    ds_read_b64_tr_b16 a[26:27], v1 offset:648
    v_cvt_pk_bf16_f32 v121, v22, v23
    v_mfma_f32_16x16x32_bf16 v[28:31], a[88:91], a[56:59], v[28:31]
    ds_read_b64_tr_b16 a[28:29], v1 offset:1160
    ds_read_b64_tr_b16 a[30:31], v1 offset:1672
    v_mfma_f32_16x16x32_bf16 v[28:31], a[84:87], a[52:55], v[28:31]
    ds_read_b128 a[112:115], v60 offset:60640
    v_mul_f32 v212, v212, v50
    v_mul_f32 v213, v213, v50
    v_mfma_f32_16x16x32_bf16 v[28:31], a[80:83], a[48:51], v[28:31]
    s_waitcnt lgkmcnt(14)
    ds_read_b128 a[116:119], v61 offset:61664
    v_mul_f32 v214, v214, v50
    v_mfma_f32_16x16x32_bf16 v[168:171], a[0:3], v[80:83], v[168:171]
    s_waitcnt lgkmcnt(14)
    ds_read_b128 a[120:123], v60 offset:62688
    v_mul_f32 v215, v215, v50
    v_mfma_f32_16x16x32_bf16 v[168:171], a[4:7], v[84:87], v[168:171]
    ds_read_b128 a[124:127], v61 offset:63712
    v_exp_f32 v24, v24
    v_mfma_f32_16x16x32_bf16 v[172:175], a[4:7], v[92:95], v[172:175]
    v_exp_f32 v25, v25
    v_mfma_f32_16x16x32_bf16 v[172:175], a[0:3], v[88:91], v[172:175]
    s_waitcnt lgkmcnt(14)
    v_exp_f32 v26, v26
    v_cvt_pk_bf16_f32 v114, v24, v25
    v_mfma_f32_16x16x32_bf16 v[188:191], a[8:11], v[88:91], v[188:191]
    s_waitcnt lgkmcnt(14)
    v_exp_f32 v27, v27
    v_mfma_f32_16x16x32_bf16 v[188:191], a[12:15], v[92:95], v[188:191]
    ds_read_b64_tr_b16 a[224:225], v1 offset:192
    ds_read_b64_tr_b16 a[226:227], v1 offset:704
    v_cvt_pk_bf16_f32 v115, v26, v27
    v_mfma_f32_16x16x32_bf16 v[184:187], a[12:15], v[84:87], v[184:187]
    v_exp_f32 v28, v28
    v_mfma_f32_16x16x32_bf16 v[184:187], a[8:11], v[80:83], v[184:187]
    s_waitcnt lgkmcnt(14)
    ds_read_b64_tr_b16 a[228:229], v1 offset:1216
    v_exp_f32 v29, v29
    v_mfma_f32_16x16x32_bf16 v[16:19], a[96:99], a[32:35], -4.0
    s_waitcnt lgkmcnt(14)
    v_exp_f32 v30, v30
    v_mfma_f32_16x16x32_bf16 v[16:19], a[100:103], a[36:39], v[16:19]
L_hop10:
    s_cbranch_execz L_hback
    s_waitcnt lgkmcnt(14)
    ds_read_b64_tr_b16 a[230:231], v1 offset:1728
    v_exp_f32 v31, v31
    v_mfma_f32_16x16x32_bf16 v[16:19], a[104:107], a[40:43], v[16:19]
    s_waitcnt vmcnt(2) lgkmcnt(14)
    v_cvt_pk_bf16_f32 v215, v214, v215
    v_cvt_pk_bf16_f32 v214, v212, v213
    v_mfma_f32_16x16x32_bf16 v[16:19], a[108:111], a[44:47], v[16:19]
    s_barrier
    v_cvt_pk_bf16_f32 v212, v196, v197
    v_cvt_pk_bf16_f32 v213, v198, v199
    v_mul_f32 v228, v228, v50
    v_mfma_f32_16x16x32_bf16 v[20:23], a[108:111], a[60:63], -4.0
    v_mul_f32 v229, v229, v50
    v_mul_f32 v230, v230, v50
    v_mfma_f32_16x16x32_bf16 v[20:23], a[104:107], a[56:59], v[20:23]
    v_mul_f32 v231, v231, v50
    v_mul_f32 v244, v244, v50
    v_mul_f32 v245, v245, v50
    v_mfma_f32_16x16x32_bf16 v[20:23], a[100:103], a[52:55], v[20:23]
    v_mul_f32 v246, v246, v50
    v_mul_f32 v247, v247, v50
    v_mfma_f32_16x16x32_bf16 v[20:23], a[96:99], a[48:51], v[20:23]
    v_cvt_pk_bf16_f32 v247, v246, v247
    v_cvt_pk_bf16_f32 v246, v244, v245
    v_cvt_pk_bf16_f32 v244, v228, v229
    v_smfmac_f32_16x16x64_bf16 v[44:47], v[12:15], v[88:95], v57
    v_cvt_pk_bf16_f32 v245, v230, v231
    v_mfma_f32_16x16x32_bf16 v[204:207], a[16:19], v[88:91], v[204:207]
    s_waitcnt lgkmcnt(12)
    v_cvt_pk_bf16_f32 v122, v28, v29
    v_cvt_pk_bf16_f32 v123, v30, v31
    v_mfma_f32_16x16x32_bf16 v[204:207], a[20:23], v[92:95], v[204:207]
    v_cndmask_b32_dpp v228, v212, v244, vcc row_ror:8 row_mask:0xf bank_mask:0xf
    v_mov_b32_dpp v212, v244 row_ror:8 row_mask:0xf bank_mask:0xc
    v_cndmask_b32_dpp v229, v213, v245, vcc row_ror:8 row_mask:0xf bank_mask:0xf
    v_mfma_f32_16x16x32_bf16 v[200:203], a[20:23], v[84:87], v[200:203]
    v_mov_b32_dpp v213, v245 row_ror:8 row_mask:0xf bank_mask:0xc
    v_cndmask_b32_dpp v230, v214, v246, vcc row_ror:8 row_mask:0xf bank_mask:0xf
    v_mov_b32_dpp v214, v246 row_ror:8 row_mask:0xf bank_mask:0xc
    v_mfma_f32_16x16x32_bf16 v[200:203], a[16:19], v[80:83], v[200:203]
    s_waitcnt lgkmcnt(10)
    ds_read_b64_tr_b16 a[232:233], v1 offset:200
    v_cndmask_b32_dpp v231, v215, v247, vcc row_ror:8 row_mask:0xf bank_mask:0xf
    v_mov_b32_dpp v215, v247 row_ror:8 row_mask:0xf bank_mask:0xc
    v_mfma_f32_16x16x32_bf16 v[216:219], a[24:27], v[80:83], v[216:219]
    s_waitcnt lgkmcnt(9)
    buffer_store_dwordx4 v[212:215], v2, s[24:27], s43 offen offset:128 sc1
    v_mfma_f32_16x16x32_bf16 v[216:219], a[28:31], v[84:87], v[216:219]
    ds_read_b64_tr_b16 a[234:235], v1 offset:712
    ds_read_b64_tr_b16 a[236:237], v1 offset:1224
    v_max3_u32 v58, v58, v36, v50
    v_mfma_f32_16x16x32_bf16 v[220:223], a[28:31], v[92:95], v[220:223]
    ds_read_b64_tr_b16 a[238:239], v1 offset:1736
    v_exp_f32 v16, v16
    v_mfma_f32_16x16x32_bf16 v[220:223], a[24:27], v[88:91], v[220:223]
    s_waitcnt lgkmcnt(11)
    ds_read_b128 a[64:67], v62 offset:0
    v_exp_f32 v17, v17
    v_mfma_f32_16x16x32_bf16 v[24:27], a[112:115], a[32:35], -4.0
    s_waitcnt lgkmcnt(11)
    ds_read_b128 a[68:71], v63 offset:1024
    v_cvt_pk_bf16_f32 v116, v16, v17
    v_mfma_f32_16x16x32_bf16 v[24:27], a[116:119], a[36:39], v[24:27]
    s_waitcnt lgkmcnt(11)
    ds_read_b128 a[72:75], v62 offset:2048
    v_exp_f32 v18, v18
    v_mfma_f32_16x16x32_bf16 v[24:27], a[120:123], a[40:43], v[24:27]
    s_waitcnt lgkmcnt(11)
    ds_read_b128 a[76:79], v63 offset:3072
    v_exp_f32 v19, v19
    v_mfma_f32_16x16x32_bf16 v[24:27], a[124:127], a[44:47], v[24:27]
    ds_read_b64_tr_b16 a[240:241], v1 offset:16584
    ds_read_b64_tr_b16 a[242:243], v1 offset:17096
    v_cvt_pk_bf16_f32 v117, v18, v19
    v_mfma_f32_16x16x32_bf16 v[28:31], a[124:127], a[60:63], -4.0
    ds_read_b64_tr_b16 a[244:245], v1 offset:17608
    ds_read_b64_tr_b16 a[246:247], v1 offset:18120
    v_mfma_f32_16x16x32_bf16 v[28:31], a[120:123], a[56:59], v[28:31]
    ds_read_b64_tr_b16 a[248:249], v1 offset:16592
    v_exp_f32 v20, v20
    v_mfma_f32_16x16x32_bf16 v[28:31], a[116:119], a[52:55], v[28:31]
    ds_read_b64_tr_b16 a[250:251], v1 offset:17104
    v_exp_f32 v21, v21
    v_mfma_f32_16x16x32_bf16 v[28:31], a[112:115], a[48:51], v[28:31]
    s_waitcnt lgkmcnt(14)
    ds_read_b64_tr_b16 a[252:253], v1 offset:17616
    v_exp_f32 v24, v24
    v_mfma_f32_16x16x32_bf16 v[232:235], a[224:227], v[80:83], v[232:235]
    s_waitcnt lgkmcnt(14)
    v_exp_f32 v25, v25
    v_mfma_f32_16x16x32_bf16 v[232:235], a[228:231], v[84:87], v[232:235]
    buffer_store_dwordx4 v[228:231], v2, s[24:27], s43 offen offset:2176 sc1
    v_cvt_pk_bf16_f32 v118, v24, v25
    v_mfma_f32_16x16x32_bf16 v[236:239], a[228:231], v[92:95], v[236:239]
    s_add_u32 s43, s43, 4096
    ds_read_b64_tr_b16 a[254:255], v1 offset:18128
    v_exp_f32 v26, v26
    v_mfma_f32_16x16x32_bf16 v[236:239], a[224:227], v[88:91], v[236:239]
    s_waitcnt lgkmcnt(14)
    v_exp_f32 v27, v27
    v_cvt_pk_bf16_f32 v124, v20, v21
    v_mfma_f32_16x16x32_bf16 v[252:255], a[232:235], v[88:91], v[252:255]
    s_waitcnt lgkmcnt(12)
    ds_read_b128 a[80:83], v62 offset:4096
    v_cvt_pk_bf16_f32 v119, v26, v27
    v_mfma_f32_16x16x32_bf16 v[252:255], a[236:239], v[92:95], v[252:255]
    ds_read_b128 a[84:87], v63 offset:5120
    v_exp_f32 v22, v22
    v_mfma_f32_16x16x32_bf16 v[248:251], a[236:239], v[84:87], v[248:251]
    ds_read_b128 a[88:91], v62 offset:6144
    v_exp_f32 v23, v23
    v_mfma_f32_16x16x32_bf16 v[248:251], a[232:235], v[80:83], v[248:251]
    s_waitcnt lgkmcnt(14)
    v_exp_f32 v28, v28
    v_cvt_pk_bf16_f32 v125, v22, v23
    v_mfma_f32_16x16x32_bf16 v[16:19], a[64:67], a[48:51], -4.0
    s_waitcnt lgkmcnt(13)
    v_exp_f32 v29, v29
    v_mfma_f32_16x16x32_bf16 v[16:19], a[68:71], a[52:55], v[16:19]
    s_waitcnt lgkmcnt(12)
    v_exp_f32 v30, v30
    v_cvt_pk_bf16_f32 v126, v28, v29
    v_mfma_f32_16x16x32_bf16 v[16:19], a[72:75], a[56:59], v[16:19]
    s_waitcnt lgkmcnt(11)
    ds_read_b128 a[92:95], v63 offset:7168
    v_exp_f32 v31, v31
    v_mfma_f32_16x16x32_bf16 v[16:19], a[76:79], a[60:63], v[16:19]
    ds_read_b64_tr_b16 a[0:1], v1 offset:16648
    v_cvt_pk_bf16_f32 v127, v30, v31
    v_smfmac_f32_16x16x64_bf16 v[40:43], v[12:15], v[112:119], v57
    s_waitcnt lgkmcnt(11)
    ds_read_b64_tr_b16 a[2:3], v1 offset:17160
    ds_read_b64_tr_b16 a[4:5], v1 offset:17672
    v_mfma_f32_16x16x32_bf16 v[136:139], a[240:243], v[112:115], v[136:139]
    s_waitcnt lgkmcnt(11)
    ds_read_b64_tr_b16 a[6:7], v1 offset:18184
    ds_read_b64_tr_b16 a[8:9], v1 offset:16656
    v_mfma_f32_16x16x32_bf16 v[136:139], a[244:247], v[116:119], v[136:139]
    ds_read_b64_tr_b16 a[10:11], v1 offset:17168
    ds_read_b64_tr_b16 a[12:13], v1 offset:17680
    ds_read_b64_tr_b16 a[14:15], v1 offset:18192
    v_mfma_f32_16x16x32_bf16 v[140:143], a[244:247], v[124:127], v[140:143]
    ds_read_b128 a[96:99], v62 offset:8192
    v_exp_f32 v16, v16
    v_mfma_f32_16x16x32_bf16 v[140:143], a[240:243], v[120:123], v[140:143]
    s_waitcnt lgkmcnt(14)
    ds_read_b128 a[100:103], v63 offset:9216
    v_exp_f32 v17, v17
    v_mfma_f32_16x16x32_bf16 v[156:159], a[248:251], v[120:123], v[156:159]
    s_waitcnt lgkmcnt(14)
    ds_read_b128 a[104:107], v62 offset:10240
    v_exp_f32 v18, v18
    v_mfma_f32_16x16x32_bf16 v[156:159], a[252:255], v[124:127], v[156:159]
    ds_read_b128 a[108:111], v63 offset:11264
    v_exp_f32 v19, v19
    v_mfma_f32_16x16x32_bf16 v[152:155], a[252:255], v[116:119], v[152:155]
    ds_read_b64_tr_b16 a[16:17], v1 offset:16712
    ds_read_b64_tr_b16 a[18:19], v1 offset:17224
    v_cvt_pk_bf16_f32 v88, v16, v17
    v_mfma_f32_16x16x32_bf16 v[152:155], a[248:251], v[112:115], v[152:155]
    s_waitcnt lgkmcnt(14)
    ds_read_b64_tr_b16 a[20:21], v1 offset:17736
    ds_read_b64_tr_b16 a[22:23], v1 offset:18248
    v_mfma_f32_16x16x32_bf16 v[20:23], a[80:83], a[48:51], -4.0
    s_waitcnt lgkmcnt(14)
    ds_read_b64_tr_b16 a[24:25], v1 offset:16720
    ds_read_b64_tr_b16 a[26:27], v1 offset:17232
    v_cvt_pk_bf16_f32 v89, v18, v19
    v_mfma_f32_16x16x32_bf16 v[20:23], a[84:87], a[52:55], v[20:23]
    s_waitcnt lgkmcnt(14)
    ds_read_b64_tr_b16 a[28:29], v1 offset:17744
    ds_read_b64_tr_b16 a[30:31], v1 offset:18256
    v_add_f32 v40, v40, v41
    v_mfma_f32_16x16x32_bf16 v[20:23], a[88:91], a[56:59], v[20:23]
    s_waitcnt lgkmcnt(14)
    ds_read_b128 a[112:115], v62 offset:12288
    v_rcp_f32 v48, v40
    v_mfma_f32_16x16x32_bf16 v[20:23], a[92:95], a[60:63], v[20:23]
    s_waitcnt lgkmcnt(14)
    ds_read_b128 a[116:119], v63 offset:13312
    v_mul_f32 v136, v136, v48
    v_mfma_f32_16x16x32_bf16 v[168:171], a[0:3], v[112:115], v[168:171]
    s_waitcnt lgkmcnt(14)
    ds_read_b128 a[120:123], v62 offset:14336
    v_mul_f32 v137, v137, v48
    v_mul_f32 v138, v138, v48
    v_mfma_f32_16x16x32_bf16 v[168:171], a[4:7], v[116:119], v[168:171]
    ds_read_b128 a[124:127], v63 offset:15360
    v_mul_f32 v139, v139, v48
    v_mul_f32 v152, v152, v48
    v_mfma_f32_16x16x32_bf16 v[172:175], a[4:7], v[124:127], v[172:175]
    ds_read_b64_tr_b16 a[224:225], v1 offset:16776
    ds_read_b64_tr_b16 a[226:227], v1 offset:17288
    v_mul_f32 v153, v153, v48
    v_mfma_f32_16x16x32_bf16 v[172:175], a[0:3], v[120:123], v[172:175]
    s_waitcnt lgkmcnt(14)
    ds_read_b64_tr_b16 a[228:229], v1 offset:17800
    ds_read_b64_tr_b16 a[230:231], v1 offset:18312
    v_mfma_f32_16x16x32_bf16 v[188:191], a[8:11], v[120:123], v[188:191]
    s_waitcnt lgkmcnt(14)
    ds_read_b64_tr_b16 a[232:233], v1 offset:16784
    ds_read_b64_tr_b16 a[234:235], v1 offset:17296
    v_mul_f32 v154, v154, v48
    v_mfma_f32_16x16x32_bf16 v[188:191], a[12:15], v[124:127], v[188:191]
    ds_read_b64_tr_b16 a[236:237], v1 offset:17808
    ds_read_b64_tr_b16 a[238:239], v1 offset:18320
    v_mul_f32 v155, v155, v48
    v_mfma_f32_16x16x32_bf16 v[184:187], a[12:15], v[116:119], v[184:187]
    ds_read_b128 a[64:67], v62 offset:16384
    v_exp_f32 v20, v20
    v_mfma_f32_16x16x32_bf16 v[184:187], a[8:11], v[112:115], v[184:187]
    s_waitcnt lgkmcnt(14)
    ds_read_b128 a[68:71], v63 offset:17408
    v_cvt_pk_bf16_f32 v155, v154, v155
    v_mfma_f32_16x16x32_bf16 v[24:27], a[96:99], a[48:51], -4.0
    s_waitcnt lgkmcnt(14)
    ds_read_b128 a[72:75], v62 offset:18432
    v_exp_f32 v21, v21
    v_mfma_f32_16x16x32_bf16 v[24:27], a[100:103], a[52:55], v[24:27]
    s_waitcnt lgkmcnt(14)
    ds_read_b128 a[76:79], v63 offset:19456
    v_exp_f32 v22, v22
    v_mfma_f32_16x16x32_bf16 v[24:27], a[104:107], a[56:59], v[24:27]
    s_waitcnt lgkmcnt(14)
    ds_read_b128 a[92:95], v63 offset:23552
    v_exp_f32 v23, v23
    v_mfma_f32_16x16x32_bf16 v[24:27], a[108:111], a[60:63], v[24:27]
    ds_read_b128 a[88:91], v62 offset:22528
    v_cvt_pk_bf16_f32 v90, v20, v21
    v_smfmac_f32_16x16x64_bf16 v[44:47], v[12:15], v[120:127], v57
    s_waitcnt lgkmcnt(14)
    ds_read_b128 a[84:87], v63 offset:21504
    v_cvt_pk_bf16_f32 v91, v22, v23
    v_mfma_f32_16x16x32_bf16 v[204:207], a[16:19], v[120:123], v[204:207]
    s_waitcnt lgkmcnt(14)
    ds_read_b128 a[80:83], v62 offset:20480
    v_cvt_pk_bf16_f32 v154, v152, v153
    v_cvt_pk_bf16_f32 v152, v136, v137
    v_mfma_f32_16x16x32_bf16 v[204:207], a[20:23], v[124:127], v[204:207]
    ds_read_b128 a[96:99], v62 offset:24576
    v_cvt_pk_bf16_f32 v153, v138, v139
    v_mul_f32 v168, v168, v48
    v_mfma_f32_16x16x32_bf16 v[200:203], a[20:23], v[116:119], v[200:203]
    buffer_store_dwordx4 v[152:155], v59, s[24:27], s43 offen offset:0 sc1
    v_mfma_f32_16x16x32_bf16 v[200:203], a[16:19], v[112:115], v[200:203]
    s_waitcnt lgkmcnt(14)
    ds_read_b128 a[100:103], v63 offset:25600
    v_exp_f32 v24, v24
    v_mfma_f32_16x16x32_bf16 v[216:219], a[24:27], v[112:115], v[216:219]
    s_waitcnt lgkmcnt(14)
    ds_read_b128 a[104:107], v62 offset:26624
    v_exp_f32 v25, v25
    v_mfma_f32_16x16x32_bf16 v[216:219], a[28:31], v[116:119], v[216:219]
    v_exp_f32 v26, v26
    v_cvt_pk_bf16_f32 v92, v24, v25
    v_mfma_f32_16x16x32_bf16 v[220:223], a[28:31], v[124:127], v[220:223]
    v_exp_f32 v27, v27
    v_mfma_f32_16x16x32_bf16 v[220:223], a[24:27], v[120:123], v[220:223]
    s_waitcnt lgkmcnt(14)
    ds_read_b128 a[108:111], v63 offset:27648
    v_cvt_pk_bf16_f32 v93, v26, v27
    v_mul_f32 v169, v169, v48
    v_mfma_f32_16x16x32_bf16 v[28:31], a[112:115], a[48:51], -4.0
    s_waitcnt lgkmcnt(14)
    v_mul_f32 v170, v170, v48
    v_mul_f32 v171, v171, v48
    v_mul_f32 v184, v184, v48
    v_mfma_f32_16x16x32_bf16 v[28:31], a[116:119], a[52:55], v[28:31]
    s_waitcnt lgkmcnt(14)
    v_mul_f32 v185, v185, v48
    v_mul_f32 v186, v186, v48
    v_mul_f32 v187, v187, v48
    v_mfma_f32_16x16x32_bf16 v[28:31], a[120:123], a[56:59], v[28:31]
    s_waitcnt lgkmcnt(14)
    v_cvt_pk_bf16_f32 v187, v186, v187
    v_cvt_pk_bf16_f32 v186, v184, v185
    v_mfma_f32_16x16x32_bf16 v[28:31], a[124:127], a[60:63], v[28:31]
    s_waitcnt lgkmcnt(14)
    ds_read_b128 a[112:115], v62 offset:28672
    v_cvt_pk_bf16_f32 v184, v168, v169
    v_cvt_pk_bf16_f32 v185, v170, v171
    v_mfma_f32_16x16x32_bf16 v[232:235], a[224:227], v[112:115], v[232:235]
    s_waitcnt lgkmcnt(14)
    ds_read_b128 a[116:119], v63 offset:29696
    v_mul_f32 v200, v200, v48
    v_mul_f32 v201, v201, v48
    v_mfma_f32_16x16x32_bf16 v[232:235], a[228:231], v[116:119], v[232:235]
    ds_read_b128 a[120:123], v62 offset:30720
    v_mul_f32 v202, v202, v48
    v_mul_f32 v203, v203, v48
    v_mfma_f32_16x16x32_bf16 v[236:239], a[228:231], v[124:127], v[236:239]
    ds_read_b128 a[124:127], v63 offset:31744
    v_mul_f32 v216, v216, v48
    v_mul_f32 v217, v217, v48
    v_mfma_f32_16x16x32_bf16 v[236:239], a[224:227], v[120:123], v[236:239]
    s_waitcnt lgkmcnt(14)
    buffer_store_dwordx4 v[184:187], v59, s[24:27], s43 offen offset:64 sc1
    v_mfma_f32_16x16x32_bf16 v[252:255], a[232:235], v[120:123], v[252:255]
    s_waitcnt lgkmcnt(14)
    v_exp_f32 v28, v28
    v_mul_f32 v218, v218, v48
    v_mfma_f32_16x16x32_bf16 v[252:255], a[236:239], v[124:127], v[252:255]
    v_exp_f32 v29, v29
    v_mul_f32 v219, v219, v48
    v_mfma_f32_16x16x32_bf16 v[248:251], a[236:239], v[116:119], v[248:251]
    v_exp_f32 v30, v30
    v_cvt_pk_bf16_f32 v94, v28, v29
    v_mfma_f32_16x16x32_bf16 v[248:251], a[232:235], v[112:115], v[248:251]
    s_waitcnt lgkmcnt(14)
    v_exp_f32 v31, v31
    v_mfma_f32_16x16x32_bf16 v[16:19], a[64:67], a[48:51], -4.0
    s_waitcnt lgkmcnt(14)
    v_cvt_pk_bf16_f32 v95, v30, v31
    v_cvt_pk_bf16_f32 v219, v218, v219
    v_cvt_pk_bf16_f32 v218, v216, v217
    v_mfma_f32_16x16x32_bf16 v[16:19], a[68:71], a[52:55], v[16:19]
    s_waitcnt lgkmcnt(13)
    ds_read_b64_tr_b16 a[244:245], v1 offset:50776
    v_cvt_pk_bf16_f32 v216, v200, v201
    v_cvt_pk_bf16_f32 v217, v202, v203
    v_mfma_f32_16x16x32_bf16 v[16:19], a[72:75], a[56:59], v[16:19]
    s_waitcnt lgkmcnt(13)
    ds_read_b64_tr_b16 a[246:247], v1 offset:51288
    ds_read_b64_tr_b16 a[252:253], v1 offset:50784
    v_mul_f32 v232, v232, v48
    v_mfma_f32_16x16x32_bf16 v[16:19], a[76:79], a[60:63], v[16:19]
    s_waitcnt lgkmcnt(14)
    ds_read_b64_tr_b16 a[254:255], v1 offset:51296
    v_mul_f32 v233, v233, v48
    v_mfma_f32_16x16x32_bf16 v[20:23], a[92:95], a[60:63], -4.0
    s_waitcnt lgkmcnt(14)
    v_mul_f32 v234, v234, v48
    v_mul_f32 v235, v235, v48
    v_mul_f32 v248, v248, v48
    v_mfma_f32_16x16x32_bf16 v[20:23], a[88:91], a[56:59], v[20:23]
    s_waitcnt lgkmcnt(13)
    v_mul_f32 v249, v249, v48
    v_mul_f32 v250, v250, v48
    v_mul_f32 v251, v251, v48
    v_mfma_f32_16x16x32_bf16 v[20:23], a[84:87], a[52:55], v[20:23]
    s_waitcnt lgkmcnt(12)
    v_cvt_pk_bf16_f32 v251, v250, v251
    v_cvt_pk_bf16_f32 v250, v248, v249
    v_cvt_pk_bf16_f32 v248, v232, v233
    v_mfma_f32_16x16x32_bf16 v[20:23], a[80:83], a[48:51], v[20:23]
    v_exp_f32 v16, v16
    v_cvt_pk_bf16_f32 v249, v234, v235
    v_mfma_f32_16x16x32_bf16 v[140:143], a[128:131], v[88:91], v[140:143]
    buffer_store_dwordx4 v[216:219], v59, s[24:27], s43 offen offset:128 sc1
    v_mfma_f32_16x16x32_bf16 v[140:143], a[132:135], v[92:95], v[140:143]
    ds_read_b64_tr_b16 a[4:5], v1 offset:50840
    v_exp_f32 v17, v17
    v_smfmac_f32_16x16x64_bf16 v[44:47], v[12:15], v[88:95], v57
    v_exp_f32 v18, v18
    v_mfma_f32_16x16x32_bf16 v[156:159], a[136:139], v[88:91], v[156:159]
    v_exp_f32 v19, v19
    v_cvt_pk_bf16_f32 v120, v16, v17
    v_mfma_f32_16x16x32_bf16 v[156:159], a[140:143], v[92:95], v[156:159]
    s_waitcnt lgkmcnt(12)
    v_exp_f32 v20, v20
    v_mfma_f32_16x16x32_bf16 v[24:27], a[96:99], a[48:51], -4.0
    s_waitcnt lgkmcnt(11)
    v_exp_f32 v21, v21
    v_cvt_pk_bf16_f32 v121, v18, v19
    v_mfma_f32_16x16x32_bf16 v[24:27], a[100:103], a[52:55], v[24:27]
    s_waitcnt lgkmcnt(10)
    v_exp_f32 v22, v22
    v_cvt_pk_bf16_f32 v122, v20, v21
    v_mfma_f32_16x16x32_bf16 v[24:27], a[104:107], a[56:59], v[24:27]
    s_waitcnt lgkmcnt(9)
    ds_read_b64_tr_b16 a[6:7], v1 offset:51352
    v_exp_f32 v23, v23
    v_mfma_f32_16x16x32_bf16 v[24:27], a[108:111], a[60:63], v[24:27]
    ds_read_b64_tr_b16 a[12:13], v1 offset:50848
    ds_read_b64_tr_b16 a[14:15], v1 offset:51360
    v_cvt_pk_bf16_f32 v123, v22, v23
    v_mfma_f32_16x16x32_bf16 v[172:175], a[144:147], v[88:91], v[172:175]
    ds_read_b64_tr_b16 a[20:21], v1 offset:50904
    ds_read_b64_tr_b16 a[22:23], v1 offset:51416
    v_mfma_f32_16x16x32_bf16 v[172:175], a[148:151], v[92:95], v[172:175]
    ds_read_b64_tr_b16 a[28:29], v1 offset:50912
    ds_read_b64_tr_b16 a[30:31], v1 offset:51424
    v_max3_u32 v58, v58, v40, v48
    v_mfma_f32_16x16x32_bf16 v[188:191], a[156:159], v[92:95], v[188:191]
    ds_read_b64_tr_b16 a[228:229], v1 offset:50968
    ds_read_b64_tr_b16 a[230:231], v1 offset:51480
    v_mfma_f32_16x16x32_bf16 v[188:191], a[152:155], v[88:91], v[188:191]
    v_exp_f32 v24, v24
    v_exp_f32 v25, v25
    v_mfma_f32_16x16x32_bf16 v[204:207], a[160:163], v[88:91], v[204:207]
    buffer_store_dwordx4 v[248:251], v59, s[24:27], s43 offen offset:192 sc1
    v_cvt_pk_bf16_f32 v124, v24, v25
    v_mfma_f32_16x16x32_bf16 v[204:207], a[164:167], v[92:95], v[204:207]
    s_waitcnt lgkmcnt(14)
    ds_read_b64_tr_b16 a[236:237], v1 offset:50976
    v_exp_f32 v26, v26
    v_mfma_f32_16x16x32_bf16 v[28:31], a[112:115], a[48:51], -4.0
    s_waitcnt lgkmcnt(14)
    v_exp_f32 v27, v27
    v_mfma_f32_16x16x32_bf16 v[28:31], a[116:119], a[52:55], v[28:31]
    s_waitcnt lgkmcnt(14)
    ds_read_b64_tr_b16 a[238:239], v1 offset:51488
    v_cvt_pk_bf16_f32 v125, v26, v27
    v_mfma_f32_16x16x32_bf16 v[28:31], a[120:123], a[56:59], v[28:31]
    s_waitcnt lgkmcnt(14)
    v_mfma_f32_16x16x32_bf16 v[28:31], a[124:127], a[60:63], v[28:31]
    s_add_u32 s43, s43, 4096
    v_mfma_f32_16x16x32_bf16 v[220:223], a[168:171], v[88:91], v[220:223]
    v_mfma_f32_16x16x32_bf16 v[220:223], a[172:175], v[92:95], v[220:223]
    v_mfma_f32_16x16x32_bf16 v[236:239], a[180:183], v[92:95], v[236:239]
    s_nop 0
    s_nop 0
    v_mfma_f32_16x16x32_bf16 v[236:239], a[176:179], v[88:91], v[236:239]
    s_nop 0
    v_exp_f32 v28, v28
    v_exp_f32 v29, v29
    v_exp_f32 v30, v30
    v_mfma_f32_16x16x32_bf16 v[252:255], a[184:187], v[88:91], v[252:255]
    v_exp_f32 v31, v31
    v_cvt_pk_bf16_f32 v126, v28, v29
    v_mfma_f32_16x16x32_bf16 v[252:255], a[188:191], v[92:95], v[252:255]
    v_cvt_pk_bf16_f32 v127, v30, v31
    v_mfma_f32_16x16x32_bf16 v[140:143], a[192:195], v[120:123], v[140:143]
    s_waitcnt lgkmcnt(14)
    v_mfma_f32_16x16x32_bf16 v[140:143], a[244:247], v[124:127], v[140:143]
    v_smfmac_f32_16x16x64_bf16 v[44:47], v[12:15], v[120:127], v57
    v_mfma_f32_16x16x32_bf16 v[156:159], a[196:199], v[120:123], v[156:159]
    s_waitcnt lgkmcnt(12)
    v_mfma_f32_16x16x32_bf16 v[156:159], a[252:255], v[124:127], v[156:159]
    s_waitcnt lgkmcnt(10)
    v_mfma_f32_16x16x32_bf16 v[172:175], a[4:7], v[124:127], v[172:175]
    v_mfma_f32_16x16x32_bf16 v[172:175], a[200:203], v[120:123], v[172:175]
    v_mfma_f32_16x16x32_bf16 v[188:191], a[204:207], v[120:123], v[188:191]
    s_nop 0
    s_nop 0
    s_waitcnt lgkmcnt(8)
    v_mfma_f32_16x16x32_bf16 v[188:191], a[12:15], v[124:127], v[188:191]
    s_waitcnt lgkmcnt(6)
    v_add_f32 v44, v44, v45
    v_rcp_f32 v50, v44
    v_mfma_f32_16x16x32_bf16 v[204:207], a[20:23], v[124:127], v[204:207]
    v_mul_f32 v140, v140, v50
    v_mul_f32 v141, v141, v50
    v_mul_f32 v142, v142, v50
    v_mul_f32 v143, v143, v50
    v_mul_f32 v156, v156, v50
    v_mul_f32 v157, v157, v50
    v_mul_f32 v158, v158, v50
    v_mul_f32 v159, v159, v50
    v_cvt_pk_bf16_f32 v159, v158, v159
    v_cvt_pk_bf16_f32 v158, v156, v157
    v_mfma_f32_16x16x32_bf16 v[204:207], a[208:211], v[120:123], v[204:207]
    v_cvt_pk_bf16_f32 v156, v140, v141
    v_cvt_pk_bf16_f32 v157, v142, v143
    v_mul_f32 v172, v172, v50
    v_mul_f32 v173, v173, v50
    v_mul_f32 v174, v174, v50
    v_mul_f32 v175, v175, v50
    v_max3_u32 v58, v58, v44, v50
    v_mfma_f32_16x16x32_bf16 v[220:223], a[212:215], v[120:123], v[220:223]
    s_waitcnt lgkmcnt(4)
    buffer_store_dwordx4 v[156:159], v59, s[24:27], s43 offen offset:0 sc1
    v_mfma_f32_16x16x32_bf16 v[220:223], a[28:31], v[124:127], v[220:223]
    s_waitcnt lgkmcnt(2)
    v_mul_f32 v188, v188, v50
    v_mul_f32 v189, v189, v50
    v_mul_f32 v190, v190, v50
    v_mul_f32 v191, v191, v50
    v_cvt_pk_bf16_f32 v191, v190, v191
    v_cvt_pk_bf16_f32 v190, v188, v189
    v_cvt_pk_bf16_f32 v188, v172, v173
    v_cvt_pk_bf16_f32 v189, v174, v175
    v_mfma_f32_16x16x32_bf16 v[236:239], a[228:231], v[124:127], v[236:239]
    v_mfma_f32_16x16x32_bf16 v[236:239], a[216:219], v[120:123], v[236:239]
    buffer_store_dwordx4 v[188:191], v59, s[24:27], s43 offen offset:64 sc1
    v_mul_f32 v204, v204, v50
    v_mul_f32 v205, v205, v50
    v_mul_f32 v206, v206, v50
    v_mul_f32 v207, v207, v50
    v_mfma_f32_16x16x32_bf16 v[252:255], a[220:223], v[120:123], v[252:255]
    s_waitcnt lgkmcnt(0)
    v_mul_f32 v220, v220, v50
    v_mul_f32 v221, v221, v50
    v_mul_f32 v222, v222, v50
    v_mul_f32 v223, v223, v50
    v_cvt_pk_bf16_f32 v223, v222, v223
    v_cvt_pk_bf16_f32 v222, v220, v221
    v_cvt_pk_bf16_f32 v220, v204, v205
    v_cvt_pk_bf16_f32 v221, v206, v207
    v_mul_f32 v236, v236, v50
    v_mul_f32 v237, v237, v50
    v_mul_f32 v238, v238, v50
    v_mul_f32 v239, v239, v50
    buffer_store_dwordx4 v[220:223], v59, s[24:27], s43 offen offset:128 sc1
    v_mfma_f32_16x16x32_bf16 v[252:255], a[236:239], v[124:127], v[252:255]
    s_nop 7
    v_mul_f32 v252, v252, v50
    v_mul_f32 v253, v253, v50
    v_mul_f32 v254, v254, v50
    v_mul_f32 v255, v255, v50
    v_cvt_pk_bf16_f32 v255, v254, v255
    v_cvt_pk_bf16_f32 v254, v252, v253
    v_cvt_pk_bf16_f32 v252, v236, v237
    v_cvt_pk_bf16_f32 v253, v238, v239
    buffer_store_dwordx4 v[252:255], v59, s[24:27], s43 offen offset:192 sc1
    s_add_u32 s43, s43, 4096
    v_cmp_lt_u32 vcc, 0x4f800000, v58
    s_nop 4
    s_cbranch_vccnz L_slow
L_end:
    s_endpgm
L_slow:
    s_waitcnt vmcnt(0) lgkmcnt(0)
    s_barrier
    s_mov_b32 s42, 0
    s_lshl_b32 s46, s3, 12
    s_lshl_b32 s47, s3, 13
    s_add_u32 s48, s47, 0x20000
    s_add_u32 s49, s48, 4096
    s_sub_u32 s20, s20, s46
    s_subb_u32 s21, s21, 0
    s_mov_b32 s22, 0x20000
    v_bfe_u32 v25, v0, 4, 4
    v_lshrrev_b32 v26, 8, v0
    v_lshlrev_b32 v3, 4, v26
    v_lshl_add_u32 v3, v25, 8, v3
    v_xor_b32 v26, v25, v26
    v_and_b32 v26, 7, v26
    v_lshlrev_b32 v26, 4, v26
    v_lshl_add_u32 v50, v25, 8, v26
    v_xor_b32 v51, 64, v50
    v_lshrrev_b32 v26, 6, v0
    v_lshlrev_b32 v26, 8, v26
    v_and_b32 v25, 0x30, v0
    v_add3_u32 v1, v25, v26, s48
    s_sub_u32 s16, s16, s46
    s_subb_u32 s17, s17, 0
    s_mov_b32 s18, 0x20000
    s_mov_b32 s44, 0
L_skld:
    buffer_load_dwordx4 v[128:131], v0, s[16:19], s44 offen offset:0
    buffer_load_dwordx4 v[132:135], v0, s[16:19], s44 offen offset:1024
    buffer_load_dwordx4 v[136:139], v0, s[16:19], s44 offen offset:2048
    buffer_load_dwordx4 v[140:143], v0, s[16:19], s44 offen offset:3072
    s_waitcnt vmcnt(0)
    v_lshlrev_b32 v25, 16, v128
    v_and_b32 v128, s54, v128
    v_mul_f32 v25, s45, v25
    v_mul_f32 v128, s45, v128
    v_cvt_pk_bf16_f32 v128, v25, v128
    v_lshlrev_b32 v25, 16, v129
    v_and_b32 v129, s54, v129
    v_mul_f32 v25, s45, v25
    v_mul_f32 v129, s45, v129
    v_cvt_pk_bf16_f32 v129, v25, v129
    v_lshlrev_b32 v25, 16, v130
    v_and_b32 v130, s54, v130
    v_mul_f32 v25, s45, v25
    v_mul_f32 v130, s45, v130
    v_cvt_pk_bf16_f32 v130, v25, v130
    v_lshlrev_b32 v25, 16, v131
    v_and_b32 v131, s54, v131
    v_mul_f32 v25, s45, v25
    v_mul_f32 v131, s45, v131
    v_cvt_pk_bf16_f32 v131, v25, v131
    v_lshlrev_b32 v25, 16, v132
    v_and_b32 v132, s54, v132
    v_mul_f32 v25, s45, v25
    v_mul_f32 v132, s45, v132
    v_cvt_pk_bf16_f32 v132, v25, v132
    v_lshlrev_b32 v25, 16, v133
    v_and_b32 v133, s54, v133
    v_mul_f32 v25, s45, v25
    v_mul_f32 v133, s45, v133
    v_cvt_pk_bf16_f32 v133, v25, v133
    v_lshlrev_b32 v25, 16, v134
    v_and_b32 v134, s54, v134
    v_mul_f32 v25, s45, v25
    v_mul_f32 v134, s45, v134
    v_cvt_pk_bf16_f32 v134, v25, v134
    v_lshlrev_b32 v25, 16, v135
    v_and_b32 v135, s54, v135
    v_mul_f32 v25, s45, v25
    v_mul_f32 v135, s45, v135
    v_cvt_pk_bf16_f32 v135, v25, v135
    v_lshlrev_b32 v25, 16, v136
    v_and_b32 v136, s54, v136
    v_mul_f32 v25, s45, v25
    v_mul_f32 v136, s45, v136
    v_cvt_pk_bf16_f32 v136, v25, v136
    v_lshlrev_b32 v25, 16, v137
    v_and_b32 v137, s54, v137
    v_mul_f32 v25, s45, v25
    v_mul_f32 v137, s45, v137
    v_cvt_pk_bf16_f32 v137, v25, v137
    v_lshlrev_b32 v25, 16, v138
    v_and_b32 v138, s54, v138
    v_mul_f32 v25, s45, v25
    v_mul_f32 v138, s45, v138
    v_cvt_pk_bf16_f32 v138, v25, v138
    v_lshlrev_b32 v25, 16, v139
    v_and_b32 v139, s54, v139
    v_mul_f32 v25, s45, v25
    v_mul_f32 v139, s45, v139
    v_cvt_pk_bf16_f32 v139, v25, v139
    v_lshlrev_b32 v25, 16, v140
    v_and_b32 v140, s54, v140
    v_mul_f32 v25, s45, v25
    v_mul_f32 v140, s45, v140
    v_cvt_pk_bf16_f32 v140, v25, v140
    v_lshlrev_b32 v25, 16, v141
    v_and_b32 v141, s54, v141
    v_mul_f32 v25, s45, v25
    v_mul_f32 v141, s45, v141
    v_cvt_pk_bf16_f32 v141, v25, v141
    v_lshlrev_b32 v25, 16, v142
    v_and_b32 v142, s54, v142
    v_mul_f32 v25, s45, v25
    v_mul_f32 v142, s45, v142
    v_cvt_pk_bf16_f32 v142, v25, v142
    v_lshlrev_b32 v25, 16, v143
    v_and_b32 v143, s54, v143
    v_mul_f32 v25, s45, v25
    v_mul_f32 v143, s45, v143
    v_cvt_pk_bf16_f32 v143, v25, v143
    ds_write_b128 v50, v[128:131] offset:0
    ds_write_b128 v51, v[132:135] offset:0
    ds_write_b128 v50, v[136:139] offset:128
    ds_write_b128 v51, v[140:143] offset:128
    s_waitcnt lgkmcnt(0)
    v_add_u32 v50, 4096, v50
    v_add_u32 v51, 4096, v51
    s_add_u32 s44, s44, 4096
    s_cmp_lt_u32 s44, 0x20000
    s_cbranch_scc1 L_skld
L_sblk:
    buffer_load_dwordx4 a[0:3], v3, s[12:15], s42 offen offset:0
    buffer_load_dwordx4 a[4:7], v3, s[12:15], s42 offen offset:64
    buffer_load_dwordx4 a[8:11], v3, s[12:15], s42 offen offset:128
    buffer_load_dwordx4 a[12:15], v3, s[12:15], s42 offen offset:192
    v_mov_b32 v24, 0xff800000
    v_mov_b32 v62, v60
    v_mov_b32 v63, v61
    s_mov_b32 s44, 32
    s_waitcnt vmcnt(0)
L_smax:
    ds_read_b128 a[192:195], v62 offset:0
    ds_read_b128 a[196:199], v63 offset:1024
    ds_read_b128 a[200:203], v62 offset:2048
    ds_read_b128 a[204:207], v63 offset:3072
    s_waitcnt lgkmcnt(0)
    v_mfma_f32_16x16x32_bf16 v[16:19], a[192:195], a[0:3], 0
    v_mfma_f32_16x16x32_bf16 v[16:19], a[196:199], a[4:7], v[16:19]
    v_mfma_f32_16x16x32_bf16 v[16:19], a[200:203], a[8:11], v[16:19]
    v_mfma_f32_16x16x32_bf16 v[16:19], a[204:207], a[12:15], v[16:19]
    s_nop 7
    v_max3_f32 v24, v24, v16, v17
    v_max3_f32 v24, v24, v18, v19
    v_add_u32 v62, 4096, v62
    v_add_u32 v63, 4096, v63
    s_sub_u32 s44, s44, 1
    s_cmp_lg_u32 s44, 0
    s_cbranch_scc1 L_smax
    v_mov_b32 v25, v24
    s_nop 1
    v_permlane16_swap_b32 v24, v25
    s_nop 1
    v_max_f32 v24, v24, v25
    v_mov_b32 v25, v24
    s_nop 1
    v_permlane32_swap_b32 v24, v25
    s_nop 1
    v_max_f32 v24, v24, v25
    v_mov_b32 v32, 0
    v_mov_b32 v33, 0
    v_mov_b32 v34, 0
    v_mov_b32 v35, 0
    v_mov_b32 v128, 0
    v_mov_b32 v129, 0
    v_mov_b32 v130, 0
    v_mov_b32 v131, 0
    v_mov_b32 v132, 0
    v_mov_b32 v133, 0
    v_mov_b32 v134, 0
    v_mov_b32 v135, 0
    v_mov_b32 v136, 0
    v_mov_b32 v137, 0
    v_mov_b32 v138, 0
    v_mov_b32 v139, 0
    v_mov_b32 v140, 0
    v_mov_b32 v141, 0
    v_mov_b32 v142, 0
    v_mov_b32 v143, 0
    v_mov_b32 v144, 0
    v_mov_b32 v145, 0
    v_mov_b32 v146, 0
    v_mov_b32 v147, 0
    v_mov_b32 v148, 0
    v_mov_b32 v149, 0
    v_mov_b32 v150, 0
    v_mov_b32 v151, 0
    v_mov_b32 v152, 0
    v_mov_b32 v153, 0
    v_mov_b32 v154, 0
    v_mov_b32 v155, 0
    v_mov_b32 v156, 0
    v_mov_b32 v157, 0
    v_mov_b32 v158, 0
    v_mov_b32 v159, 0
    v_mov_b32 v62, v60
    v_mov_b32 v63, v61
    s_mov_b32 s44, 0
L_skey:
    s_mov_b32 m0, s48
    s_mov_b32 s51, s44
    s_add_u32 s50, s51, 4096
    buffer_load_dwordx4 v0, s[20:23], s51 offen offset:0 lds
    buffer_load_dwordx4 v0, s[20:23], s51 offen offset:1024 lds
    buffer_load_dwordx4 v0, s[20:23], s51 offen offset:2048 lds
    buffer_load_dwordx4 v0, s[20:23], s51 offen offset:3072 lds
    s_mov_b32 m0, s49
    s_nop 0
    buffer_load_dwordx4 v0, s[20:23], s50 offen offset:0 lds
    buffer_load_dwordx4 v0, s[20:23], s50 offen offset:1024 lds
    buffer_load_dwordx4 v0, s[20:23], s50 offen offset:2048 lds
    buffer_load_dwordx4 v0, s[20:23], s50 offen offset:3072 lds
    ds_read_b128 a[192:195], v62 offset:0
    ds_read_b128 a[196:199], v63 offset:1024
    ds_read_b128 a[200:203], v62 offset:2048
    ds_read_b128 a[204:207], v63 offset:3072
    ds_read_b128 a[208:211], v62 offset:4096
    ds_read_b128 a[212:215], v63 offset:5120
    ds_read_b128 a[216:219], v62 offset:6144
    ds_read_b128 a[220:223], v63 offset:7168
    s_waitcnt vmcnt(0) lgkmcnt(0)
    ds_read_b64_tr_b16 a[224:225], v1 offset:0
    ds_read_b64_tr_b16 a[226:227], v1 offset:4096
    ds_read_b64_tr_b16 a[228:229], v1 offset:8
    ds_read_b64_tr_b16 a[230:231], v1 offset:4104
    ds_read_b64_tr_b16 a[232:233], v1 offset:64
    ds_read_b64_tr_b16 a[234:235], v1 offset:4160
    ds_read_b64_tr_b16 a[236:237], v1 offset:72
    ds_read_b64_tr_b16 a[238:239], v1 offset:4168
    ds_read_b64_tr_b16 a[240:241], v1 offset:128
    ds_read_b64_tr_b16 a[242:243], v1 offset:4224
    ds_read_b64_tr_b16 a[244:245], v1 offset:136
    ds_read_b64_tr_b16 a[246:247], v1 offset:4232
    ds_read_b64_tr_b16 a[248:249], v1 offset:192
    ds_read_b64_tr_b16 a[250:251], v1 offset:4288
    ds_read_b64_tr_b16 a[252:253], v1 offset:200
    ds_read_b64_tr_b16 a[254:255], v1 offset:4296
    v_mfma_f32_16x16x32_bf16 v[16:19], a[192:195], a[0:3], 0
    v_mfma_f32_16x16x32_bf16 v[16:19], a[196:199], a[4:7], v[16:19]
    v_mfma_f32_16x16x32_bf16 v[16:19], a[200:203], a[8:11], v[16:19]
    v_mfma_f32_16x16x32_bf16 v[16:19], a[204:207], a[12:15], v[16:19]
    v_mfma_f32_16x16x32_bf16 v[20:23], a[208:211], a[0:3], 0
    v_mfma_f32_16x16x32_bf16 v[20:23], a[212:215], a[4:7], v[20:23]
    v_mfma_f32_16x16x32_bf16 v[20:23], a[216:219], a[8:11], v[20:23]
    v_mfma_f32_16x16x32_bf16 v[20:23], a[220:223], a[12:15], v[20:23]
    s_nop 7
    v_sub_f32 v16, v16, v24
    v_sub_f32 v17, v17, v24
    v_sub_f32 v18, v18, v24
    v_sub_f32 v19, v19, v24
    v_sub_f32 v20, v20, v24
    v_sub_f32 v21, v21, v24
    v_sub_f32 v22, v22, v24
    v_sub_f32 v23, v23, v24
    v_exp_f32 v16, v16
    v_exp_f32 v17, v17
    v_exp_f32 v18, v18
    v_exp_f32 v19, v19
    v_exp_f32 v20, v20
    v_exp_f32 v21, v21
    v_exp_f32 v22, v22
    v_exp_f32 v23, v23
    s_nop 0
    v_cvt_pk_bf16_f32 v64, v16, v17
    v_cvt_pk_bf16_f32 v65, v18, v19
    v_cvt_pk_bf16_f32 v66, v20, v21
    v_cvt_pk_bf16_f32 v67, v22, v23
    v_add_u32 v62, 8192, v62
    v_add_u32 v63, 8192, v63
    s_waitcnt lgkmcnt(0)
    s_nop 0
    v_mfma_f32_16x16x32_bf16 v[32:35], v[12:15], v[64:67], v[32:35]
    v_mfma_f32_16x16x32_bf16 v[128:131], a[224:227], v[64:67], v[128:131]
    v_mfma_f32_16x16x32_bf16 v[132:135], a[228:231], v[64:67], v[132:135]
    v_mfma_f32_16x16x32_bf16 v[136:139], a[232:235], v[64:67], v[136:139]
    v_mfma_f32_16x16x32_bf16 v[140:143], a[236:239], v[64:67], v[140:143]
    v_mfma_f32_16x16x32_bf16 v[144:147], a[240:243], v[64:67], v[144:147]
    v_mfma_f32_16x16x32_bf16 v[148:151], a[244:247], v[64:67], v[148:151]
    v_mfma_f32_16x16x32_bf16 v[152:155], a[248:251], v[64:67], v[152:155]
    v_mfma_f32_16x16x32_bf16 v[156:159], a[252:255], v[64:67], v[156:159]
    s_add_u32 s44, s44, 8192
    s_cmp_lt_u32 s44, 0x20000
    s_cbranch_scc1 L_skey
    s_nop 7
    v_rcp_f32 v48, v32
    s_nop 0
    v_mul_f32 v128, v128, v48
    v_mul_f32 v129, v129, v48
    v_mul_f32 v130, v130, v48
    v_mul_f32 v131, v131, v48
    v_mul_f32 v132, v132, v48
    v_mul_f32 v133, v133, v48
    v_mul_f32 v134, v134, v48
    v_mul_f32 v135, v135, v48
    v_mul_f32 v136, v136, v48
    v_mul_f32 v137, v137, v48
    v_mul_f32 v138, v138, v48
    v_mul_f32 v139, v139, v48
    v_mul_f32 v140, v140, v48
    v_mul_f32 v141, v141, v48
    v_mul_f32 v142, v142, v48
    v_mul_f32 v143, v143, v48
    v_mul_f32 v144, v144, v48
    v_mul_f32 v145, v145, v48
    v_mul_f32 v146, v146, v48
    v_mul_f32 v147, v147, v48
    v_mul_f32 v148, v148, v48
    v_mul_f32 v149, v149, v48
    v_mul_f32 v150, v150, v48
    v_mul_f32 v151, v151, v48
    v_mul_f32 v152, v152, v48
    v_mul_f32 v153, v153, v48
    v_mul_f32 v154, v154, v48
    v_mul_f32 v155, v155, v48
    v_mul_f32 v156, v156, v48
    v_mul_f32 v157, v157, v48
    v_mul_f32 v158, v158, v48
    v_mul_f32 v159, v159, v48
    v_cvt_pk_bf16_f32 v64, v128, v129
    v_cvt_pk_bf16_f32 v65, v130, v131
    v_cvt_pk_bf16_f32 v66, v132, v133
    v_cvt_pk_bf16_f32 v67, v134, v135
    v_cvt_pk_bf16_f32 v68, v136, v137
    v_cvt_pk_bf16_f32 v69, v138, v139
    v_cvt_pk_bf16_f32 v70, v140, v141
    v_cvt_pk_bf16_f32 v71, v142, v143
    v_cvt_pk_bf16_f32 v72, v144, v145
    v_cvt_pk_bf16_f32 v73, v146, v147
    v_cvt_pk_bf16_f32 v74, v148, v149
    v_cvt_pk_bf16_f32 v75, v150, v151
    v_cvt_pk_bf16_f32 v76, v152, v153
    v_cvt_pk_bf16_f32 v77, v154, v155
    v_cvt_pk_bf16_f32 v78, v156, v157
    v_cvt_pk_bf16_f32 v79, v158, v159
    s_nop 1
    buffer_store_dwordx4 v[64:67], v3, s[24:27], s42 offen offset:0
    buffer_store_dwordx4 v[68:71], v3, s[24:27], s42 offen offset:64
    buffer_store_dwordx4 v[72:75], v3, s[24:27], s42 offen offset:128
    buffer_store_dwordx4 v[76:79], v3, s[24:27], s42 offen offset:192
    s_add_u32 s42, s42, 4096
    s_cmp_lt_u32 s42, 0x10000
    s_waitcnt vmcnt(0)
    s_cbranch_scc1 L_sblk
    s_endpgm
.section .rodata,"a"
.p2align 6
.amdhsa_kernel standalone__gqa_softmax__near_ridge_kernel
  .amdhsa_next_free_vgpr 512
  .amdhsa_next_free_sgpr 102
  .amdhsa_accum_offset 256
  .amdhsa_group_segment_fixed_size 0
  .amdhsa_kernarg_size 48
  .amdhsa_user_sgpr_count 2
  .amdhsa_user_sgpr_kernarg_segment_ptr 1
  .amdhsa_system_sgpr_workgroup_id_x 1
.end_amdhsa_kernel
```
